```python
import torch

def _softmax(x, axis=-1):
    return torch.softmax(x, dim=axis)
def _gelu(x):
    return torch.nn.functional.gelu(x, approximate="tanh")
def _silu(x):
    return torch.nn.functional.silu(x)
def _sigmoid(x):
    return torch.sigmoid(x)
def _layernorm(x, axis=-1, eps=1e-5):
    m = x.mean(dim=axis, keepdim=True)
    v = x.var(dim=axis, keepdim=True, unbiased=False)
    return (x - m) / torch.sqrt(v + eps)
def _scatter_add(tgt, idx, src, axis=0):
    return tgt.clone().index_add_(axis, idx, src)
def _segment_sum(src, seg, n):
    out = torch.zeros((n,) + src.shape[1:], dtype=src.dtype)
    return out.index_add_(0, seg, src)
def _pad(x, pw):
    flat = tuple(v for pair in reversed(pw) for v in pair)
    return torch.nn.functional.pad(x, flat)

kernel_name = 'recurrent_scan__mha_block_cached__dense_activation_relu__prompt'

def setup_inputs():

    _w = (lambda a: (lambda t: t.to(torch.bfloat16) if t.is_floating_point() else t)(torch.as_tensor(a)))
    def _A_setup():
        B, Sq, D = 1, 2048, 512
        H, Sk, Dh = 32, 2048, 128
        return {
            "x": _w((lambda *s: torch.randn(*s, dtype=torch.bfloat16) * 0.05)(B, Sq, D)),
            "k_cache": _w((lambda *s: torch.randn(*s, dtype=torch.bfloat16) * 1.6)(B, H, Sk, Dh)),
            "v_cache": _w((lambda *s: torch.randn(*s, dtype=torch.bfloat16) * 0.2)(B, H, Sk, Dh)),
            "wq": _w((lambda *s: torch.randn(*s, dtype=torch.bfloat16) * 1.6)(D, H * Dh) * (D ** -0.5)),
            "wo": _w((lambda *s: torch.randn(*s, dtype=torch.bfloat16) * 0.2)(H * Dh, D) * ((H * Dh) ** -0.5)),
        }
    _A_in = _A_setup()

    def _B_setup():
        B, S, D, Dff = 1, 2048, 512, 1792
        return {
            "x": _w((lambda *s: torch.randn(*s, dtype=torch.bfloat16) * 0.05)(B, S, D)),
            "w1": _w((lambda *s: torch.randn(*s, dtype=torch.bfloat16) * 0.1)(D, Dff)),
            "w2": _w((lambda *s: torch.randn(*s, dtype=torch.bfloat16) * 0.1)(Dff, D)),
        }
    _B_in = _B_setup()

    return {
        "A_x": _A_in["x"],
        "A_k_cache": _A_in["k_cache"],
        "A_v_cache": _A_in["v_cache"],
        "A_wq": _A_in["wq"],
        "A_wo": _A_in["wo"],
        "B_x": _B_in["x"],
        "B_w1": _B_in["w1"],
        "B_w2": _B_in["w2"],
    }

def reference(A_x, A_k_cache, A_v_cache, A_wq, A_wo, B_x, B_w1, B_w2):
    def _A_ref(x, k_cache, v_cache, wq, wo):
        B, Sq, D = x.shape
        H, Dh = 32, 128
        q = (lambda x, *d: x.permute(*d))((x @ wq).reshape(B, Sq, H, Dh), 0, 2, 1, 3)
        scores = torch.einsum("bhqd,bhkd->bhqk", q, k_cache) * (Dh ** -0.5)
        p = _softmax(scores, axis=-1)
        o = torch.einsum("bhqk,bhkd->bhqd", p, v_cache)
        return (lambda x, *d: x.permute(*d))(o, 0, 2, 1, 3).reshape(B, Sq, H * Dh) @ wo

    def _B_ref(x, w1, w2):
        h = torch.einsum("bsd,df->bsf", x, w1)
        zero = torch.zeros_like(h)
        h = torch.maximum(h, zero)
        return torch.einsum("bsf,fd->bsd", h, w2)

    x = A_x
    xn = _layernorm(x, axis=-1)
    s = _A_ref(xn, A_k_cache, A_v_cache, A_wq, A_wo)
    g = _silu(_B_ref(xn, B_w1, B_w2))
    return x + s * g
```

```asm
; @launch grid=(256,1,1) block=(256,1,1) lds=163840
.amdgcn_target "amdgcn-amd-amdhsa--gfx950"
.text
.globl recurrent_scan__mha_block_cached__dense_activation_relu__prompt_kernel
.p2align 8
.type recurrent_scan__mha_block_cached__dense_activation_relu__prompt_kernel,@function
recurrent_scan__mha_block_cached__dense_activation_relu__prompt_kernel:
    s_cmp_ge_u32 s2, 256
    s_cbranch_scc1 K1_END
    s_nop 0
    s_load_dwordx2 s[50:51], s[0:1], 0
    s_load_dwordx2 s[54:55], s[0:1], 24
    s_load_dwordx2 s[46:47], s[0:1], 48
    s_load_dwordx4 s[4:7], s[0:1], 8
    s_load_dwordx2 s[52:53], s[0:1], 80
    s_load_dwordx2 s[80:81], s[0:1], 32
    s_load_dwordx2 s[82:83], s[0:1], 56
    s_load_dwordx2 s[96:97], s[0:1], 72
    s_and_b32 s44, s2, 7
    s_lshr_b32 s45, s2, 3
    s_lshl_b32 s44, s44, 2
    s_lshr_b32 s48, s45, 3
    s_add_u32 s42, s44, s48
    s_and_b32 s43, s45, 7
    v_lshrrev_b32 v1, 6, v0
    v_and_b32 v250, 63, v0
    s_nop 0
    v_readfirstlane_b32 s36, v1
    s_nop 3
    s_lshl_b32 s37, s36, 10
    s_lshl_b32 s38, s36, 11
    s_getpc_b64 s[100:101]
    s_lshr_b32 s44, s2, 3
    s_lshl_b32 s44, s44, 11
    v_lshlrev_b32 v32, 3, v0
    v_add_u32 v32, s44, v32
    global_load_dwordx2 a[160:161], v32, s[100:101]
    v_lshrrev_b32 v32, 3, v250
    v_and_b32 v33, 7, v250
    v_lshrrev_b32 v34, 4, v250
    v_xor_b32 v35, v33, v34
    v_lshlrev_b32 v35, 4, v35
    s_lshl_b32 s44, s36, 6
    v_add_u32_e64 v247, s44, v32
    v_lshl_add_u32 v246, v247, 10, v35
    v_xor_b32 v247, 64, v246
    s_lshl_b32 s49, s36, 13
    v_lshrrev_b32 v32, 4, v250
    v_and_b32 v33, 15, v250
    v_lshlrev_b32 v34, 2, v32
    v_xor_b32 v33, v33, v34
    v_lshlrev_b32 v33, 4, v33
    s_lshl_b32 s44, s36, 3
    v_add_u32_e64 v32, s44, v32
    v_lshl_add_u32 v248, v32, 13, v33
    v_lshrrev_b32 v32, 3, v250
    v_and_b32 v33, 7, v250
    v_lshrrev_b32 v34, 1, v32
    v_and_b32 v34, 1, v34
    s_and_b32 s45, s36, 1
    s_lshl_b32 s45, s45, 1
    v_or_b32 v34, s45, v34
    v_lshlrev_b32 v34, 1, v34
    v_xor_b32 v33, v33, v34
    v_lshlrev_b32 v33, 4, v33
    v_add_u32_e64 v32, s44, v32
    v_mul_u32_u24 v32, 0xe00, v32
    v_add_u32_e64 v249, v32, v33
    s_waitcnt lgkmcnt(0)
    s_lshl_b32 s44, s43, 18
    s_add_u32 s16, s50, s44
    s_addc_u32 s17, s51, 0
    s_mov_b32 s18, 0x40000
    s_mov_b32 s19, 0x20000
    s_lshl_b32 s44, s42, 8
    s_add_u32 s20, s54, s44
    s_addc_u32 s21, s55, 0
    s_nop 0
    s_sub_u32 s22, 0x400000, s44
    s_mov_b32 s23, 0x20000
    s_lshl_b32 s44, s42, 7
    s_add_u32 s24, s46, s44
    s_addc_u32 s25, s47, 0
    s_nop 0
    s_sub_u32 s26, 0x1c0000, s44
    s_cmp_ge_u32 s42, 28
    s_cselect_b32 s26, 0, s26
    s_mov_b32 s27, 0x20000
    s_add_u32 m0, s38, 0x1c000
    s_mov_b32 s45, 0x0
    s_nop 0
    buffer_load_dwordx4 v248, s[20:23], s45 offen lds
    s_mov_b32 s46, 0x7c00
    buffer_load_dwordx4 v248, s[20:23], s46 offen offset:1024 lds
    s_add_u32 m0, s37, 0x1e000
    s_mov_b32 s45, 0x0
    s_nop 0
    buffer_load_dwordx4 v249, s[24:27], s45 offen lds
    s_add_u32 m0, s49, 0x8000
    s_mov_b32 s45, 0x0
    s_nop 0
    buffer_load_dwordx4 v246, s[16:19], s45 offen offset:0 lds
    s_mov_b32 s46, 0x1c00
    buffer_load_dwordx4 v247, s[16:19], s46 offen offset:1024 lds
    s_mov_b32 s45, 0x3800
    buffer_load_dwordx4 v246, s[16:19], s45 offen offset:2048 lds
    s_mov_b32 s46, 0x5400
    buffer_load_dwordx4 v247, s[16:19], s46 offen offset:3072 lds
    s_add_u32 m0, s49, 0x9000
    s_mov_b32 s45, 0x8000
    buffer_load_dwordx4 v246, s[16:19], s45 offen offset:0 lds
    s_mov_b32 s46, 0x9c00
    buffer_load_dwordx4 v247, s[16:19], s46 offen offset:1024 lds
    s_mov_b32 s45, 0xb800
    buffer_load_dwordx4 v246, s[16:19], s45 offen offset:2048 lds
    s_mov_b32 s46, 0xd400
    buffer_load_dwordx4 v247, s[16:19], s46 offen offset:3072 lds
    s_add_u32 m0, s38, 0x1f000
    s_mov_b32 s45, 0x40000
    buffer_load_dwordx4 v248, s[20:23], s45 offen lds
    s_mov_b32 s46, 0x47c00
    buffer_load_dwordx4 v248, s[20:23], s46 offen offset:1024 lds
    s_add_u32 m0, s37, 0x21000
    s_mov_b32 s45, 0x1c000
    buffer_load_dwordx4 v249, s[24:27], s45 offen lds
    s_add_u32 m0, s49, 0x14000
    s_mov_b32 s45, 0x80
    buffer_load_dwordx4 v246, s[16:19], s45 offen offset:0 lds
    s_mov_b32 s46, 0x1c80
    buffer_load_dwordx4 v247, s[16:19], s46 offen offset:1024 lds
    s_mov_b32 s45, 0x3880
    buffer_load_dwordx4 v246, s[16:19], s45 offen offset:2048 lds
    s_mov_b32 s46, 0x5480
    buffer_load_dwordx4 v247, s[16:19], s46 offen offset:3072 lds
    s_add_u32 m0, s49, 0x15000
    s_mov_b32 s45, 0x8080
    buffer_load_dwordx4 v246, s[16:19], s45 offen offset:0 lds
    s_mov_b32 s46, 0x9c80
    buffer_load_dwordx4 v247, s[16:19], s46 offen offset:1024 lds
    s_mov_b32 s45, 0xb880
    buffer_load_dwordx4 v246, s[16:19], s45 offen offset:2048 lds
    s_mov_b32 s46, 0xd480
    buffer_load_dwordx4 v247, s[16:19], s46 offen offset:3072 lds
    s_add_u32 m0, s38, 0x22000
    s_mov_b32 s45, 0x80000
    buffer_load_dwordx4 v248, s[20:23], s45 offen lds
    s_mov_b32 s46, 0x87c00
    buffer_load_dwordx4 v248, s[20:23], s46 offen offset:1024 lds
    s_add_u32 m0, s37, 0x24000
    s_mov_b32 s45, 0x38000
    buffer_load_dwordx4 v249, s[24:27], s45 offen lds
    s_add_u32 m0, s38, 0x25000
    s_mov_b32 s45, 0xc0000
    buffer_load_dwordx4 v248, s[20:23], s45 offen lds
    s_mov_b32 s46, 0xc7c00
    buffer_load_dwordx4 v248, s[20:23], s46 offen offset:1024 lds
    s_add_u32 m0, s37, 0x27000
    s_mov_b32 s45, 0x54000
    buffer_load_dwordx4 v249, s[24:27], s45 offen lds
    s_lshl_b32 s44, s42, 19
    s_add_u32 s8, s4, s44
    s_addc_u32 s9, s5, 0
    s_nop 0
    s_mov_b32 s10, 0x80000
    s_mov_b32 s11, 0x20000
    s_add_u32 s12, s6, s44
    s_addc_u32 s13, s7, 0
    s_sub_u32 s12, s12, 24576
    s_subb_u32 s13, s13, 0
    s_nop 0
    s_mov_b32 s14, 0x86000
    s_mov_b32 s15, 0x20000
    s_mov_b32 s28, s52
    s_mov_b32 s29, s53
    s_mov_b32 s30, 0x1700000
    s_mov_b32 s31, 0x20000
    s_add_u32 s92, s52, 0x1800000
    s_addc_u32 s93, s53, 0
    s_nop 0
    s_mov_b32 s94, 0x5c0000
    s_mov_b32 s95, 0x20000
    s_mul_i32 s84, s2, 3
    v_and_b32 v32, 15, v250
    v_lshrrev_b32 v33, 4, v250
    v_lshrrev_b32 v34, 1, v32
    v_xor_b32 v34, v34, v33
    v_lshlrev_b32 v34, 4, v34
    v_lshl_add_u32 v34, v32, 7, v34
    s_lshl_b32 s44, s36, 13
    s_nop 0
    s_add_u32 s44, s44, 0x8000
    v_add_u32 v236, s44, v34
    v_xor_b32 v237, 64, v236
    v_and_b32 v32, 15, v250
    v_lshrrev_b32 v32, 2, v32
    v_lshrrev_b32_e64 v33, 4, v250
    v_lshl_add_u32 v34, v33, 3, v32
    v_lshlrev_b32 v34, 8, v34
    v_and_b32 v35, 3, v250
    v_lshl_add_u32 v34, v35, 4, v34
    v_lshl_add_u32 v34, v32, 6, v34
    s_lshl_b32 s44, s36, 6
    v_xor_b32 v34, s44, v34
    v_add_u32 v34, 0x1c000, v34
    v_xor_b32 v238, 0x0, v34
    v_xor_b32 v239, 0x40, v34
    v_xor_b32 v240, 0x80, v34
    v_xor_b32 v241, 0xc0, v34
    v_lshl_add_u32 v34, v33, 3, v32
    v_lshlrev_b32_e64 v34, 7, v34
    v_lshl_add_u32 v34, v35, 3, v34
    v_lshrrev_b32 v32, 1, v32
    v_and_b32 v33, 1, v33
    v_lshl_or_b32 v32, v33, 1, v32
    s_and_b32 s44, s36, 2
    v_xor_b32 v32, s44, v32
    v_lshl_add_u32 v34, v32, 5, v34
    v_add_u32 v34, 0x1e000, v34
    v_xor_b32 v242, 0x0, v34
    v_xor_b32 v243, 0x20, v34
    v_xor_b32_e64 v244, 0x40, v34
    v_xor_b32 v245, 0x60, v34
    v_lshrrev_b32 v32, 4, v250
    v_and_b32 v33, 15, v250
    v_lshlrev_b32 v34, 1, v32
    v_xor_b32 v34, v34, v33
    v_lshlrev_b32 v34, 4, v34
    s_lshl_b32 s44, s36, 3
    v_add_u32_e64 v35, s44, v32
    v_lshl_add_u32 v232, v35, 10, v34
    v_xor_b32 v233, 0x80, v232
    v_lshrrev_b32_e64 v33, 2, v33
    v_lshl_add_u32 v34, v32, 2, v33
    v_and_b32 v35, 7, v34
    v_lshlrev_b32 v35, 1, v35
    v_and_b32 v33, 3, v250
    v_xor_b32 v35, v35, v33
    v_lshlrev_b32_e64 v35, 4, v35
    v_lshl_add_u32 v34, v34, 8, v35
    s_lshl_b32 s44, s36, 6
    v_xor_b32 v234, s44, v34
    v_lshlrev_b32 v235, 4, v250
    v_lshlrev_b32 v251, 4, v250
    v_lshrrev_b32 v32, 4, v250
    v_and_b32 v33, 15, v250
    s_lshl_b32 s44, s36, 2
    v_add_u32 v34, s44, v32
    v_xor_b32 v35, v34, v33
    v_lshlrev_b32 v35, 4, v35
    v_lshl_add_u32 v252, v34, 8, v35
    v_add_u32 v253, 0x1000, v252
    v_lshlrev_b32 v35, 1, v32
    v_xor_b32 v35, v35, v33
    v_lshlrev_b32 v35, 4, v35
    s_lshl_b32 s44, s36, 3
    v_add_u32_e64 v34, s44, v32
    v_lshl_add_u32 v254, v34, 8, v35
    v_xor_b32 v255, 0x80, v254
    v_mov_b32 v64, 0
    v_mov_b32 v65, 0
    v_mov_b32 v66, 0
    v_mov_b32 v67, 0
    v_mov_b32 v68, 0
    v_mov_b32 v69, 0
    v_mov_b32 v70, 0
    v_mov_b32 v71, 0
    v_mov_b32 v72, 0
    v_mov_b32 v73, 0
    v_mov_b32 v74, 0
    v_mov_b32 v75, 0
    v_mov_b32 v76, 0
    v_mov_b32 v77, 0
    v_mov_b32 v78, 0
    v_mov_b32 v79, 0
    v_mov_b32 v80, 0
    v_mov_b32 v81, 0
    v_mov_b32 v82, 0
    v_mov_b32 v83, 0
    v_mov_b32 v84, 0
    v_mov_b32 v85, 0
    v_mov_b32 v86, 0
    v_mov_b32 v87, 0
    v_mov_b32 v88, 0
    v_mov_b32 v89, 0
    v_mov_b32 v90, 0
    v_mov_b32 v91, 0
    v_mov_b32 v92, 0
    v_mov_b32 v93, 0
    v_mov_b32 v94, 0
    v_mov_b32 v95, 0
    v_mov_b32 v96, 0
    v_mov_b32 v97, 0
    v_mov_b32 v98, 0
    v_mov_b32 v99, 0
    v_mov_b32 v100, 0
    v_mov_b32 v101, 0
    v_mov_b32 v102, 0
    v_mov_b32 v103, 0
    v_mov_b32 v104, 0
    v_mov_b32 v105, 0
    v_mov_b32 v106, 0
    v_mov_b32 v107, 0
    v_mov_b32 v108, 0
    v_mov_b32 v109, 0
    v_mov_b32 v110, 0
    v_mov_b32 v111, 0
    v_mov_b32 v112, 0
    v_mov_b32 v113, 0
    v_mov_b32 v114, 0
    v_mov_b32 v115, 0
    v_mov_b32 v116, 0
    v_mov_b32 v117, 0
    v_mov_b32 v118, 0
    v_mov_b32 v119, 0
    v_mov_b32 v120, 0
    v_mov_b32 v121, 0
    v_mov_b32 v122, 0
    v_mov_b32 v123, 0
    v_mov_b32 v124, 0
    v_mov_b32 v125, 0
    v_mov_b32 v126, 0
    v_mov_b32 v127, 0
    v_mov_b32 v128, 0
    v_mov_b32 v129, 0
    v_mov_b32 v130, 0
    v_mov_b32 v131, 0
    v_mov_b32 v132, 0
    v_mov_b32 v133, 0
    v_mov_b32 v134, 0
    v_mov_b32 v135, 0
    v_mov_b32 v136, 0
    v_mov_b32 v137, 0
    v_mov_b32 v138, 0
    v_mov_b32 v139, 0
    v_mov_b32 v140, 0
    v_mov_b32 v141, 0
    v_mov_b32 v142, 0
    v_mov_b32 v143, 0
    v_mov_b32 v144, 0
    v_mov_b32 v145, 0
    v_mov_b32 v146, 0
    v_mov_b32 v147, 0
    v_mov_b32 v148, 0
    v_mov_b32 v149, 0
    v_mov_b32 v150, 0
    v_mov_b32 v151, 0
    v_mov_b32 v152, 0
    v_mov_b32 v153, 0
    v_mov_b32 v154, 0
    v_mov_b32 v155, 0
    v_mov_b32 v156, 0
    v_mov_b32 v157, 0
    v_mov_b32 v158, 0
    v_mov_b32 v159, 0
    v_mov_b32 v160, 0
    v_mov_b32 v161, 0
    v_mov_b32 v162, 0
    v_mov_b32 v163, 0
    v_mov_b32 v164, 0
    v_mov_b32 v165, 0
    v_mov_b32 v166, 0
    v_mov_b32 v167, 0
    v_mov_b32 v168, 0
    v_mov_b32 v169, 0
    v_mov_b32 v170, 0
    v_mov_b32 v171, 0
    v_mov_b32 v172, 0
    v_mov_b32 v173, 0
    v_mov_b32 v174, 0
    v_mov_b32 v175, 0
    v_mov_b32 v176, 0
    v_mov_b32 v177, 0
    v_mov_b32 v178, 0
    v_mov_b32 v179, 0
    v_mov_b32 v180, 0
    v_mov_b32 v181, 0
    v_mov_b32 v182, 0
    v_mov_b32 v183, 0
    v_mov_b32 v184, 0
    v_mov_b32 v185, 0
    v_mov_b32 v186, 0
    v_mov_b32 v187, 0
    v_mov_b32 v188, 0
    v_mov_b32 v189, 0
    v_mov_b32 v190, 0
    v_mov_b32 v191, 0
    v_mov_b32 v192, 0
    v_mov_b32 v193, 0
    v_mov_b32 v194, 0
    v_mov_b32 v195, 0
    v_mov_b32 v196, 0
    v_mov_b32 v197, 0
    v_mov_b32 v198, 0
    v_mov_b32 v199, 0
    v_mov_b32 v200, 0
    v_mov_b32 v201, 0
    v_mov_b32 v202, 0
    v_mov_b32 v203, 0
    v_mov_b32 v204, 0
    v_mov_b32 v205, 0
    v_mov_b32 v206, 0
    v_mov_b32 v207, 0
    v_mov_b32 v208, 0
    v_mov_b32 v209, 0
    v_mov_b32 v210, 0
    v_mov_b32 v211, 0
    v_mov_b32 v212, 0
    v_mov_b32 v213, 0
    v_mov_b32 v214, 0
    v_mov_b32 v215, 0
    v_mov_b32 v216, 0
    v_mov_b32 v217, 0
    v_mov_b32 v218, 0
    v_mov_b32 v219, 0
    v_mov_b32 v220, 0
    v_mov_b32 v221, 0
    v_mov_b32 v222, 0
    v_mov_b32 v223, 0
    v_mov_b32 v224, 0
    v_mov_b32 v225, 0
    v_mov_b32 v226, 0
    v_mov_b32 v227, 0
    v_mov_b32 v228, 0
    v_mov_b32 v229, 0
    v_mov_b32 v230, 0
    v_mov_b32 v231, 0
    v_accvgpr_write_b32 a124, 0
    v_accvgpr_write_b32 a125, 0
    v_accvgpr_write_b32 a126, 0
    v_accvgpr_write_b32 a127, 0
    v_accvgpr_write_b32 a128, 0
    v_accvgpr_write_b32 a129, 0
    v_accvgpr_write_b32 a130, 0
    v_accvgpr_write_b32 a131, 0
    v_accvgpr_write_b32 a0, 0
    v_accvgpr_write_b32 a1, 0
    v_accvgpr_write_b32 a2, 0
    v_accvgpr_write_b32 a3, 0
    v_accvgpr_write_b32 a4, 0
    v_accvgpr_write_b32 a5, 0
    v_accvgpr_write_b32 a6, 0
    v_accvgpr_write_b32 a7, 0
    v_accvgpr_write_b32 a8, 0
    v_accvgpr_write_b32 a9, 0
    v_accvgpr_write_b32 a10, 0
    v_accvgpr_write_b32 a11, 0
    v_accvgpr_write_b32 a12, 0
    v_accvgpr_write_b32 a13, 0
    v_accvgpr_write_b32 a14, 0
    v_accvgpr_write_b32 a15, 0
    v_accvgpr_write_b32 a16, 0
    v_accvgpr_write_b32 a17, 0
    v_accvgpr_write_b32 a18, 0
    v_accvgpr_write_b32 a19, 0
    v_accvgpr_write_b32 a20, 0
    v_accvgpr_write_b32 a21, 0
    v_accvgpr_write_b32 a22, 0
    v_accvgpr_write_b32 a23, 0
    v_accvgpr_write_b32 a24, 0
    v_accvgpr_write_b32 a25, 0
    v_accvgpr_write_b32 a26, 0
    v_accvgpr_write_b32 a27, 0
    v_accvgpr_write_b32 a28, 0
    v_accvgpr_write_b32 a29, 0
    v_accvgpr_write_b32 a30, 0
    v_accvgpr_write_b32 a31, 0
    v_accvgpr_write_b32 a32, 0
    v_accvgpr_write_b32 a33, 0
    v_accvgpr_write_b32 a34, 0
    v_accvgpr_write_b32 a35, 0
    v_accvgpr_write_b32 a36, 0
    v_accvgpr_write_b32 a37, 0
    v_accvgpr_write_b32 a38, 0
    v_accvgpr_write_b32 a39, 0
    v_accvgpr_write_b32 a40, 0
    v_accvgpr_write_b32 a41, 0
    v_accvgpr_write_b32 a42, 0
    v_accvgpr_write_b32 a43, 0
    v_accvgpr_write_b32 a44, 0
    v_accvgpr_write_b32 a45, 0
    v_accvgpr_write_b32 a46, 0
    v_accvgpr_write_b32 a47, 0
    v_accvgpr_write_b32 a48, 0
    v_accvgpr_write_b32 a49, 0
    v_accvgpr_write_b32 a50, 0
    v_accvgpr_write_b32 a51, 0
    v_accvgpr_write_b32 a52, 0
    v_accvgpr_write_b32 a53, 0
    v_accvgpr_write_b32 a54, 0
    v_accvgpr_write_b32 a55, 0
    v_accvgpr_write_b32 a56, 0
    v_accvgpr_write_b32 a57, 0
    v_accvgpr_write_b32 a58, 0
    v_accvgpr_write_b32 a59, 0
    v_accvgpr_write_b32 a60, 0
    v_accvgpr_write_b32 a61, 0
    v_accvgpr_write_b32 a62, 0
    v_accvgpr_write_b32 a63, 0
    v_mov_b32 v32, 0x3f803f80
    v_accvgpr_write_b32 a112, v32
    v_accvgpr_write_b32 a113, v32
    v_accvgpr_write_b32 a114, v32
    v_accvgpr_write_b32 a115, v32
    s_waitcnt vmcnt(14)
    s_barrier
    ds_read_b64_tr_b16 a[64:65], v238 offset:0
    ds_read_b64_tr_b16 a[66:67], v238 offset:1024
    ds_read_b64_tr_b16 a[68:69], v238 offset:8
    ds_read_b64_tr_b16 a[70:71], v238 offset:1032
    ds_read_b64_tr_b16 a[72:73], v239 offset:0
    ds_read_b64_tr_b16 a[74:75], v239 offset:1024
    ds_read_b64_tr_b16 a[76:77], v239 offset:8
    ds_read_b64_tr_b16 a[78:79], v239 offset:1032
    ds_read_b64_tr_b16 a[80:81], v240 offset:0
    ds_read_b64_tr_b16 a[82:83], v240 offset:1024
    ds_read_b64_tr_b16 a[84:85], v240 offset:8
    ds_read_b64_tr_b16 a[86:87], v240 offset:1032
    ds_read_b64_tr_b16 a[88:89], v241 offset:0
    ds_read_b64_tr_b16 a[90:91], v241 offset:1024
    ds_read_b64_tr_b16 a[92:93], v241 offset:8
    ds_read_b64_tr_b16 a[94:95], v241 offset:1032
    ds_read_b64_tr_b16 a[96:97], v242 offset:0
    ds_read_b64_tr_b16 a[98:99], v242 offset:512
    ds_read_b64_tr_b16 a[100:101], v243 offset:0
    ds_read_b64_tr_b16 a[102:103], v243 offset:512
    ds_read_b64_tr_b16 a[104:105], v244 offset:0
    ds_read_b64_tr_b16 a[106:107], v244 offset:512
    ds_read_b64_tr_b16 a[108:109], v245 offset:0
    ds_read_b64_tr_b16 a[110:111], v245 offset:512
    ds_read_b128 v[0:3], v236 offset:0
    ds_read_b128 v[4:7], v236 offset:2048
    ds_read_b128 v[8:11], v236 offset:4096
    ds_read_b128 v[12:15], v236 offset:6144
    ds_read_b128 v[16:19], v237 offset:0
    ds_read_b128 v[20:23], v237 offset:2048
    ds_read_b128 v[24:27], v237 offset:4096
    ds_read_b128 v[28:31], v237 offset:6144
    s_waitcnt lgkmcnt(0)
    s_nop 0
    v_mfma_f32_16x16x32_bf16 v[64:67], a[64:67], v[0:3], v[64:67]
    v_mfma_f32_16x16x32_bf16 v[68:71], a[64:67], v[4:7], v[68:71]
    v_mfma_f32_16x16x32_bf16 v[72:75], a[64:67], v[8:11], v[72:75]
    v_mfma_f32_16x16x32_bf16 v[76:79], a[64:67], v[12:15], v[76:79]
    v_mfma_f32_16x16x32_bf16 v[224:227], a[64:67], a[112:115], v[224:227]
    ds_read_b64_tr_b16 a[64:65], v238 offset:12288
    v_mfma_f32_16x16x32_bf16 v[80:83], a[68:71], v[0:3], v[80:83]
    s_add_u32 m0, s38, 0x1c000
    s_mov_b32 s45, 0x100000
    ds_read_b64_tr_b16 a[66:67], v238 offset:13312
    v_mfma_f32_16x16x32_bf16 v[84:87], a[68:71], v[4:7], v[84:87]
    buffer_load_dwordx4 v248, s[20:23], s45 offen lds
    v_mfma_f32_16x16x32_bf16 v[88:91], a[68:71], v[8:11], v[88:91]
    v_mfma_f32_16x16x32_bf16 v[92:95], a[68:71], v[12:15], v[92:95]
    v_mfma_f32_16x16x32_bf16 v[228:231], a[68:71], a[112:115], v[228:231]
    ds_read_b64_tr_b16 a[68:69], v238 offset:12296
    v_mfma_f32_16x16x32_bf16 v[96:99], a[72:75], v[0:3], v[96:99]
    s_mov_b32 s46, 0x107c00
    ds_read_b64_tr_b16 a[70:71], v238 offset:13320
    v_mfma_f32_16x16x32_bf16 v[100:103], a[72:75], v[4:7], v[100:103]
    buffer_load_dwordx4 v248, s[20:23], s46 offen offset:1024 lds
    v_mfma_f32_16x16x32_bf16 v[104:107], a[72:75], v[8:11], v[104:107]
    v_mfma_f32_16x16x32_bf16 v[108:111], a[72:75], v[12:15], v[108:111]
    ds_read_b64_tr_b16 a[72:73], v239 offset:12288
    v_mfma_f32_16x16x32_bf16 v[112:115], a[76:79], v[0:3], v[112:115]
    ds_read_b64_tr_b16 a[74:75], v239 offset:13312
    v_mfma_f32_16x16x32_bf16 v[116:119], a[76:79], v[4:7], v[116:119]
    s_add_u32 m0, s37, 0x1e000
    s_mov_b32 s45, 0x70000
    v_mfma_f32_16x16x32_bf16 v[120:123], a[76:79], v[8:11], v[120:123]
    buffer_load_dwordx4 v249, s[24:27], s45 offen lds
    v_mfma_f32_16x16x32_bf16 v[124:127], a[76:79], v[12:15], v[124:127]
    ds_read_b64_tr_b16 a[76:77], v239 offset:12296
    v_mfma_f32_16x16x32_bf16 v[128:131], a[80:83], v[0:3], v[128:131]
    ds_read_b64_tr_b16 a[78:79], v239 offset:13320
    v_mfma_f32_16x16x32_bf16 v[132:135], a[80:83], v[4:7], v[132:135]
    v_mfma_f32_16x16x32_bf16 v[136:139], a[80:83], v[8:11], v[136:139]
    s_add_u32 m0, s49, 0x8000
    s_mov_b32 s45, 0x100
    v_mfma_f32_16x16x32_bf16 v[140:143], a[80:83], v[12:15], v[140:143]
    buffer_load_dwordx4 v246, s[16:19], s45 offen offset:0 lds
    ds_read_b64_tr_b16 a[80:81], v240 offset:12288
    v_mfma_f32_16x16x32_bf16 v[144:147], a[84:87], v[0:3], v[144:147]
    ds_read_b64_tr_b16 a[82:83], v240 offset:13312
    v_mfma_f32_16x16x32_bf16 v[148:151], a[84:87], v[4:7], v[148:151]
    v_mfma_f32_16x16x32_bf16 v[152:155], a[84:87], v[8:11], v[152:155]
    v_mfma_f32_16x16x32_bf16 v[156:159], a[84:87], v[12:15], v[156:159]
    s_mov_b32 s46, 0x1d00
    ds_read_b64_tr_b16 a[84:85], v240 offset:12296
    v_mfma_f32_16x16x32_bf16 v[160:163], a[88:91], v[0:3], v[160:163]
    buffer_load_dwordx4 v247, s[16:19], s46 offen offset:1024 lds
    ds_read_b64_tr_b16 a[86:87], v240 offset:13320
    v_mfma_f32_16x16x32_bf16 v[164:167], a[88:91], v[4:7], v[164:167]
    v_mfma_f32_16x16x32_bf16 v[168:171], a[88:91], v[8:11], v[168:171]
    v_mfma_f32_16x16x32_bf16 v[172:175], a[88:91], v[12:15], v[172:175]
    ds_read_b64_tr_b16 a[88:89], v241 offset:12288
    v_mfma_f32_16x16x32_bf16 v[176:179], a[92:95], v[0:3], v[176:179]
    s_mov_b32 s45, 0x3900
    ds_read_b64_tr_b16 a[90:91], v241 offset:13312
    v_mfma_f32_16x16x32_bf16 v[180:183], a[92:95], v[4:7], v[180:183]
    buffer_load_dwordx4 v246, s[16:19], s45 offen offset:2048 lds
    v_mfma_f32_16x16x32_bf16 v[184:187], a[92:95], v[8:11], v[184:187]
    v_mfma_f32_16x16x32_bf16 v[188:191], a[92:95], v[12:15], v[188:191]
    ds_read_b64_tr_b16 a[92:93], v241 offset:12296
    v_mfma_f32_16x16x32_bf16 a[0:3], a[96:99], v[0:3], a[0:3]
    ds_read_b64_tr_b16 a[94:95], v241 offset:13320
    v_mfma_f32_16x16x32_bf16 a[4:7], a[96:99], v[4:7], a[4:7]
    s_mov_b32 s46, 0x5500
    v_mfma_f32_16x16x32_bf16 a[8:11], a[96:99], v[8:11], a[8:11]
    buffer_load_dwordx4 v247, s[16:19], s46 offen offset:3072 lds
    v_mfma_f32_16x16x32_bf16 a[12:15], a[96:99], v[12:15], a[12:15]
    v_mfma_f32_16x16x32_bf16 a[124:127], a[96:99], a[112:115], a[124:127]
    ds_read_b64_tr_b16 a[96:97], v242 offset:12288
    v_mfma_f32_16x16x32_bf16 a[16:19], a[100:103], v[0:3], a[16:19]
    ds_read_b64_tr_b16 a[98:99], v242 offset:12800
    v_mfma_f32_16x16x32_bf16 a[20:23], a[100:103], v[4:7], a[20:23]
    v_mfma_f32_16x16x32_bf16 a[24:27], a[100:103], v[8:11], a[24:27]
    v_mfma_f32_16x16x32_bf16 a[28:31], a[100:103], v[12:15], a[28:31]
    v_mfma_f32_16x16x32_bf16 a[128:131], a[100:103], a[112:115], a[128:131]
    ds_read_b64_tr_b16 a[100:101], v243 offset:12288
    v_mfma_f32_16x16x32_bf16 a[32:35], a[104:107], v[0:3], a[32:35]
    ds_read_b64_tr_b16 a[102:103], v243 offset:12800
    v_mfma_f32_16x16x32_bf16 a[36:39], a[104:107], v[4:7], a[36:39]
    v_mfma_f32_16x16x32_bf16 a[40:43], a[104:107], v[8:11], a[40:43]
    v_mfma_f32_16x16x32_bf16 a[44:47], a[104:107], v[12:15], a[44:47]
    ds_read_b64_tr_b16 a[104:105], v244 offset:12288
    v_mfma_f32_16x16x32_bf16 a[48:51], a[108:111], v[0:3], a[48:51]
    ds_read_b64_tr_b16 a[106:107], v244 offset:12800
    v_mfma_f32_16x16x32_bf16 a[52:55], a[108:111], v[4:7], a[52:55]
    v_mfma_f32_16x16x32_bf16 a[56:59], a[108:111], v[8:11], a[56:59]
    v_mfma_f32_16x16x32_bf16 a[60:63], a[108:111], v[12:15], a[60:63]
    ds_read_b64_tr_b16 a[108:109], v245 offset:12288
    v_mfma_f32_16x16x32_bf16 v[192:195], a[112:115], v[0:3], v[192:195]
    ds_read_b64_tr_b16 a[110:111], v245 offset:12800
    v_mfma_f32_16x16x32_bf16 v[208:211], v[0:3], v[0:3], v[208:211]
    v_mfma_f32_16x16x32_bf16 v[196:199], a[112:115], v[4:7], v[196:199]
    v_mfma_f32_16x16x32_bf16 v[212:215], v[4:7], v[4:7], v[212:215]
    v_mfma_f32_16x16x32_bf16 v[200:203], a[112:115], v[8:11], v[200:203]
    v_mfma_f32_16x16x32_bf16 v[216:219], v[8:11], v[8:11], v[216:219]
    v_mfma_f32_16x16x32_bf16 v[204:207], a[112:115], v[12:15], v[204:207]
    v_mfma_f32_16x16x32_bf16 v[220:223], v[12:15], v[12:15], v[220:223]
    s_waitcnt vmcnt(10) lgkmcnt(0)
    s_barrier
    v_mfma_f32_16x16x32_bf16 v[64:67], a[64:67], v[16:19], v[64:67]
    v_mfma_f32_16x16x32_bf16 v[68:71], a[64:67], v[20:23], v[68:71]
    v_mfma_f32_16x16x32_bf16 v[72:75], a[64:67], v[24:27], v[72:75]
    ds_read_b128 v[32:35], v236 offset:49152
    v_mfma_f32_16x16x32_bf16 v[76:79], a[64:67], v[28:31], v[76:79]
    v_mfma_f32_16x16x32_bf16 v[224:227], a[64:67], a[112:115], v[224:227]
    ds_read_b64_tr_b16 a[64:65], v238 offset:24576
    v_mfma_f32_16x16x32_bf16 v[80:83], a[68:71], v[16:19], v[80:83]
    s_add_u32 m0, s38, 0x1f000
    s_mov_b32 s45, 0x140000
    ds_read_b64_tr_b16 a[66:67], v238 offset:25600
    ds_read_b128 v[36:39], v236 offset:51200
    v_mfma_f32_16x16x32_bf16 v[84:87], a[68:71], v[20:23], v[84:87]
    buffer_load_dwordx4 v248, s[20:23], s45 offen lds
    v_mfma_f32_16x16x32_bf16 v[88:91], a[68:71], v[24:27], v[88:91]
    v_mfma_f32_16x16x32_bf16 v[92:95], a[68:71], v[28:31], v[92:95]
    ds_read_b128 v[40:43], v236 offset:53248
    v_mfma_f32_16x16x32_bf16 v[228:231], a[68:71], a[112:115], v[228:231]
    ds_read_b64_tr_b16 a[68:69], v238 offset:24584
    v_mfma_f32_16x16x32_bf16 v[96:99], a[72:75], v[16:19], v[96:99]
    s_mov_b32 s46, 0x147c00
    ds_read_b64_tr_b16 a[70:71], v238 offset:25608
    v_mfma_f32_16x16x32_bf16 v[100:103], a[72:75], v[20:23], v[100:103]
    buffer_load_dwordx4 v248, s[20:23], s46 offen offset:1024 lds
    ds_read_b128 v[44:47], v236 offset:55296
    v_mfma_f32_16x16x32_bf16 v[104:107], a[72:75], v[24:27], v[104:107]
    v_mfma_f32_16x16x32_bf16 v[108:111], a[72:75], v[28:31], v[108:111]
    ds_read_b64_tr_b16 a[72:73], v239 offset:24576
    v_mfma_f32_16x16x32_bf16 v[112:115], a[76:79], v[16:19], v[112:115]
    ds_read_b64_tr_b16 a[74:75], v239 offset:25600
    ds_read_b128 v[48:51], v237 offset:49152
    v_mfma_f32_16x16x32_bf16 v[116:119], a[76:79], v[20:23], v[116:119]
    s_add_u32 m0, s37, 0x21000
    s_mov_b32 s45, 0x8c000
    v_mfma_f32_16x16x32_bf16 v[120:123], a[76:79], v[24:27], v[120:123]
    buffer_load_dwordx4 v249, s[24:27], s45 offen lds
    v_mfma_f32_16x16x32_bf16 v[124:127], a[76:79], v[28:31], v[124:127]
    ds_read_b64_tr_b16 a[76:77], v239 offset:24584
    ds_read_b128 v[52:55], v237 offset:51200
    v_mfma_f32_16x16x32_bf16 v[128:131], a[80:83], v[16:19], v[128:131]
    ds_read_b64_tr_b16 a[78:79], v239 offset:25608
    v_mfma_f32_16x16x32_bf16 v[132:135], a[80:83], v[20:23], v[132:135]
    v_mfma_f32_16x16x32_bf16 v[136:139], a[80:83], v[24:27], v[136:139]
    s_add_u32 m0, s49, 0x9000
    s_mov_b32 s45, 0x8100
    ds_read_b128 v[56:59], v237 offset:53248
    v_mfma_f32_16x16x32_bf16 v[140:143], a[80:83], v[28:31], v[140:143]
    buffer_load_dwordx4 v246, s[16:19], s45 offen offset:0 lds
    ds_read_b64_tr_b16 a[80:81], v240 offset:24576
    v_mfma_f32_16x16x32_bf16 v[144:147], a[84:87], v[16:19], v[144:147]
    ds_read_b64_tr_b16 a[82:83], v240 offset:25600
    v_mfma_f32_16x16x32_bf16 v[148:151], a[84:87], v[20:23], v[148:151]
    ds_read_b128 v[60:63], v237 offset:55296
    v_mfma_f32_16x16x32_bf16 v[152:155], a[84:87], v[24:27], v[152:155]
    v_mfma_f32_16x16x32_bf16 v[156:159], a[84:87], v[28:31], v[156:159]
    s_mov_b32 s46, 0x9d00
    ds_read_b64_tr_b16 a[84:85], v240 offset:24584
    v_mfma_f32_16x16x32_bf16 v[160:163], a[88:91], v[16:19], v[160:163]
    buffer_load_dwordx4 v247, s[16:19], s46 offen offset:1024 lds
    ds_read_b64_tr_b16 a[86:87], v240 offset:25608
    v_mfma_f32_16x16x32_bf16 v[164:167], a[88:91], v[20:23], v[164:167]
    v_mfma_f32_16x16x32_bf16 v[168:171], a[88:91], v[24:27], v[168:171]
    v_mfma_f32_16x16x32_bf16 v[172:175], a[88:91], v[28:31], v[172:175]
    ds_read_b64_tr_b16 a[88:89], v241 offset:24576
    v_mfma_f32_16x16x32_bf16 v[176:179], a[92:95], v[16:19], v[176:179]
    s_mov_b32 s45, 0xb900
    ds_read_b64_tr_b16 a[90:91], v241 offset:25600
    v_mfma_f32_16x16x32_bf16 v[180:183], a[92:95], v[20:23], v[180:183]
    buffer_load_dwordx4 v246, s[16:19], s45 offen offset:2048 lds
    v_mfma_f32_16x16x32_bf16 v[184:187], a[92:95], v[24:27], v[184:187]
    v_mfma_f32_16x16x32_bf16 v[188:191], a[92:95], v[28:31], v[188:191]
    ds_read_b64_tr_b16 a[92:93], v241 offset:24584
    v_mfma_f32_16x16x32_bf16 a[0:3], a[96:99], v[16:19], a[0:3]
    ds_read_b64_tr_b16 a[94:95], v241 offset:25608
    v_mfma_f32_16x16x32_bf16 a[4:7], a[96:99], v[20:23], a[4:7]
    s_mov_b32 s46, 0xd500
    v_mfma_f32_16x16x32_bf16 a[8:11], a[96:99], v[24:27], a[8:11]
    buffer_load_dwordx4 v247, s[16:19], s46 offen offset:3072 lds
    v_mfma_f32_16x16x32_bf16 a[12:15], a[96:99], v[28:31], a[12:15]
    v_mfma_f32_16x16x32_bf16 a[124:127], a[96:99], a[112:115], a[124:127]
    ds_read_b64_tr_b16 a[96:97], v242 offset:24576
    v_mfma_f32_16x16x32_bf16 a[16:19], a[100:103], v[16:19], a[16:19]
    ds_read_b64_tr_b16 a[98:99], v242 offset:25088
    v_mfma_f32_16x16x32_bf16 a[20:23], a[100:103], v[20:23], a[20:23]
    v_mfma_f32_16x16x32_bf16 a[24:27], a[100:103], v[24:27], a[24:27]
    v_mfma_f32_16x16x32_bf16 a[28:31], a[100:103], v[28:31], a[28:31]
    v_mfma_f32_16x16x32_bf16 a[128:131], a[100:103], a[112:115], a[128:131]
    ds_read_b64_tr_b16 a[100:101], v243 offset:24576
    v_mfma_f32_16x16x32_bf16 a[32:35], a[104:107], v[16:19], a[32:35]
    ds_read_b64_tr_b16 a[102:103], v243 offset:25088
    v_mfma_f32_16x16x32_bf16 a[36:39], a[104:107], v[20:23], a[36:39]
    v_mfma_f32_16x16x32_bf16 a[40:43], a[104:107], v[24:27], a[40:43]
    v_mfma_f32_16x16x32_bf16 a[44:47], a[104:107], v[28:31], a[44:47]
    ds_read_b64_tr_b16 a[104:105], v244 offset:24576
    v_mfma_f32_16x16x32_bf16 a[48:51], a[108:111], v[16:19], a[48:51]
    ds_read_b64_tr_b16 a[106:107], v244 offset:25088
    v_mfma_f32_16x16x32_bf16 a[52:55], a[108:111], v[20:23], a[52:55]
    v_mfma_f32_16x16x32_bf16 a[56:59], a[108:111], v[24:27], a[56:59]
    v_mfma_f32_16x16x32_bf16 a[60:63], a[108:111], v[28:31], a[60:63]
    ds_read_b64_tr_b16 a[108:109], v245 offset:24576
    v_mfma_f32_16x16x32_bf16 v[192:195], a[112:115], v[16:19], v[192:195]
    ds_read_b64_tr_b16 a[110:111], v245 offset:25088
    v_mfma_f32_16x16x32_bf16 v[208:211], v[16:19], v[16:19], v[208:211]
    v_mfma_f32_16x16x32_bf16 v[196:199], a[112:115], v[20:23], v[196:199]
    v_mfma_f32_16x16x32_bf16 v[212:215], v[20:23], v[20:23], v[212:215]
    v_mfma_f32_16x16x32_bf16 v[200:203], a[112:115], v[24:27], v[200:203]
    v_mfma_f32_16x16x32_bf16 v[216:219], v[24:27], v[24:27], v[216:219]
    v_mfma_f32_16x16x32_bf16 v[204:207], a[112:115], v[28:31], v[204:207]
    v_mfma_f32_16x16x32_bf16 v[220:223], v[28:31], v[28:31], v[220:223]
    s_waitcnt vmcnt(14) lgkmcnt(0)
    s_barrier
    v_mfma_f32_16x16x32_bf16 v[64:67], a[64:67], v[32:35], v[64:67]
    v_mfma_f32_16x16x32_bf16 v[68:71], a[64:67], v[36:39], v[68:71]
    v_mfma_f32_16x16x32_bf16 v[72:75], a[64:67], v[40:43], v[72:75]
    v_mfma_f32_16x16x32_bf16 v[76:79], a[64:67], v[44:47], v[76:79]
    v_mfma_f32_16x16x32_bf16 v[224:227], a[64:67], a[112:115], v[224:227]
    ds_read_b64_tr_b16 a[64:65], v238 offset:36864
    v_mfma_f32_16x16x32_bf16 v[80:83], a[68:71], v[32:35], v[80:83]
    s_add_u32 m0, s38, 0x22000
    s_mov_b32 s45, 0x180000
    ds_read_b64_tr_b16 a[66:67], v238 offset:37888
    v_mfma_f32_16x16x32_bf16 v[84:87], a[68:71], v[36:39], v[84:87]
    buffer_load_dwordx4 v248, s[20:23], s45 offen lds
    v_mfma_f32_16x16x32_bf16 v[88:91], a[68:71], v[40:43], v[88:91]
    v_mfma_f32_16x16x32_bf16 v[92:95], a[68:71], v[44:47], v[92:95]
    v_mfma_f32_16x16x32_bf16 v[228:231], a[68:71], a[112:115], v[228:231]
    ds_read_b64_tr_b16 a[68:69], v238 offset:36872
    v_mfma_f32_16x16x32_bf16 v[96:99], a[72:75], v[32:35], v[96:99]
    s_mov_b32 s46, 0x187c00
    ds_read_b64_tr_b16 a[70:71], v238 offset:37896
    v_mfma_f32_16x16x32_bf16 v[100:103], a[72:75], v[36:39], v[100:103]
    buffer_load_dwordx4 v248, s[20:23], s46 offen offset:1024 lds
    v_mfma_f32_16x16x32_bf16 v[104:107], a[72:75], v[40:43], v[104:107]
    v_mfma_f32_16x16x32_bf16 v[108:111], a[72:75], v[44:47], v[108:111]
    ds_read_b64_tr_b16 a[72:73], v239 offset:36864
    v_mfma_f32_16x16x32_bf16 v[112:115], a[76:79], v[32:35], v[112:115]
    ds_read_b64_tr_b16 a[74:75], v239 offset:37888
    v_mfma_f32_16x16x32_bf16 v[116:119], a[76:79], v[36:39], v[116:119]
    s_add_u32 m0, s37, 0x24000
    s_mov_b32 s45, 0xa8000
    v_mfma_f32_16x16x32_bf16 v[120:123], a[76:79], v[40:43], v[120:123]
    buffer_load_dwordx4 v249, s[24:27], s45 offen lds
    v_mfma_f32_16x16x32_bf16 v[124:127], a[76:79], v[44:47], v[124:127]
    ds_read_b64_tr_b16 a[76:77], v239 offset:36872
    v_mfma_f32_16x16x32_bf16 v[128:131], a[80:83], v[32:35], v[128:131]
    ds_read_b64_tr_b16 a[78:79], v239 offset:37896
    v_mfma_f32_16x16x32_bf16 v[132:135], a[80:83], v[36:39], v[132:135]
    v_mfma_f32_16x16x32_bf16 v[136:139], a[80:83], v[40:43], v[136:139]
    s_add_u32 m0, s49, 0x14000
    s_mov_b32 s45, 0x180
    v_mfma_f32_16x16x32_bf16 v[140:143], a[80:83], v[44:47], v[140:143]
    buffer_load_dwordx4 v246, s[16:19], s45 offen offset:0 lds
    ds_read_b64_tr_b16 a[80:81], v240 offset:36864
    v_mfma_f32_16x16x32_bf16 v[144:147], a[84:87], v[32:35], v[144:147]
    ds_read_b64_tr_b16 a[82:83], v240 offset:37888
    v_mfma_f32_16x16x32_bf16 v[148:151], a[84:87], v[36:39], v[148:151]
    v_mfma_f32_16x16x32_bf16 v[152:155], a[84:87], v[40:43], v[152:155]
    v_mfma_f32_16x16x32_bf16 v[156:159], a[84:87], v[44:47], v[156:159]
    s_mov_b32 s46, 0x1d80
    ds_read_b64_tr_b16 a[84:85], v240 offset:36872
    v_mfma_f32_16x16x32_bf16 v[160:163], a[88:91], v[32:35], v[160:163]
    buffer_load_dwordx4 v247, s[16:19], s46 offen offset:1024 lds
    ds_read_b64_tr_b16 a[86:87], v240 offset:37896
    v_mfma_f32_16x16x32_bf16 v[164:167], a[88:91], v[36:39], v[164:167]
    v_mfma_f32_16x16x32_bf16 v[168:171], a[88:91], v[40:43], v[168:171]
    v_mfma_f32_16x16x32_bf16 v[172:175], a[88:91], v[44:47], v[172:175]
    ds_read_b64_tr_b16 a[88:89], v241 offset:36864
    v_mfma_f32_16x16x32_bf16 v[176:179], a[92:95], v[32:35], v[176:179]
    s_mov_b32 s45, 0x3980
    ds_read_b64_tr_b16 a[90:91], v241 offset:37888
    v_mfma_f32_16x16x32_bf16 v[180:183], a[92:95], v[36:39], v[180:183]
    buffer_load_dwordx4 v246, s[16:19], s45 offen offset:2048 lds
    v_mfma_f32_16x16x32_bf16 v[184:187], a[92:95], v[40:43], v[184:187]
    v_mfma_f32_16x16x32_bf16 v[188:191], a[92:95], v[44:47], v[188:191]
    ds_read_b64_tr_b16 a[92:93], v241 offset:36872
    v_mfma_f32_16x16x32_bf16 a[0:3], a[96:99], v[32:35], a[0:3]
    ds_read_b64_tr_b16 a[94:95], v241 offset:37896
    v_mfma_f32_16x16x32_bf16 a[4:7], a[96:99], v[36:39], a[4:7]
    s_mov_b32 s46, 0x5580
    v_mfma_f32_16x16x32_bf16 a[8:11], a[96:99], v[40:43], a[8:11]
    buffer_load_dwordx4 v247, s[16:19], s46 offen offset:3072 lds
    v_mfma_f32_16x16x32_bf16 a[12:15], a[96:99], v[44:47], a[12:15]
    v_mfma_f32_16x16x32_bf16 a[124:127], a[96:99], a[112:115], a[124:127]
    ds_read_b64_tr_b16 a[96:97], v242 offset:36864
    v_mfma_f32_16x16x32_bf16 a[16:19], a[100:103], v[32:35], a[16:19]
    ds_read_b64_tr_b16 a[98:99], v242 offset:37376
    v_mfma_f32_16x16x32_bf16 a[20:23], a[100:103], v[36:39], a[20:23]
    v_mfma_f32_16x16x32_bf16 a[24:27], a[100:103], v[40:43], a[24:27]
    v_mfma_f32_16x16x32_bf16 a[28:31], a[100:103], v[44:47], a[28:31]
    v_mfma_f32_16x16x32_bf16 a[128:131], a[100:103], a[112:115], a[128:131]
    ds_read_b64_tr_b16 a[100:101], v243 offset:36864
    v_mfma_f32_16x16x32_bf16 a[32:35], a[104:107], v[32:35], a[32:35]
    ds_read_b64_tr_b16 a[102:103], v243 offset:37376
    v_mfma_f32_16x16x32_bf16 a[36:39], a[104:107], v[36:39], a[36:39]
    v_mfma_f32_16x16x32_bf16 a[40:43], a[104:107], v[40:43], a[40:43]
    v_mfma_f32_16x16x32_bf16 a[44:47], a[104:107], v[44:47], a[44:47]
    ds_read_b64_tr_b16 a[104:105], v244 offset:36864
    v_mfma_f32_16x16x32_bf16 a[48:51], a[108:111], v[32:35], a[48:51]
    ds_read_b64_tr_b16 a[106:107], v244 offset:37376
    v_mfma_f32_16x16x32_bf16 a[52:55], a[108:111], v[36:39], a[52:55]
    v_mfma_f32_16x16x32_bf16 a[56:59], a[108:111], v[40:43], a[56:59]
    v_mfma_f32_16x16x32_bf16 a[60:63], a[108:111], v[44:47], a[60:63]
    ds_read_b64_tr_b16 a[108:109], v245 offset:36864
    v_mfma_f32_16x16x32_bf16 v[192:195], a[112:115], v[32:35], v[192:195]
    ds_read_b64_tr_b16 a[110:111], v245 offset:37376
    v_mfma_f32_16x16x32_bf16 v[208:211], v[32:35], v[32:35], v[208:211]
    v_mfma_f32_16x16x32_bf16 v[196:199], a[112:115], v[36:39], v[196:199]
    v_mfma_f32_16x16x32_bf16 v[212:215], v[36:39], v[36:39], v[212:215]
    v_mfma_f32_16x16x32_bf16 v[200:203], a[112:115], v[40:43], v[200:203]
    v_mfma_f32_16x16x32_bf16 v[216:219], v[40:43], v[40:43], v[216:219]
    v_mfma_f32_16x16x32_bf16 v[204:207], a[112:115], v[44:47], v[204:207]
    v_mfma_f32_16x16x32_bf16 v[220:223], v[44:47], v[44:47], v[220:223]
    s_waitcnt vmcnt(7) lgkmcnt(0)
    s_barrier
    v_mfma_f32_16x16x32_bf16 v[64:67], a[64:67], v[48:51], v[64:67]
    v_mfma_f32_16x16x32_bf16 v[68:71], a[64:67], v[52:55], v[68:71]
    v_mfma_f32_16x16x32_bf16 v[72:75], a[64:67], v[56:59], v[72:75]
    ds_read_b128 v[0:3], v236 offset:0
    v_mfma_f32_16x16x32_bf16 v[76:79], a[64:67], v[60:63], v[76:79]
    v_mfma_f32_16x16x32_bf16 v[224:227], a[64:67], a[112:115], v[224:227]
    ds_read_b64_tr_b16 a[64:65], v238 offset:0
    v_mfma_f32_16x16x32_bf16 v[80:83], a[68:71], v[48:51], v[80:83]
    s_add_u32 m0, s38, 0x25000
    s_mov_b32 s45, 0x1c0000
    ds_read_b64_tr_b16 a[66:67], v238 offset:1024
    ds_read_b128 v[4:7], v236 offset:2048
    v_mfma_f32_16x16x32_bf16 v[84:87], a[68:71], v[52:55], v[84:87]
    buffer_load_dwordx4 v248, s[20:23], s45 offen lds
    v_mfma_f32_16x16x32_bf16 v[88:91], a[68:71], v[56:59], v[88:91]
    v_mfma_f32_16x16x32_bf16 v[92:95], a[68:71], v[60:63], v[92:95]
    ds_read_b128 v[8:11], v236 offset:4096
    v_mfma_f32_16x16x32_bf16 v[228:231], a[68:71], a[112:115], v[228:231]
    ds_read_b64_tr_b16 a[68:69], v238 offset:8
    v_mfma_f32_16x16x32_bf16 v[96:99], a[72:75], v[48:51], v[96:99]
    s_mov_b32 s46, 0x1c7c00
    ds_read_b64_tr_b16 a[70:71], v238 offset:1032
    v_mfma_f32_16x16x32_bf16 v[100:103], a[72:75], v[52:55], v[100:103]
    buffer_load_dwordx4 v248, s[20:23], s46 offen offset:1024 lds
    ds_read_b128 v[12:15], v236 offset:6144
    v_mfma_f32_16x16x32_bf16 v[104:107], a[72:75], v[56:59], v[104:107]
    v_mfma_f32_16x16x32_bf16 v[108:111], a[72:75], v[60:63], v[108:111]
    ds_read_b64_tr_b16 a[72:73], v239 offset:0
    v_mfma_f32_16x16x32_bf16 v[112:115], a[76:79], v[48:51], v[112:115]
    ds_read_b64_tr_b16 a[74:75], v239 offset:1024
    ds_read_b128 v[16:19], v237 offset:0
    v_mfma_f32_16x16x32_bf16 v[116:119], a[76:79], v[52:55], v[116:119]
    s_add_u32 m0, s37, 0x27000
    s_mov_b32 s45, 0xc4000
    v_mfma_f32_16x16x32_bf16 v[120:123], a[76:79], v[56:59], v[120:123]
    buffer_load_dwordx4 v249, s[24:27], s45 offen lds
    v_mfma_f32_16x16x32_bf16 v[124:127], a[76:79], v[60:63], v[124:127]
    ds_read_b64_tr_b16 a[76:77], v239 offset:8
    ds_read_b128 v[20:23], v237 offset:2048
    v_mfma_f32_16x16x32_bf16 v[128:131], a[80:83], v[48:51], v[128:131]
    ds_read_b64_tr_b16 a[78:79], v239 offset:1032
    v_mfma_f32_16x16x32_bf16 v[132:135], a[80:83], v[52:55], v[132:135]
    v_mfma_f32_16x16x32_bf16 v[136:139], a[80:83], v[56:59], v[136:139]
    s_add_u32 m0, s49, 0x15000
    s_mov_b32 s45, 0x8180
    ds_read_b128 v[24:27], v237 offset:4096
    v_mfma_f32_16x16x32_bf16 v[140:143], a[80:83], v[60:63], v[140:143]
    buffer_load_dwordx4 v246, s[16:19], s45 offen offset:0 lds
    ds_read_b64_tr_b16 a[80:81], v240 offset:0
    v_mfma_f32_16x16x32_bf16 v[144:147], a[84:87], v[48:51], v[144:147]
    ds_read_b64_tr_b16 a[82:83], v240 offset:1024
    v_mfma_f32_16x16x32_bf16 v[148:151], a[84:87], v[52:55], v[148:151]
    ds_read_b128 v[28:31], v237 offset:6144
    v_mfma_f32_16x16x32_bf16 v[152:155], a[84:87], v[56:59], v[152:155]
    v_mfma_f32_16x16x32_bf16 v[156:159], a[84:87], v[60:63], v[156:159]
    s_mov_b32 s46, 0x9d80
    ds_read_b64_tr_b16 a[84:85], v240 offset:8
    v_mfma_f32_16x16x32_bf16 v[160:163], a[88:91], v[48:51], v[160:163]
    buffer_load_dwordx4 v247, s[16:19], s46 offen offset:1024 lds
    ds_read_b64_tr_b16 a[86:87], v240 offset:1032
    v_mfma_f32_16x16x32_bf16 v[164:167], a[88:91], v[52:55], v[164:167]
    v_mfma_f32_16x16x32_bf16 v[168:171], a[88:91], v[56:59], v[168:171]
    v_mfma_f32_16x16x32_bf16 v[172:175], a[88:91], v[60:63], v[172:175]
    ds_read_b64_tr_b16 a[88:89], v241 offset:0
    v_mfma_f32_16x16x32_bf16 v[176:179], a[92:95], v[48:51], v[176:179]
    s_mov_b32 s45, 0xb980
    ds_read_b64_tr_b16 a[90:91], v241 offset:1024
    v_mfma_f32_16x16x32_bf16 v[180:183], a[92:95], v[52:55], v[180:183]
    buffer_load_dwordx4 v246, s[16:19], s45 offen offset:2048 lds
    v_mfma_f32_16x16x32_bf16 v[184:187], a[92:95], v[56:59], v[184:187]
    v_mfma_f32_16x16x32_bf16 v[188:191], a[92:95], v[60:63], v[188:191]
    ds_read_b64_tr_b16 a[92:93], v241 offset:8
    v_mfma_f32_16x16x32_bf16 a[0:3], a[96:99], v[48:51], a[0:3]
    ds_read_b64_tr_b16 a[94:95], v241 offset:1032
    v_mfma_f32_16x16x32_bf16 a[4:7], a[96:99], v[52:55], a[4:7]
    s_mov_b32 s46, 0xd580
    v_mfma_f32_16x16x32_bf16 a[8:11], a[96:99], v[56:59], a[8:11]
    buffer_load_dwordx4 v247, s[16:19], s46 offen offset:3072 lds
    v_mfma_f32_16x16x32_bf16 a[12:15], a[96:99], v[60:63], a[12:15]
    v_mfma_f32_16x16x32_bf16 a[124:127], a[96:99], a[112:115], a[124:127]
    ds_read_b64_tr_b16 a[96:97], v242 offset:0
    v_mfma_f32_16x16x32_bf16 a[16:19], a[100:103], v[48:51], a[16:19]
    ds_read_b64_tr_b16 a[98:99], v242 offset:512
    v_mfma_f32_16x16x32_bf16 a[20:23], a[100:103], v[52:55], a[20:23]
    v_mfma_f32_16x16x32_bf16 a[24:27], a[100:103], v[56:59], a[24:27]
    v_mfma_f32_16x16x32_bf16 a[28:31], a[100:103], v[60:63], a[28:31]
    v_mfma_f32_16x16x32_bf16 a[128:131], a[100:103], a[112:115], a[128:131]
    ds_read_b64_tr_b16 a[100:101], v243 offset:0
    v_mfma_f32_16x16x32_bf16 a[32:35], a[104:107], v[48:51], a[32:35]
    ds_read_b64_tr_b16 a[102:103], v243 offset:512
    v_mfma_f32_16x16x32_bf16 a[36:39], a[104:107], v[52:55], a[36:39]
    v_mfma_f32_16x16x32_bf16 a[40:43], a[104:107], v[56:59], a[40:43]
    v_mfma_f32_16x16x32_bf16 a[44:47], a[104:107], v[60:63], a[44:47]
    ds_read_b64_tr_b16 a[104:105], v244 offset:0
    v_mfma_f32_16x16x32_bf16 a[48:51], a[108:111], v[48:51], a[48:51]
    ds_read_b64_tr_b16 a[106:107], v244 offset:512
    v_mfma_f32_16x16x32_bf16 a[52:55], a[108:111], v[52:55], a[52:55]
    v_mfma_f32_16x16x32_bf16 a[56:59], a[108:111], v[56:59], a[56:59]
    v_mfma_f32_16x16x32_bf16 a[60:63], a[108:111], v[60:63], a[60:63]
    ds_read_b64_tr_b16 a[108:109], v245 offset:0
    v_mfma_f32_16x16x32_bf16 v[192:195], a[112:115], v[48:51], v[192:195]
    ds_read_b64_tr_b16 a[110:111], v245 offset:512
    v_mfma_f32_16x16x32_bf16 v[208:211], v[48:51], v[48:51], v[208:211]
    v_mfma_f32_16x16x32_bf16 v[196:199], a[112:115], v[52:55], v[196:199]
    v_mfma_f32_16x16x32_bf16 v[212:215], v[52:55], v[52:55], v[212:215]
    v_mfma_f32_16x16x32_bf16 v[200:203], a[112:115], v[56:59], v[200:203]
    v_mfma_f32_16x16x32_bf16 v[216:219], v[56:59], v[56:59], v[216:219]
    v_mfma_f32_16x16x32_bf16 v[204:207], a[112:115], v[60:63], v[204:207]
    v_mfma_f32_16x16x32_bf16 v[220:223], v[60:63], v[60:63], v[220:223]
    s_waitcnt vmcnt(18) lgkmcnt(0)
    s_barrier
    v_mfma_f32_16x16x32_bf16 v[64:67], a[64:67], v[0:3], v[64:67]
    v_mfma_f32_16x16x32_bf16 v[68:71], a[64:67], v[4:7], v[68:71]
    v_mfma_f32_16x16x32_bf16 v[72:75], a[64:67], v[8:11], v[72:75]
    v_mfma_f32_16x16x32_bf16 v[76:79], a[64:67], v[12:15], v[76:79]
    v_mfma_f32_16x16x32_bf16 v[224:227], a[64:67], a[112:115], v[224:227]
    ds_read_b64_tr_b16 a[64:65], v238 offset:12288
    v_mfma_f32_16x16x32_bf16 v[80:83], a[68:71], v[0:3], v[80:83]
    s_add_u32 m0, s38, 0x1c000
    s_mov_b32 s45, 0x200000
    ds_read_b64_tr_b16 a[66:67], v238 offset:13312
    v_mfma_f32_16x16x32_bf16 v[84:87], a[68:71], v[4:7], v[84:87]
    buffer_load_dwordx4 v248, s[20:23], s45 offen lds
    v_mfma_f32_16x16x32_bf16 v[88:91], a[68:71], v[8:11], v[88:91]
    v_mfma_f32_16x16x32_bf16 v[92:95], a[68:71], v[12:15], v[92:95]
    v_mfma_f32_16x16x32_bf16 v[228:231], a[68:71], a[112:115], v[228:231]
    ds_read_b64_tr_b16 a[68:69], v238 offset:12296
    v_mfma_f32_16x16x32_bf16 v[96:99], a[72:75], v[0:3], v[96:99]
    s_mov_b32 s46, 0x207c00
    ds_read_b64_tr_b16 a[70:71], v238 offset:13320
    v_mfma_f32_16x16x32_bf16 v[100:103], a[72:75], v[4:7], v[100:103]
    buffer_load_dwordx4 v248, s[20:23], s46 offen offset:1024 lds
    v_mfma_f32_16x16x32_bf16 v[104:107], a[72:75], v[8:11], v[104:107]
    v_mfma_f32_16x16x32_bf16 v[108:111], a[72:75], v[12:15], v[108:111]
    ds_read_b64_tr_b16 a[72:73], v239 offset:12288
    v_mfma_f32_16x16x32_bf16 v[112:115], a[76:79], v[0:3], v[112:115]
    ds_read_b64_tr_b16 a[74:75], v239 offset:13312
    v_mfma_f32_16x16x32_bf16 v[116:119], a[76:79], v[4:7], v[116:119]
    s_add_u32 m0, s37, 0x1e000
    s_mov_b32 s45, 0xe0000
    v_mfma_f32_16x16x32_bf16 v[120:123], a[76:79], v[8:11], v[120:123]
    buffer_load_dwordx4 v249, s[24:27], s45 offen lds
    v_mfma_f32_16x16x32_bf16 v[124:127], a[76:79], v[12:15], v[124:127]
    ds_read_b64_tr_b16 a[76:77], v239 offset:12296
    v_mfma_f32_16x16x32_bf16 v[128:131], a[80:83], v[0:3], v[128:131]
    ds_read_b64_tr_b16 a[78:79], v239 offset:13320
    v_mfma_f32_16x16x32_bf16 v[132:135], a[80:83], v[4:7], v[132:135]
    v_mfma_f32_16x16x32_bf16 v[136:139], a[80:83], v[8:11], v[136:139]
    s_add_u32 m0, s49, 0x8000
    s_mov_b32 s45, 0x200
    v_mfma_f32_16x16x32_bf16 v[140:143], a[80:83], v[12:15], v[140:143]
    buffer_load_dwordx4 v246, s[16:19], s45 offen offset:0 lds
    ds_read_b64_tr_b16 a[80:81], v240 offset:12288
    v_mfma_f32_16x16x32_bf16 v[144:147], a[84:87], v[0:3], v[144:147]
    ds_read_b64_tr_b16 a[82:83], v240 offset:13312
    v_mfma_f32_16x16x32_bf16 v[148:151], a[84:87], v[4:7], v[148:151]
    v_mfma_f32_16x16x32_bf16 v[152:155], a[84:87], v[8:11], v[152:155]
    v_mfma_f32_16x16x32_bf16 v[156:159], a[84:87], v[12:15], v[156:159]
    s_mov_b32 s46, 0x1e00
    ds_read_b64_tr_b16 a[84:85], v240 offset:12296
    v_mfma_f32_16x16x32_bf16 v[160:163], a[88:91], v[0:3], v[160:163]
    buffer_load_dwordx4 v247, s[16:19], s46 offen offset:1024 lds
    ds_read_b64_tr_b16 a[86:87], v240 offset:13320
    v_mfma_f32_16x16x32_bf16 v[164:167], a[88:91], v[4:7], v[164:167]
    v_mfma_f32_16x16x32_bf16 v[168:171], a[88:91], v[8:11], v[168:171]
    v_mfma_f32_16x16x32_bf16 v[172:175], a[88:91], v[12:15], v[172:175]
    ds_read_b64_tr_b16 a[88:89], v241 offset:12288
    v_mfma_f32_16x16x32_bf16 v[176:179], a[92:95], v[0:3], v[176:179]
    s_mov_b32 s45, 0x3a00
    ds_read_b64_tr_b16 a[90:91], v241 offset:13312
    v_mfma_f32_16x16x32_bf16 v[180:183], a[92:95], v[4:7], v[180:183]
    buffer_load_dwordx4 v246, s[16:19], s45 offen offset:2048 lds
    v_mfma_f32_16x16x32_bf16 v[184:187], a[92:95], v[8:11], v[184:187]
    v_mfma_f32_16x16x32_bf16 v[188:191], a[92:95], v[12:15], v[188:191]
    ds_read_b64_tr_b16 a[92:93], v241 offset:12296
    v_mfma_f32_16x16x32_bf16 a[0:3], a[96:99], v[0:3], a[0:3]
    ds_read_b64_tr_b16 a[94:95], v241 offset:13320
    v_mfma_f32_16x16x32_bf16 a[4:7], a[96:99], v[4:7], a[4:7]
    s_mov_b32 s46, 0x5600
    v_mfma_f32_16x16x32_bf16 a[8:11], a[96:99], v[8:11], a[8:11]
    buffer_load_dwordx4 v247, s[16:19], s46 offen offset:3072 lds
    v_mfma_f32_16x16x32_bf16 a[12:15], a[96:99], v[12:15], a[12:15]
    v_mfma_f32_16x16x32_bf16 a[124:127], a[96:99], a[112:115], a[124:127]
    ds_read_b64_tr_b16 a[96:97], v242 offset:12288
    v_mfma_f32_16x16x32_bf16 a[16:19], a[100:103], v[0:3], a[16:19]
    ds_read_b64_tr_b16 a[98:99], v242 offset:12800
    v_mfma_f32_16x16x32_bf16 a[20:23], a[100:103], v[4:7], a[20:23]
    v_mfma_f32_16x16x32_bf16 a[24:27], a[100:103], v[8:11], a[24:27]
    v_mfma_f32_16x16x32_bf16 a[28:31], a[100:103], v[12:15], a[28:31]
    v_mfma_f32_16x16x32_bf16 a[128:131], a[100:103], a[112:115], a[128:131]
    ds_read_b64_tr_b16 a[100:101], v243 offset:12288
    v_mfma_f32_16x16x32_bf16 a[32:35], a[104:107], v[0:3], a[32:35]
    ds_read_b64_tr_b16 a[102:103], v243 offset:12800
    v_mfma_f32_16x16x32_bf16 a[36:39], a[104:107], v[4:7], a[36:39]
    v_mfma_f32_16x16x32_bf16 a[40:43], a[104:107], v[8:11], a[40:43]
    v_mfma_f32_16x16x32_bf16 a[44:47], a[104:107], v[12:15], a[44:47]
    ds_read_b64_tr_b16 a[104:105], v244 offset:12288
    v_mfma_f32_16x16x32_bf16 a[48:51], a[108:111], v[0:3], a[48:51]
    ds_read_b64_tr_b16 a[106:107], v244 offset:12800
    v_mfma_f32_16x16x32_bf16 a[52:55], a[108:111], v[4:7], a[52:55]
    v_mfma_f32_16x16x32_bf16 a[56:59], a[108:111], v[8:11], a[56:59]
    v_mfma_f32_16x16x32_bf16 a[60:63], a[108:111], v[12:15], a[60:63]
    ds_read_b64_tr_b16 a[108:109], v245 offset:12288
    v_mfma_f32_16x16x32_bf16 v[192:195], a[112:115], v[0:3], v[192:195]
    ds_read_b64_tr_b16 a[110:111], v245 offset:12800
    v_mfma_f32_16x16x32_bf16 v[208:211], v[0:3], v[0:3], v[208:211]
    v_mfma_f32_16x16x32_bf16 v[196:199], a[112:115], v[4:7], v[196:199]
    v_mfma_f32_16x16x32_bf16 v[212:215], v[4:7], v[4:7], v[212:215]
    v_mfma_f32_16x16x32_bf16 v[200:203], a[112:115], v[8:11], v[200:203]
    v_mfma_f32_16x16x32_bf16 v[216:219], v[8:11], v[8:11], v[216:219]
    v_mfma_f32_16x16x32_bf16 v[204:207], a[112:115], v[12:15], v[204:207]
    v_mfma_f32_16x16x32_bf16 v[220:223], v[12:15], v[12:15], v[220:223]
    s_waitcnt vmcnt(7) lgkmcnt(0)
    s_barrier
    v_mfma_f32_16x16x32_bf16 v[64:67], a[64:67], v[16:19], v[64:67]
    v_mfma_f32_16x16x32_bf16 v[68:71], a[64:67], v[20:23], v[68:71]
    v_mfma_f32_16x16x32_bf16 v[72:75], a[64:67], v[24:27], v[72:75]
    ds_read_b128 v[32:35], v236 offset:49152
    v_mfma_f32_16x16x32_bf16 v[76:79], a[64:67], v[28:31], v[76:79]
    v_mfma_f32_16x16x32_bf16 v[224:227], a[64:67], a[112:115], v[224:227]
    ds_read_b64_tr_b16 a[64:65], v238 offset:24576
    v_mfma_f32_16x16x32_bf16 v[80:83], a[68:71], v[16:19], v[80:83]
    s_add_u32 m0, s38, 0x1f000
    s_mov_b32 s45, 0x240000
    ds_read_b64_tr_b16 a[66:67], v238 offset:25600
    ds_read_b128 v[36:39], v236 offset:51200
    v_mfma_f32_16x16x32_bf16 v[84:87], a[68:71], v[20:23], v[84:87]
    buffer_load_dwordx4 v248, s[20:23], s45 offen lds
    v_mfma_f32_16x16x32_bf16 v[88:91], a[68:71], v[24:27], v[88:91]
    v_mfma_f32_16x16x32_bf16 v[92:95], a[68:71], v[28:31], v[92:95]
    ds_read_b128 v[40:43], v236 offset:53248
    v_mfma_f32_16x16x32_bf16 v[228:231], a[68:71], a[112:115], v[228:231]
    ds_read_b64_tr_b16 a[68:69], v238 offset:24584
    v_mfma_f32_16x16x32_bf16 v[96:99], a[72:75], v[16:19], v[96:99]
    s_mov_b32 s46, 0x247c00
    ds_read_b64_tr_b16 a[70:71], v238 offset:25608
    v_mfma_f32_16x16x32_bf16 v[100:103], a[72:75], v[20:23], v[100:103]
    buffer_load_dwordx4 v248, s[20:23], s46 offen offset:1024 lds
    ds_read_b128 v[44:47], v236 offset:55296
    v_mfma_f32_16x16x32_bf16 v[104:107], a[72:75], v[24:27], v[104:107]
    v_mfma_f32_16x16x32_bf16 v[108:111], a[72:75], v[28:31], v[108:111]
    ds_read_b64_tr_b16 a[72:73], v239 offset:24576
    v_mfma_f32_16x16x32_bf16 v[112:115], a[76:79], v[16:19], v[112:115]
    ds_read_b64_tr_b16 a[74:75], v239 offset:25600
    ds_read_b128 v[48:51], v237 offset:49152
    v_mfma_f32_16x16x32_bf16 v[116:119], a[76:79], v[20:23], v[116:119]
    s_add_u32 m0, s37, 0x21000
    s_mov_b32 s45, 0xfc000
    v_mfma_f32_16x16x32_bf16 v[120:123], a[76:79], v[24:27], v[120:123]
    buffer_load_dwordx4 v249, s[24:27], s45 offen lds
    v_mfma_f32_16x16x32_bf16 v[124:127], a[76:79], v[28:31], v[124:127]
    ds_read_b64_tr_b16 a[76:77], v239 offset:24584
    ds_read_b128 v[52:55], v237 offset:51200
    v_mfma_f32_16x16x32_bf16 v[128:131], a[80:83], v[16:19], v[128:131]
    ds_read_b64_tr_b16 a[78:79], v239 offset:25608
    v_mfma_f32_16x16x32_bf16 v[132:135], a[80:83], v[20:23], v[132:135]
    v_mfma_f32_16x16x32_bf16 v[136:139], a[80:83], v[24:27], v[136:139]
    s_add_u32 m0, s49, 0x9000
    s_mov_b32 s45, 0x8200
    ds_read_b128 v[56:59], v237 offset:53248
    v_mfma_f32_16x16x32_bf16 v[140:143], a[80:83], v[28:31], v[140:143]
    buffer_load_dwordx4 v246, s[16:19], s45 offen offset:0 lds
    ds_read_b64_tr_b16 a[80:81], v240 offset:24576
    v_mfma_f32_16x16x32_bf16 v[144:147], a[84:87], v[16:19], v[144:147]
    ds_read_b64_tr_b16 a[82:83], v240 offset:25600
    v_mfma_f32_16x16x32_bf16 v[148:151], a[84:87], v[20:23], v[148:151]
    ds_read_b128 v[60:63], v237 offset:55296
    v_mfma_f32_16x16x32_bf16 v[152:155], a[84:87], v[24:27], v[152:155]
    v_mfma_f32_16x16x32_bf16 v[156:159], a[84:87], v[28:31], v[156:159]
    s_mov_b32 s46, 0x9e00
    ds_read_b64_tr_b16 a[84:85], v240 offset:24584
    v_mfma_f32_16x16x32_bf16 v[160:163], a[88:91], v[16:19], v[160:163]
    buffer_load_dwordx4 v247, s[16:19], s46 offen offset:1024 lds
    ds_read_b64_tr_b16 a[86:87], v240 offset:25608
    v_mfma_f32_16x16x32_bf16 v[164:167], a[88:91], v[20:23], v[164:167]
    v_mfma_f32_16x16x32_bf16 v[168:171], a[88:91], v[24:27], v[168:171]
    v_mfma_f32_16x16x32_bf16 v[172:175], a[88:91], v[28:31], v[172:175]
    ds_read_b64_tr_b16 a[88:89], v241 offset:24576
    v_mfma_f32_16x16x32_bf16 v[176:179], a[92:95], v[16:19], v[176:179]
    s_mov_b32 s45, 0xba00
    ds_read_b64_tr_b16 a[90:91], v241 offset:25600
    v_mfma_f32_16x16x32_bf16 v[180:183], a[92:95], v[20:23], v[180:183]
    buffer_load_dwordx4 v246, s[16:19], s45 offen offset:2048 lds
    v_mfma_f32_16x16x32_bf16 v[184:187], a[92:95], v[24:27], v[184:187]
    v_mfma_f32_16x16x32_bf16 v[188:191], a[92:95], v[28:31], v[188:191]
    ds_read_b64_tr_b16 a[92:93], v241 offset:24584
    v_mfma_f32_16x16x32_bf16 a[0:3], a[96:99], v[16:19], a[0:3]
    ds_read_b64_tr_b16 a[94:95], v241 offset:25608
    v_mfma_f32_16x16x32_bf16 a[4:7], a[96:99], v[20:23], a[4:7]
    s_mov_b32 s46, 0xd600
    v_mfma_f32_16x16x32_bf16 a[8:11], a[96:99], v[24:27], a[8:11]
    buffer_load_dwordx4 v247, s[16:19], s46 offen offset:3072 lds
    v_mfma_f32_16x16x32_bf16 a[12:15], a[96:99], v[28:31], a[12:15]
    v_mfma_f32_16x16x32_bf16 a[124:127], a[96:99], a[112:115], a[124:127]
    ds_read_b64_tr_b16 a[96:97], v242 offset:24576
    v_mfma_f32_16x16x32_bf16 a[16:19], a[100:103], v[16:19], a[16:19]
    ds_read_b64_tr_b16 a[98:99], v242 offset:25088
    v_mfma_f32_16x16x32_bf16 a[20:23], a[100:103], v[20:23], a[20:23]
    s_mov_b32 s39, 0x0
    s_add_u32 m0, s37, 0x0
    v_mfma_f32_16x16x32_bf16 a[24:27], a[100:103], v[24:27], a[24:27]
    buffer_load_dwordx4 v252, s[8:11], s39 offen lds
    v_mfma_f32_16x16x32_bf16 a[28:31], a[100:103], v[28:31], a[28:31]
    v_mfma_f32_16x16x32_bf16 a[128:131], a[100:103], a[112:115], a[128:131]
    ds_read_b64_tr_b16 a[100:101], v243 offset:24576
    v_mfma_f32_16x16x32_bf16 a[32:35], a[104:107], v[16:19], a[32:35]
    ds_read_b64_tr_b16 a[102:103], v243 offset:25088
    v_mfma_f32_16x16x32_bf16 a[36:39], a[104:107], v[20:23], a[36:39]
    s_add_u32 m0, s37, 0x1000
    v_mfma_f32_16x16x32_bf16 a[40:43], a[104:107], v[24:27], a[40:43]
    buffer_load_dwordx4 v253, s[8:11], s39 offen lds
    v_mfma_f32_16x16x32_bf16 a[44:47], a[104:107], v[28:31], a[44:47]
    ds_read_b64_tr_b16 a[104:105], v244 offset:24576
    v_mfma_f32_16x16x32_bf16 a[48:51], a[108:111], v[16:19], a[48:51]
    ds_read_b64_tr_b16 a[106:107], v244 offset:25088
    v_mfma_f32_16x16x32_bf16 a[52:55], a[108:111], v[20:23], a[52:55]
    v_mfma_f32_16x16x32_bf16 a[56:59], a[108:111], v[24:27], a[56:59]
    v_mfma_f32_16x16x32_bf16 a[60:63], a[108:111], v[28:31], a[60:63]
    ds_read_b64_tr_b16 a[108:109], v245 offset:24576
    v_mfma_f32_16x16x32_bf16 v[192:195], a[112:115], v[16:19], v[192:195]
    ds_read_b64_tr_b16 a[110:111], v245 offset:25088
    v_mfma_f32_16x16x32_bf16 v[208:211], v[16:19], v[16:19], v[208:211]
    v_mfma_f32_16x16x32_bf16 v[196:199], a[112:115], v[20:23], v[196:199]
    v_mfma_f32_16x16x32_bf16 v[212:215], v[20:23], v[20:23], v[212:215]
    v_mfma_f32_16x16x32_bf16 v[200:203], a[112:115], v[24:27], v[200:203]
    v_mfma_f32_16x16x32_bf16 v[216:219], v[24:27], v[24:27], v[216:219]
    v_mfma_f32_16x16x32_bf16 v[204:207], a[112:115], v[28:31], v[204:207]
    v_mfma_f32_16x16x32_bf16 v[220:223], v[28:31], v[28:31], v[220:223]
    s_waitcnt vmcnt(20) lgkmcnt(0)
    s_barrier
    v_mfma_f32_16x16x32_bf16 v[64:67], a[64:67], v[32:35], v[64:67]
    v_mfma_f32_16x16x32_bf16 v[68:71], a[64:67], v[36:39], v[68:71]
    v_mfma_f32_16x16x32_bf16 v[72:75], a[64:67], v[40:43], v[72:75]
    v_mfma_f32_16x16x32_bf16 v[76:79], a[64:67], v[44:47], v[76:79]
    v_mfma_f32_16x16x32_bf16 v[224:227], a[64:67], a[112:115], v[224:227]
    ds_read_b64_tr_b16 a[64:65], v238 offset:36864
    v_mfma_f32_16x16x32_bf16 v[80:83], a[68:71], v[32:35], v[80:83]
    s_add_u32 m0, s38, 0x22000
    s_mov_b32 s45, 0x280000
    ds_read_b64_tr_b16 a[66:67], v238 offset:37888
    v_mfma_f32_16x16x32_bf16 v[84:87], a[68:71], v[36:39], v[84:87]
    buffer_load_dwordx4 v248, s[20:23], s45 offen lds
    v_mfma_f32_16x16x32_bf16 v[88:91], a[68:71], v[40:43], v[88:91]
    v_mfma_f32_16x16x32_bf16 v[92:95], a[68:71], v[44:47], v[92:95]
    v_mfma_f32_16x16x32_bf16 v[228:231], a[68:71], a[112:115], v[228:231]
    ds_read_b64_tr_b16 a[68:69], v238 offset:36872
    v_mfma_f32_16x16x32_bf16 v[96:99], a[72:75], v[32:35], v[96:99]
    s_mov_b32 s46, 0x287c00
    ds_read_b64_tr_b16 a[70:71], v238 offset:37896
    v_mfma_f32_16x16x32_bf16 v[100:103], a[72:75], v[36:39], v[100:103]
    buffer_load_dwordx4 v248, s[20:23], s46 offen offset:1024 lds
    v_mfma_f32_16x16x32_bf16 v[104:107], a[72:75], v[40:43], v[104:107]
    v_mfma_f32_16x16x32_bf16 v[108:111], a[72:75], v[44:47], v[108:111]
    ds_read_b64_tr_b16 a[72:73], v239 offset:36864
    v_mfma_f32_16x16x32_bf16 v[112:115], a[76:79], v[32:35], v[112:115]
    ds_read_b64_tr_b16 a[74:75], v239 offset:37888
    v_mfma_f32_16x16x32_bf16 v[116:119], a[76:79], v[36:39], v[116:119]
    s_add_u32 m0, s37, 0x24000
    s_mov_b32 s45, 0x118000
    v_mfma_f32_16x16x32_bf16 v[120:123], a[76:79], v[40:43], v[120:123]
    buffer_load_dwordx4 v249, s[24:27], s45 offen lds
    v_mfma_f32_16x16x32_bf16 v[124:127], a[76:79], v[44:47], v[124:127]
    ds_read_b64_tr_b16 a[76:77], v239 offset:36872
    v_mfma_f32_16x16x32_bf16 v[128:131], a[80:83], v[32:35], v[128:131]
    ds_read_b64_tr_b16 a[78:79], v239 offset:37896
    v_mfma_f32_16x16x32_bf16 v[132:135], a[80:83], v[36:39], v[132:135]
    v_mfma_f32_16x16x32_bf16 v[136:139], a[80:83], v[40:43], v[136:139]
    s_add_u32 m0, s49, 0x14000
    s_mov_b32 s45, 0x280
    v_mfma_f32_16x16x32_bf16 v[140:143], a[80:83], v[44:47], v[140:143]
    buffer_load_dwordx4 v246, s[16:19], s45 offen offset:0 lds
    ds_read_b64_tr_b16 a[80:81], v240 offset:36864
    v_mfma_f32_16x16x32_bf16 v[144:147], a[84:87], v[32:35], v[144:147]
    ds_read_b64_tr_b16 a[82:83], v240 offset:37888
    v_mfma_f32_16x16x32_bf16 v[148:151], a[84:87], v[36:39], v[148:151]
    v_mfma_f32_16x16x32_bf16 v[152:155], a[84:87], v[40:43], v[152:155]
    v_mfma_f32_16x16x32_bf16 v[156:159], a[84:87], v[44:47], v[156:159]
    s_mov_b32 s46, 0x1e80
    ds_read_b64_tr_b16 a[84:85], v240 offset:36872
    v_mfma_f32_16x16x32_bf16 v[160:163], a[88:91], v[32:35], v[160:163]
    buffer_load_dwordx4 v247, s[16:19], s46 offen offset:1024 lds
    ds_read_b64_tr_b16 a[86:87], v240 offset:37896
    v_mfma_f32_16x16x32_bf16 v[164:167], a[88:91], v[36:39], v[164:167]
    v_mfma_f32_16x16x32_bf16 v[168:171], a[88:91], v[40:43], v[168:171]
    v_mfma_f32_16x16x32_bf16 v[172:175], a[88:91], v[44:47], v[172:175]
    ds_read_b64_tr_b16 a[88:89], v241 offset:36864
    v_mfma_f32_16x16x32_bf16 v[176:179], a[92:95], v[32:35], v[176:179]
    s_mov_b32 s45, 0x3a80
    ds_read_b64_tr_b16 a[90:91], v241 offset:37888
    v_mfma_f32_16x16x32_bf16 v[180:183], a[92:95], v[36:39], v[180:183]
    buffer_load_dwordx4 v246, s[16:19], s45 offen offset:2048 lds
    v_mfma_f32_16x16x32_bf16 v[184:187], a[92:95], v[40:43], v[184:187]
    v_mfma_f32_16x16x32_bf16 v[188:191], a[92:95], v[44:47], v[188:191]
    ds_read_b64_tr_b16 a[92:93], v241 offset:36872
    v_mfma_f32_16x16x32_bf16 a[0:3], a[96:99], v[32:35], a[0:3]
    ds_read_b64_tr_b16 a[94:95], v241 offset:37896
    v_mfma_f32_16x16x32_bf16 a[4:7], a[96:99], v[36:39], a[4:7]
    s_mov_b32 s46, 0x5680
    v_mfma_f32_16x16x32_bf16 a[8:11], a[96:99], v[40:43], a[8:11]
    buffer_load_dwordx4 v247, s[16:19], s46 offen offset:3072 lds
    v_mfma_f32_16x16x32_bf16 a[12:15], a[96:99], v[44:47], a[12:15]
    v_mfma_f32_16x16x32_bf16 a[124:127], a[96:99], a[112:115], a[124:127]
    ds_read_b64_tr_b16 a[96:97], v242 offset:36864
    v_mfma_f32_16x16x32_bf16 a[16:19], a[100:103], v[32:35], a[16:19]
    ds_read_b64_tr_b16 a[98:99], v242 offset:37376
    v_mfma_f32_16x16x32_bf16 a[20:23], a[100:103], v[36:39], a[20:23]
    s_mov_b32 s39, 0x2000
    s_add_u32 m0, s37, 0x2000
    v_mfma_f32_16x16x32_bf16 a[24:27], a[100:103], v[40:43], a[24:27]
    buffer_load_dwordx4 v252, s[8:11], s39 offen lds
    v_mfma_f32_16x16x32_bf16 a[28:31], a[100:103], v[44:47], a[28:31]
    v_mfma_f32_16x16x32_bf16 a[128:131], a[100:103], a[112:115], a[128:131]
    ds_read_b64_tr_b16 a[100:101], v243 offset:36864
    v_mfma_f32_16x16x32_bf16 a[32:35], a[104:107], v[32:35], a[32:35]
    ds_read_b64_tr_b16 a[102:103], v243 offset:37376
    v_mfma_f32_16x16x32_bf16 a[36:39], a[104:107], v[36:39], a[36:39]
    s_add_u32 m0, s37, 0x3000
    v_mfma_f32_16x16x32_bf16 a[40:43], a[104:107], v[40:43], a[40:43]
    buffer_load_dwordx4 v253, s[8:11], s39 offen lds
    v_mfma_f32_16x16x32_bf16 a[44:47], a[104:107], v[44:47], a[44:47]
    ds_read_b64_tr_b16 a[104:105], v244 offset:36864
    v_mfma_f32_16x16x32_bf16 a[48:51], a[108:111], v[32:35], a[48:51]
    ds_read_b64_tr_b16 a[106:107], v244 offset:37376
    v_mfma_f32_16x16x32_bf16 a[52:55], a[108:111], v[36:39], a[52:55]
    v_mfma_f32_16x16x32_bf16 a[56:59], a[108:111], v[40:43], a[56:59]
    v_mfma_f32_16x16x32_bf16 a[60:63], a[108:111], v[44:47], a[60:63]
    ds_read_b64_tr_b16 a[108:109], v245 offset:36864
    v_mfma_f32_16x16x32_bf16 v[192:195], a[112:115], v[32:35], v[192:195]
    ds_read_b64_tr_b16 a[110:111], v245 offset:37376
    v_mfma_f32_16x16x32_bf16 v[208:211], v[32:35], v[32:35], v[208:211]
    v_mfma_f32_16x16x32_bf16 v[196:199], a[112:115], v[36:39], v[196:199]
    v_mfma_f32_16x16x32_bf16 v[212:215], v[36:39], v[36:39], v[212:215]
    v_mfma_f32_16x16x32_bf16 v[200:203], a[112:115], v[40:43], v[200:203]
    v_mfma_f32_16x16x32_bf16 v[216:219], v[40:43], v[40:43], v[216:219]
    v_mfma_f32_16x16x32_bf16 v[204:207], a[112:115], v[44:47], v[204:207]
    v_mfma_f32_16x16x32_bf16 v[220:223], v[44:47], v[44:47], v[220:223]
    s_waitcnt vmcnt(11) lgkmcnt(0)
    s_barrier
    v_mfma_f32_16x16x32_bf16 v[64:67], a[64:67], v[48:51], v[64:67]
    v_mfma_f32_16x16x32_bf16 v[68:71], a[64:67], v[52:55], v[68:71]
    v_mfma_f32_16x16x32_bf16 v[72:75], a[64:67], v[56:59], v[72:75]
    ds_read_b128 v[0:3], v236 offset:0
    v_mfma_f32_16x16x32_bf16 v[76:79], a[64:67], v[60:63], v[76:79]
    v_mfma_f32_16x16x32_bf16 v[224:227], a[64:67], a[112:115], v[224:227]
    ds_read_b64_tr_b16 a[64:65], v238 offset:0
    v_mfma_f32_16x16x32_bf16 v[80:83], a[68:71], v[48:51], v[80:83]
    s_add_u32 m0, s38, 0x25000
    s_mov_b32 s45, 0x2c0000
    ds_read_b64_tr_b16 a[66:67], v238 offset:1024
    ds_read_b128 v[4:7], v236 offset:2048
    v_mfma_f32_16x16x32_bf16 v[84:87], a[68:71], v[52:55], v[84:87]
    buffer_load_dwordx4 v248, s[20:23], s45 offen lds
    v_mfma_f32_16x16x32_bf16 v[88:91], a[68:71], v[56:59], v[88:91]
    v_mfma_f32_16x16x32_bf16 v[92:95], a[68:71], v[60:63], v[92:95]
    ds_read_b128 v[8:11], v236 offset:4096
    v_mfma_f32_16x16x32_bf16 v[228:231], a[68:71], a[112:115], v[228:231]
    ds_read_b64_tr_b16 a[68:69], v238 offset:8
    v_mfma_f32_16x16x32_bf16 v[96:99], a[72:75], v[48:51], v[96:99]
    s_mov_b32 s46, 0x2c7c00
    ds_read_b64_tr_b16 a[70:71], v238 offset:1032
    v_mfma_f32_16x16x32_bf16 v[100:103], a[72:75], v[52:55], v[100:103]
    buffer_load_dwordx4 v248, s[20:23], s46 offen offset:1024 lds
    ds_read_b128 v[12:15], v236 offset:6144
    v_mfma_f32_16x16x32_bf16 v[104:107], a[72:75], v[56:59], v[104:107]
    v_mfma_f32_16x16x32_bf16 v[108:111], a[72:75], v[60:63], v[108:111]
    ds_read_b64_tr_b16 a[72:73], v239 offset:0
    v_mfma_f32_16x16x32_bf16 v[112:115], a[76:79], v[48:51], v[112:115]
    ds_read_b64_tr_b16 a[74:75], v239 offset:1024
    ds_read_b128 v[16:19], v237 offset:0
    v_mfma_f32_16x16x32_bf16 v[116:119], a[76:79], v[52:55], v[116:119]
    s_add_u32 m0, s37, 0x27000
    s_mov_b32 s45, 0x134000
    v_mfma_f32_16x16x32_bf16 v[120:123], a[76:79], v[56:59], v[120:123]
    buffer_load_dwordx4 v249, s[24:27], s45 offen lds
    v_mfma_f32_16x16x32_bf16 v[124:127], a[76:79], v[60:63], v[124:127]
    ds_read_b64_tr_b16 a[76:77], v239 offset:8
    ds_read_b128 v[20:23], v237 offset:2048
    v_mfma_f32_16x16x32_bf16 v[128:131], a[80:83], v[48:51], v[128:131]
    ds_read_b64_tr_b16 a[78:79], v239 offset:1032
    v_mfma_f32_16x16x32_bf16 v[132:135], a[80:83], v[52:55], v[132:135]
    v_mfma_f32_16x16x32_bf16 v[136:139], a[80:83], v[56:59], v[136:139]
    s_add_u32 m0, s49, 0x15000
    s_mov_b32 s45, 0x8280
    ds_read_b128 v[24:27], v237 offset:4096
    v_mfma_f32_16x16x32_bf16 v[140:143], a[80:83], v[60:63], v[140:143]
    buffer_load_dwordx4 v246, s[16:19], s45 offen offset:0 lds
    ds_read_b64_tr_b16 a[80:81], v240 offset:0
    v_mfma_f32_16x16x32_bf16 v[144:147], a[84:87], v[48:51], v[144:147]
    ds_read_b64_tr_b16 a[82:83], v240 offset:1024
    v_mfma_f32_16x16x32_bf16 v[148:151], a[84:87], v[52:55], v[148:151]
    ds_read_b128 v[28:31], v237 offset:6144
    v_mfma_f32_16x16x32_bf16 v[152:155], a[84:87], v[56:59], v[152:155]
    v_mfma_f32_16x16x32_bf16 v[156:159], a[84:87], v[60:63], v[156:159]
    s_mov_b32 s46, 0x9e80
    ds_read_b64_tr_b16 a[84:85], v240 offset:8
    v_mfma_f32_16x16x32_bf16 v[160:163], a[88:91], v[48:51], v[160:163]
    buffer_load_dwordx4 v247, s[16:19], s46 offen offset:1024 lds
    ds_read_b64_tr_b16 a[86:87], v240 offset:1032
    v_mfma_f32_16x16x32_bf16 v[164:167], a[88:91], v[52:55], v[164:167]
    v_mfma_f32_16x16x32_bf16 v[168:171], a[88:91], v[56:59], v[168:171]
    v_mfma_f32_16x16x32_bf16 v[172:175], a[88:91], v[60:63], v[172:175]
    ds_read_b64_tr_b16 a[88:89], v241 offset:0
    v_mfma_f32_16x16x32_bf16 v[176:179], a[92:95], v[48:51], v[176:179]
    s_mov_b32 s45, 0xba80
    ds_read_b64_tr_b16 a[90:91], v241 offset:1024
    v_mfma_f32_16x16x32_bf16 v[180:183], a[92:95], v[52:55], v[180:183]
    buffer_load_dwordx4 v246, s[16:19], s45 offen offset:2048 lds
    v_mfma_f32_16x16x32_bf16 v[184:187], a[92:95], v[56:59], v[184:187]
    v_mfma_f32_16x16x32_bf16 v[188:191], a[92:95], v[60:63], v[188:191]
    ds_read_b64_tr_b16 a[92:93], v241 offset:8
    v_mfma_f32_16x16x32_bf16 a[0:3], a[96:99], v[48:51], a[0:3]
    ds_read_b64_tr_b16 a[94:95], v241 offset:1032
    v_mfma_f32_16x16x32_bf16 a[4:7], a[96:99], v[52:55], a[4:7]
    s_mov_b32 s46, 0xd680
    v_mfma_f32_16x16x32_bf16 a[8:11], a[96:99], v[56:59], a[8:11]
    buffer_load_dwordx4 v247, s[16:19], s46 offen offset:3072 lds
    v_mfma_f32_16x16x32_bf16 a[12:15], a[96:99], v[60:63], a[12:15]
    v_mfma_f32_16x16x32_bf16 a[124:127], a[96:99], a[112:115], a[124:127]
    ds_read_b64_tr_b16 a[96:97], v242 offset:0
    v_mfma_f32_16x16x32_bf16 a[16:19], a[100:103], v[48:51], a[16:19]
    ds_read_b64_tr_b16 a[98:99], v242 offset:512
    v_mfma_f32_16x16x32_bf16 a[20:23], a[100:103], v[52:55], a[20:23]
    s_mov_b32 s39, 0x6000
    s_add_u32 m0, s38, 0x10000
    v_mfma_f32_16x16x32_bf16 a[24:27], a[100:103], v[56:59], a[24:27]
    buffer_load_dwordx4 v254, s[12:15], s39 offen lds
    v_mfma_f32_16x16x32_bf16 a[28:31], a[100:103], v[60:63], a[28:31]
    v_mfma_f32_16x16x32_bf16 a[128:131], a[100:103], a[112:115], a[128:131]
    ds_read_b64_tr_b16 a[100:101], v243 offset:0
    v_mfma_f32_16x16x32_bf16 a[32:35], a[104:107], v[48:51], a[32:35]
    ds_read_b64_tr_b16 a[102:103], v243 offset:512
    v_mfma_f32_16x16x32_bf16 a[36:39], a[104:107], v[52:55], a[36:39]
    v_mfma_f32_16x16x32_bf16 a[40:43], a[104:107], v[56:59], a[40:43]
    buffer_load_dwordx4 v255, s[12:15], s39 offen offset:1024 lds
    v_mfma_f32_16x16x32_bf16 a[44:47], a[104:107], v[60:63], a[44:47]
    ds_read_b64_tr_b16 a[104:105], v244 offset:0
    v_mfma_f32_16x16x32_bf16 a[48:51], a[108:111], v[48:51], a[48:51]
    ds_read_b64_tr_b16 a[106:107], v244 offset:512
    v_mfma_f32_16x16x32_bf16 a[52:55], a[108:111], v[52:55], a[52:55]
    v_mfma_f32_16x16x32_bf16 a[56:59], a[108:111], v[56:59], a[56:59]
    v_mfma_f32_16x16x32_bf16 a[60:63], a[108:111], v[60:63], a[60:63]
    ds_read_b64_tr_b16 a[108:109], v245 offset:0
    v_mfma_f32_16x16x32_bf16 v[192:195], a[112:115], v[48:51], v[192:195]
    ds_read_b64_tr_b16 a[110:111], v245 offset:512
    v_mfma_f32_16x16x32_bf16 v[208:211], v[48:51], v[48:51], v[208:211]
    v_mfma_f32_16x16x32_bf16 v[196:199], a[112:115], v[52:55], v[196:199]
    v_mfma_f32_16x16x32_bf16 v[212:215], v[52:55], v[52:55], v[212:215]
    v_mfma_f32_16x16x32_bf16 v[200:203], a[112:115], v[56:59], v[200:203]
    v_mfma_f32_16x16x32_bf16 v[216:219], v[56:59], v[56:59], v[216:219]
    v_mfma_f32_16x16x32_bf16 v[204:207], a[112:115], v[60:63], v[204:207]
    v_mfma_f32_16x16x32_bf16 v[220:223], v[60:63], v[60:63], v[220:223]
    s_waitcnt vmcnt(24) lgkmcnt(0)
    s_barrier
    v_mfma_f32_16x16x32_bf16 v[64:67], a[64:67], v[0:3], v[64:67]
    v_mfma_f32_16x16x32_bf16 v[68:71], a[64:67], v[4:7], v[68:71]
    v_mfma_f32_16x16x32_bf16 v[72:75], a[64:67], v[8:11], v[72:75]
    v_mfma_f32_16x16x32_bf16 v[76:79], a[64:67], v[12:15], v[76:79]
    v_mfma_f32_16x16x32_bf16 v[224:227], a[64:67], a[112:115], v[224:227]
    ds_read_b64_tr_b16 a[64:65], v238 offset:12288
    v_mfma_f32_16x16x32_bf16 v[80:83], a[68:71], v[0:3], v[80:83]
    s_add_u32 m0, s38, 0x1c000
    s_mov_b32 s45, 0x300000
    ds_read_b64_tr_b16 a[66:67], v238 offset:13312
    v_mfma_f32_16x16x32_bf16 v[84:87], a[68:71], v[4:7], v[84:87]
    buffer_load_dwordx4 v248, s[20:23], s45 offen lds
    v_mfma_f32_16x16x32_bf16 v[88:91], a[68:71], v[8:11], v[88:91]
    v_mfma_f32_16x16x32_bf16 v[92:95], a[68:71], v[12:15], v[92:95]
    v_mfma_f32_16x16x32_bf16 v[228:231], a[68:71], a[112:115], v[228:231]
    ds_read_b64_tr_b16 a[68:69], v238 offset:12296
    v_mfma_f32_16x16x32_bf16 v[96:99], a[72:75], v[0:3], v[96:99]
    s_mov_b32 s46, 0x307c00
    ds_read_b64_tr_b16 a[70:71], v238 offset:13320
    v_mfma_f32_16x16x32_bf16 v[100:103], a[72:75], v[4:7], v[100:103]
    buffer_load_dwordx4 v248, s[20:23], s46 offen offset:1024 lds
    v_mfma_f32_16x16x32_bf16 v[104:107], a[72:75], v[8:11], v[104:107]
    v_mfma_f32_16x16x32_bf16 v[108:111], a[72:75], v[12:15], v[108:111]
    ds_read_b64_tr_b16 a[72:73], v239 offset:12288
    v_mfma_f32_16x16x32_bf16 v[112:115], a[76:79], v[0:3], v[112:115]
    ds_read_b64_tr_b16 a[74:75], v239 offset:13312
    v_mfma_f32_16x16x32_bf16 v[116:119], a[76:79], v[4:7], v[116:119]
    s_add_u32 m0, s37, 0x1e000
    s_mov_b32 s45, 0x150000
    v_mfma_f32_16x16x32_bf16 v[120:123], a[76:79], v[8:11], v[120:123]
    buffer_load_dwordx4 v249, s[24:27], s45 offen lds
    v_mfma_f32_16x16x32_bf16 v[124:127], a[76:79], v[12:15], v[124:127]
    ds_read_b64_tr_b16 a[76:77], v239 offset:12296
    v_mfma_f32_16x16x32_bf16 v[128:131], a[80:83], v[0:3], v[128:131]
    ds_read_b64_tr_b16 a[78:79], v239 offset:13320
    v_mfma_f32_16x16x32_bf16 v[132:135], a[80:83], v[4:7], v[132:135]
    v_mfma_f32_16x16x32_bf16 v[136:139], a[80:83], v[8:11], v[136:139]
    s_add_u32 m0, s49, 0x8000
    s_mov_b32 s45, 0x300
    v_mfma_f32_16x16x32_bf16 v[140:143], a[80:83], v[12:15], v[140:143]
    buffer_load_dwordx4 v246, s[16:19], s45 offen offset:0 lds
    ds_read_b64_tr_b16 a[80:81], v240 offset:12288
    v_mfma_f32_16x16x32_bf16 v[144:147], a[84:87], v[0:3], v[144:147]
    ds_read_b64_tr_b16 a[82:83], v240 offset:13312
    v_mfma_f32_16x16x32_bf16 v[148:151], a[84:87], v[4:7], v[148:151]
    v_mfma_f32_16x16x32_bf16 v[152:155], a[84:87], v[8:11], v[152:155]
    v_mfma_f32_16x16x32_bf16 v[156:159], a[84:87], v[12:15], v[156:159]
    s_mov_b32 s46, 0x1f00
    ds_read_b64_tr_b16 a[84:85], v240 offset:12296
    v_mfma_f32_16x16x32_bf16 v[160:163], a[88:91], v[0:3], v[160:163]
    buffer_load_dwordx4 v247, s[16:19], s46 offen offset:1024 lds
    ds_read_b64_tr_b16 a[86:87], v240 offset:13320
    v_mfma_f32_16x16x32_bf16 v[164:167], a[88:91], v[4:7], v[164:167]
    v_mfma_f32_16x16x32_bf16 v[168:171], a[88:91], v[8:11], v[168:171]
    v_mfma_f32_16x16x32_bf16 v[172:175], a[88:91], v[12:15], v[172:175]
    ds_read_b64_tr_b16 a[88:89], v241 offset:12288
    v_mfma_f32_16x16x32_bf16 v[176:179], a[92:95], v[0:3], v[176:179]
    s_mov_b32 s45, 0x3b00
    ds_read_b64_tr_b16 a[90:91], v241 offset:13312
    v_mfma_f32_16x16x32_bf16 v[180:183], a[92:95], v[4:7], v[180:183]
    buffer_load_dwordx4 v246, s[16:19], s45 offen offset:2048 lds
    v_mfma_f32_16x16x32_bf16 v[184:187], a[92:95], v[8:11], v[184:187]
    v_mfma_f32_16x16x32_bf16 v[188:191], a[92:95], v[12:15], v[188:191]
    ds_read_b64_tr_b16 a[92:93], v241 offset:12296
    v_mfma_f32_16x16x32_bf16 a[0:3], a[96:99], v[0:3], a[0:3]
    ds_read_b64_tr_b16 a[94:95], v241 offset:13320
    v_mfma_f32_16x16x32_bf16 a[4:7], a[96:99], v[4:7], a[4:7]
    s_mov_b32 s46, 0x5700
    v_mfma_f32_16x16x32_bf16 a[8:11], a[96:99], v[8:11], a[8:11]
    buffer_load_dwordx4 v247, s[16:19], s46 offen offset:3072 lds
    v_mfma_f32_16x16x32_bf16 a[12:15], a[96:99], v[12:15], a[12:15]
    v_mfma_f32_16x16x32_bf16 a[124:127], a[96:99], a[112:115], a[124:127]
    ds_read_b64_tr_b16 a[96:97], v242 offset:12288
    v_mfma_f32_16x16x32_bf16 a[16:19], a[100:103], v[0:3], a[16:19]
    ds_read_b64_tr_b16 a[98:99], v242 offset:12800
    v_mfma_f32_16x16x32_bf16 a[20:23], a[100:103], v[4:7], a[20:23]
    s_add_u32 s85, s84, 0
    s_lshr_b32 s86, s85, 2
    s_and_b32 s87, s85, 3
    s_nop 0
    s_cmp_lt_u32 s86, 128
    s_cselect_b32 s88, s80, s82
    s_cselect_b32 s89, s81, s83
    s_mov_b32 s90, 0x1c0000
    s_cselect_b32 s90, 0x400000, s90
    s_mov_b32 s91, 0x20000
    s_and_b32 s86, s86, 127
    s_lshl_b32 s86, s86, 15
    s_lshl_b32 s87, s87, 8
    s_add_u32 s85, s86, s87
    s_nop 0
    s_add_u32 m0, s38, 0x4000
    v_mfma_f32_16x16x32_bf16 a[24:27], a[100:103], v[8:11], a[24:27]
    buffer_load_dwordx4 v232, s[88:91], s85 offen lds
    v_mfma_f32_16x16x32_bf16 a[28:31], a[100:103], v[12:15], a[28:31]
    v_mfma_f32_16x16x32_bf16 a[128:131], a[100:103], a[112:115], a[128:131]
    ds_read_b64_tr_b16 a[100:101], v243 offset:12288
    v_mfma_f32_16x16x32_bf16 a[32:35], a[104:107], v[0:3], a[32:35]
    ds_read_b64_tr_b16 a[102:103], v243 offset:12800
    v_mfma_f32_16x16x32_bf16 a[36:39], a[104:107], v[4:7], a[36:39]
    s_add_u32 s85, s85, 0xc00
    v_mfma_f32_16x16x32_bf16 a[40:43], a[104:107], v[8:11], a[40:43]
    buffer_load_dwordx4 v233, s[88:91], s85 offen offset:1024 lds
    v_mfma_f32_16x16x32_bf16 a[44:47], a[104:107], v[12:15], a[44:47]
    ds_read_b64_tr_b16 a[104:105], v244 offset:12288
    v_mfma_f32_16x16x32_bf16 a[48:51], a[108:111], v[0:3], a[48:51]
    ds_read_b64_tr_b16 a[106:107], v244 offset:12800
    v_mfma_f32_16x16x32_bf16 a[52:55], a[108:111], v[4:7], a[52:55]
    v_mfma_f32_16x16x32_bf16 a[56:59], a[108:111], v[8:11], a[56:59]
    v_mfma_f32_16x16x32_bf16 a[60:63], a[108:111], v[12:15], a[60:63]
    ds_read_b64_tr_b16 a[108:109], v245 offset:12288
    v_mfma_f32_16x16x32_bf16 v[192:195], a[112:115], v[0:3], v[192:195]
    ds_read_b64_tr_b16 a[110:111], v245 offset:12800
    v_mfma_f32_16x16x32_bf16 v[208:211], v[0:3], v[0:3], v[208:211]
    v_mfma_f32_16x16x32_bf16 v[196:199], a[112:115], v[4:7], v[196:199]
    v_mfma_f32_16x16x32_bf16 v[212:215], v[4:7], v[4:7], v[212:215]
    v_mfma_f32_16x16x32_bf16 v[200:203], a[112:115], v[8:11], v[200:203]
    v_mfma_f32_16x16x32_bf16 v[216:219], v[8:11], v[8:11], v[216:219]
    v_mfma_f32_16x16x32_bf16 v[204:207], a[112:115], v[12:15], v[204:207]
    v_mfma_f32_16x16x32_bf16 v[220:223], v[12:15], v[12:15], v[220:223]
    s_waitcnt vmcnt(11) lgkmcnt(0)
    s_barrier
    v_mfma_f32_16x16x32_bf16 v[64:67], a[64:67], v[16:19], v[64:67]
    v_mfma_f32_16x16x32_bf16 v[68:71], a[64:67], v[20:23], v[68:71]
    v_mfma_f32_16x16x32_bf16 v[72:75], a[64:67], v[24:27], v[72:75]
    ds_read_b128 v[32:35], v236 offset:49152
    v_mfma_f32_16x16x32_bf16 v[76:79], a[64:67], v[28:31], v[76:79]
    v_mfma_f32_16x16x32_bf16 v[224:227], a[64:67], a[112:115], v[224:227]
    ds_read_b64_tr_b16 a[64:65], v238 offset:24576
    v_mfma_f32_16x16x32_bf16 v[80:83], a[68:71], v[16:19], v[80:83]
    s_add_u32 m0, s38, 0x1f000
    s_mov_b32 s45, 0x340000
    ds_read_b64_tr_b16 a[66:67], v238 offset:25600
    ds_read_b128 v[36:39], v236 offset:51200
    v_mfma_f32_16x16x32_bf16 v[84:87], a[68:71], v[20:23], v[84:87]
    buffer_load_dwordx4 v248, s[20:23], s45 offen lds
    v_mfma_f32_16x16x32_bf16 v[88:91], a[68:71], v[24:27], v[88:91]
    v_mfma_f32_16x16x32_bf16 v[92:95], a[68:71], v[28:31], v[92:95]
    ds_read_b128 v[40:43], v236 offset:53248
    v_mfma_f32_16x16x32_bf16 v[228:231], a[68:71], a[112:115], v[228:231]
    ds_read_b64_tr_b16 a[68:69], v238 offset:24584
    v_mfma_f32_16x16x32_bf16 v[96:99], a[72:75], v[16:19], v[96:99]
    s_mov_b32 s46, 0x347c00
    ds_read_b64_tr_b16 a[70:71], v238 offset:25608
    v_mfma_f32_16x16x32_bf16 v[100:103], a[72:75], v[20:23], v[100:103]
    buffer_load_dwordx4 v248, s[20:23], s46 offen offset:1024 lds
    ds_read_b128 v[44:47], v236 offset:55296
    v_mfma_f32_16x16x32_bf16 v[104:107], a[72:75], v[24:27], v[104:107]
    v_mfma_f32_16x16x32_bf16 v[108:111], a[72:75], v[28:31], v[108:111]
    ds_read_b64_tr_b16 a[72:73], v239 offset:24576
    v_mfma_f32_16x16x32_bf16 v[112:115], a[76:79], v[16:19], v[112:115]
    ds_read_b64_tr_b16 a[74:75], v239 offset:25600
    ds_read_b128 v[48:51], v237 offset:49152
    v_mfma_f32_16x16x32_bf16 v[116:119], a[76:79], v[20:23], v[116:119]
    s_add_u32 m0, s37, 0x21000
    s_mov_b32 s45, 0x16c000
    v_mfma_f32_16x16x32_bf16 v[120:123], a[76:79], v[24:27], v[120:123]
    buffer_load_dwordx4 v249, s[24:27], s45 offen lds
    v_mfma_f32_16x16x32_bf16 v[124:127], a[76:79], v[28:31], v[124:127]
    ds_read_b64_tr_b16 a[76:77], v239 offset:24584
    ds_read_b128 v[52:55], v237 offset:51200
    v_mfma_f32_16x16x32_bf16 v[128:131], a[80:83], v[16:19], v[128:131]
    ds_read_b64_tr_b16 a[78:79], v239 offset:25608
    v_mfma_f32_16x16x32_bf16 v[132:135], a[80:83], v[20:23], v[132:135]
    v_mfma_f32_16x16x32_bf16 v[136:139], a[80:83], v[24:27], v[136:139]
    s_add_u32 m0, s49, 0x9000
    s_mov_b32 s45, 0x8300
    ds_read_b128 v[56:59], v237 offset:53248
    v_mfma_f32_16x16x32_bf16 v[140:143], a[80:83], v[28:31], v[140:143]
    buffer_load_dwordx4 v246, s[16:19], s45 offen offset:0 lds
    ds_read_b64_tr_b16 a[80:81], v240 offset:24576
    v_mfma_f32_16x16x32_bf16 v[144:147], a[84:87], v[16:19], v[144:147]
    ds_read_b64_tr_b16 a[82:83], v240 offset:25600
    v_mfma_f32_16x16x32_bf16 v[148:151], a[84:87], v[20:23], v[148:151]
    ds_read_b128 v[60:63], v237 offset:55296
    v_mfma_f32_16x16x32_bf16 v[152:155], a[84:87], v[24:27], v[152:155]
    v_mfma_f32_16x16x32_bf16 v[156:159], a[84:87], v[28:31], v[156:159]
    s_mov_b32 s46, 0x9f00
    ds_read_b64_tr_b16 a[84:85], v240 offset:24584
    v_mfma_f32_16x16x32_bf16 v[160:163], a[88:91], v[16:19], v[160:163]
    buffer_load_dwordx4 v247, s[16:19], s46 offen offset:1024 lds
    ds_read_b64_tr_b16 a[86:87], v240 offset:25608
    v_mfma_f32_16x16x32_bf16 v[164:167], a[88:91], v[20:23], v[164:167]
    v_mfma_f32_16x16x32_bf16 v[168:171], a[88:91], v[24:27], v[168:171]
    v_mfma_f32_16x16x32_bf16 v[172:175], a[88:91], v[28:31], v[172:175]
    ds_read_b64_tr_b16 a[88:89], v241 offset:24576
    v_mfma_f32_16x16x32_bf16 v[176:179], a[92:95], v[16:19], v[176:179]
    s_mov_b32 s45, 0xbb00
    ds_read_b64_tr_b16 a[90:91], v241 offset:25600
    v_mfma_f32_16x16x32_bf16 v[180:183], a[92:95], v[20:23], v[180:183]
    buffer_load_dwordx4 v246, s[16:19], s45 offen offset:2048 lds
    v_mfma_f32_16x16x32_bf16 v[184:187], a[92:95], v[24:27], v[184:187]
    v_mfma_f32_16x16x32_bf16 v[188:191], a[92:95], v[28:31], v[188:191]
    ds_read_b64_tr_b16 a[92:93], v241 offset:24584
    v_mfma_f32_16x16x32_bf16 a[0:3], a[96:99], v[16:19], a[0:3]
    ds_read_b64_tr_b16 a[94:95], v241 offset:25608
    v_mfma_f32_16x16x32_bf16 a[4:7], a[96:99], v[20:23], a[4:7]
    s_mov_b32 s46, 0xd700
    v_mfma_f32_16x16x32_bf16 a[8:11], a[96:99], v[24:27], a[8:11]
    buffer_load_dwordx4 v247, s[16:19], s46 offen offset:3072 lds
    v_mfma_f32_16x16x32_bf16 a[12:15], a[96:99], v[28:31], a[12:15]
    v_mfma_f32_16x16x32_bf16 a[124:127], a[96:99], a[112:115], a[124:127]
    ds_read_b64_tr_b16 a[96:97], v242 offset:24576
    v_mfma_f32_16x16x32_bf16 a[16:19], a[100:103], v[16:19], a[16:19]
    ds_read_b64_tr_b16 a[98:99], v242 offset:25088
    v_mfma_f32_16x16x32_bf16 a[20:23], a[100:103], v[20:23], a[20:23]
    s_add_u32 s85, s84, 1
    s_lshr_b32 s86, s85, 2
    s_and_b32 s87, s85, 3
    s_nop 0
    s_cmp_lt_u32 s86, 128
    s_cselect_b32 s88, s80, s82
    s_cselect_b32 s89, s81, s83
    s_mov_b32 s90, 0x1c0000
    s_cselect_b32 s90, 0x400000, s90
    s_mov_b32 s91, 0x20000
    s_and_b32 s86, s86, 127
    s_lshl_b32 s86, s86, 15
    s_lshl_b32 s87, s87, 8
    s_add_u32 s85, s86, s87
    s_nop 0
    s_add_u32 m0, s38, 0x6000
    v_mfma_f32_16x16x32_bf16 a[24:27], a[100:103], v[24:27], a[24:27]
    buffer_load_dwordx4 v232, s[88:91], s85 offen lds
    v_mfma_f32_16x16x32_bf16 a[28:31], a[100:103], v[28:31], a[28:31]
    v_mfma_f32_16x16x32_bf16 a[128:131], a[100:103], a[112:115], a[128:131]
    ds_read_b64_tr_b16 a[100:101], v243 offset:24576
    v_mfma_f32_16x16x32_bf16 a[32:35], a[104:107], v[16:19], a[32:35]
    ds_read_b64_tr_b16 a[102:103], v243 offset:25088
    v_mfma_f32_16x16x32_bf16 a[36:39], a[104:107], v[20:23], a[36:39]
    s_add_u32 s85, s85, 0xc00
    v_mfma_f32_16x16x32_bf16 a[40:43], a[104:107], v[24:27], a[40:43]
    buffer_load_dwordx4 v233, s[88:91], s85 offen offset:1024 lds
    v_mfma_f32_16x16x32_bf16 a[44:47], a[104:107], v[28:31], a[44:47]
    ds_read_b64_tr_b16 a[104:105], v244 offset:24576
    v_mfma_f32_16x16x32_bf16 a[48:51], a[108:111], v[16:19], a[48:51]
    ds_read_b64_tr_b16 a[106:107], v244 offset:25088
    v_mfma_f32_16x16x32_bf16 a[52:55], a[108:111], v[20:23], a[52:55]
    v_mfma_f32_16x16x32_bf16 a[56:59], a[108:111], v[24:27], a[56:59]
    v_mfma_f32_16x16x32_bf16 a[60:63], a[108:111], v[28:31], a[60:63]
    ds_read_b64_tr_b16 a[108:109], v245 offset:24576
    v_mfma_f32_16x16x32_bf16 v[192:195], a[112:115], v[16:19], v[192:195]
    ds_read_b64_tr_b16 a[110:111], v245 offset:25088
    v_mfma_f32_16x16x32_bf16 v[208:211], v[16:19], v[16:19], v[208:211]
    v_mfma_f32_16x16x32_bf16 v[196:199], a[112:115], v[20:23], v[196:199]
    v_mfma_f32_16x16x32_bf16 v[212:215], v[20:23], v[20:23], v[212:215]
    v_mfma_f32_16x16x32_bf16 v[200:203], a[112:115], v[24:27], v[200:203]
    v_mfma_f32_16x16x32_bf16 v[216:219], v[24:27], v[24:27], v[216:219]
    v_mfma_f32_16x16x32_bf16 v[204:207], a[112:115], v[28:31], v[204:207]
    v_mfma_f32_16x16x32_bf16 v[220:223], v[28:31], v[28:31], v[220:223]
    s_waitcnt vmcnt(24) lgkmcnt(0)
    s_barrier
    v_mfma_f32_16x16x32_bf16 v[64:67], a[64:67], v[32:35], v[64:67]
    v_mfma_f32_16x16x32_bf16 v[68:71], a[64:67], v[36:39], v[68:71]
    v_mfma_f32_16x16x32_bf16 v[72:75], a[64:67], v[40:43], v[72:75]
    v_mfma_f32_16x16x32_bf16 v[76:79], a[64:67], v[44:47], v[76:79]
    v_mfma_f32_16x16x32_bf16 v[224:227], a[64:67], a[112:115], v[224:227]
    ds_read_b64_tr_b16 a[64:65], v238 offset:36864
    v_mfma_f32_16x16x32_bf16 v[80:83], a[68:71], v[32:35], v[80:83]
    s_add_u32 m0, s38, 0x22000
    s_mov_b32 s45, 0x380000
    ds_read_b64_tr_b16 a[66:67], v238 offset:37888
    v_mfma_f32_16x16x32_bf16 v[84:87], a[68:71], v[36:39], v[84:87]
    buffer_load_dwordx4 v248, s[20:23], s45 offen lds
    v_mfma_f32_16x16x32_bf16 v[88:91], a[68:71], v[40:43], v[88:91]
    v_mfma_f32_16x16x32_bf16 v[92:95], a[68:71], v[44:47], v[92:95]
    v_mfma_f32_16x16x32_bf16 v[228:231], a[68:71], a[112:115], v[228:231]
    ds_read_b64_tr_b16 a[68:69], v238 offset:36872
    v_mfma_f32_16x16x32_bf16 v[96:99], a[72:75], v[32:35], v[96:99]
    s_mov_b32 s46, 0x387c00
    ds_read_b64_tr_b16 a[70:71], v238 offset:37896
    v_mfma_f32_16x16x32_bf16 v[100:103], a[72:75], v[36:39], v[100:103]
    buffer_load_dwordx4 v248, s[20:23], s46 offen offset:1024 lds
    v_mfma_f32_16x16x32_bf16 v[104:107], a[72:75], v[40:43], v[104:107]
    v_mfma_f32_16x16x32_bf16 v[108:111], a[72:75], v[44:47], v[108:111]
    ds_read_b64_tr_b16 a[72:73], v239 offset:36864
    v_mfma_f32_16x16x32_bf16 v[112:115], a[76:79], v[32:35], v[112:115]
    ds_read_b64_tr_b16 a[74:75], v239 offset:37888
    v_mfma_f32_16x16x32_bf16 v[116:119], a[76:79], v[36:39], v[116:119]
    s_add_u32 m0, s37, 0x24000
    s_mov_b32 s45, 0x188000
    v_mfma_f32_16x16x32_bf16 v[120:123], a[76:79], v[40:43], v[120:123]
    buffer_load_dwordx4 v249, s[24:27], s45 offen lds
    v_mfma_f32_16x16x32_bf16 v[124:127], a[76:79], v[44:47], v[124:127]
    ds_read_b64_tr_b16 a[76:77], v239 offset:36872
    v_mfma_f32_16x16x32_bf16 v[128:131], a[80:83], v[32:35], v[128:131]
    ds_read_b64_tr_b16 a[78:79], v239 offset:37896
    v_mfma_f32_16x16x32_bf16 v[132:135], a[80:83], v[36:39], v[132:135]
    v_mfma_f32_16x16x32_bf16 v[136:139], a[80:83], v[40:43], v[136:139]
    s_add_u32 m0, s49, 0x14000
    s_mov_b32 s45, 0x380
    v_mfma_f32_16x16x32_bf16 v[140:143], a[80:83], v[44:47], v[140:143]
    buffer_load_dwordx4 v246, s[16:19], s45 offen offset:0 lds
    ds_read_b64_tr_b16 a[80:81], v240 offset:36864
    v_mfma_f32_16x16x32_bf16 v[144:147], a[84:87], v[32:35], v[144:147]
    ds_read_b64_tr_b16 a[82:83], v240 offset:37888
    v_mfma_f32_16x16x32_bf16 v[148:151], a[84:87], v[36:39], v[148:151]
    v_mfma_f32_16x16x32_bf16 v[152:155], a[84:87], v[40:43], v[152:155]
    v_mfma_f32_16x16x32_bf16 v[156:159], a[84:87], v[44:47], v[156:159]
    s_mov_b32 s46, 0x1f80
    ds_read_b64_tr_b16 a[84:85], v240 offset:36872
    v_mfma_f32_16x16x32_bf16 v[160:163], a[88:91], v[32:35], v[160:163]
    buffer_load_dwordx4 v247, s[16:19], s46 offen offset:1024 lds
    ds_read_b64_tr_b16 a[86:87], v240 offset:37896
    v_mfma_f32_16x16x32_bf16 v[164:167], a[88:91], v[36:39], v[164:167]
    v_mfma_f32_16x16x32_bf16 v[168:171], a[88:91], v[40:43], v[168:171]
    v_mfma_f32_16x16x32_bf16 v[172:175], a[88:91], v[44:47], v[172:175]
    ds_read_b64_tr_b16 a[88:89], v241 offset:36864
    v_mfma_f32_16x16x32_bf16 v[176:179], a[92:95], v[32:35], v[176:179]
    s_mov_b32 s45, 0x3b80
    ds_read_b64_tr_b16 a[90:91], v241 offset:37888
    v_mfma_f32_16x16x32_bf16 v[180:183], a[92:95], v[36:39], v[180:183]
    buffer_load_dwordx4 v246, s[16:19], s45 offen offset:2048 lds
    v_mfma_f32_16x16x32_bf16 v[184:187], a[92:95], v[40:43], v[184:187]
    v_mfma_f32_16x16x32_bf16 v[188:191], a[92:95], v[44:47], v[188:191]
    ds_read_b64_tr_b16 a[92:93], v241 offset:36872
    v_mfma_f32_16x16x32_bf16 a[0:3], a[96:99], v[32:35], a[0:3]
    ds_read_b64_tr_b16 a[94:95], v241 offset:37896
    v_mfma_f32_16x16x32_bf16 a[4:7], a[96:99], v[36:39], a[4:7]
    s_mov_b32 s46, 0x5780
    v_mfma_f32_16x16x32_bf16 a[8:11], a[96:99], v[40:43], a[8:11]
    buffer_load_dwordx4 v247, s[16:19], s46 offen offset:3072 lds
    v_mfma_f32_16x16x32_bf16 a[12:15], a[96:99], v[44:47], a[12:15]
    v_mfma_f32_16x16x32_bf16 a[124:127], a[96:99], a[112:115], a[124:127]
    ds_read_b64_tr_b16 a[96:97], v242 offset:36864
    v_mfma_f32_16x16x32_bf16 a[16:19], a[100:103], v[32:35], a[16:19]
    ds_read_b64_tr_b16 a[98:99], v242 offset:37376
    v_mfma_f32_16x16x32_bf16 a[20:23], a[100:103], v[36:39], a[20:23]
    s_add_u32 s85, s84, 2
    s_lshr_b32 s86, s85, 2
    s_and_b32 s87, s85, 3
    s_nop 0
    s_cmp_lt_u32 s86, 128
    s_cselect_b32 s88, s80, s82
    s_cselect_b32 s89, s81, s83
    s_mov_b32 s90, 0x1c0000
    s_cselect_b32 s90, 0x400000, s90
    s_mov_b32 s91, 0x20000
    s_and_b32 s86, s86, 127
    s_lshl_b32 s86, s86, 15
    s_lshl_b32 s87, s87, 8
    s_add_u32 s85, s86, s87
    s_nop 0
    s_add_u32 m0, s38, 0x12000
    v_mfma_f32_16x16x32_bf16 a[24:27], a[100:103], v[40:43], a[24:27]
    buffer_load_dwordx4 v232, s[88:91], s85 offen lds
    v_mfma_f32_16x16x32_bf16 a[28:31], a[100:103], v[44:47], a[28:31]
    v_mfma_f32_16x16x32_bf16 a[128:131], a[100:103], a[112:115], a[128:131]
    ds_read_b64_tr_b16 a[100:101], v243 offset:36864
    v_mfma_f32_16x16x32_bf16 a[32:35], a[104:107], v[32:35], a[32:35]
    ds_read_b64_tr_b16 a[102:103], v243 offset:37376
    v_mfma_f32_16x16x32_bf16 a[36:39], a[104:107], v[36:39], a[36:39]
    s_add_u32 s85, s85, 0xc00
    v_mfma_f32_16x16x32_bf16 a[40:43], a[104:107], v[40:43], a[40:43]
    buffer_load_dwordx4 v233, s[88:91], s85 offen offset:1024 lds
    v_mfma_f32_16x16x32_bf16 a[44:47], a[104:107], v[44:47], a[44:47]
    ds_read_b64_tr_b16 a[104:105], v244 offset:36864
    v_mfma_f32_16x16x32_bf16 a[48:51], a[108:111], v[32:35], a[48:51]
    ds_read_b64_tr_b16 a[106:107], v244 offset:37376
    v_mfma_f32_16x16x32_bf16 a[52:55], a[108:111], v[36:39], a[52:55]
    v_mfma_f32_16x16x32_bf16 a[56:59], a[108:111], v[40:43], a[56:59]
    v_mfma_f32_16x16x32_bf16 a[60:63], a[108:111], v[44:47], a[60:63]
    ds_read_b64_tr_b16 a[108:109], v245 offset:36864
    v_mfma_f32_16x16x32_bf16 v[192:195], a[112:115], v[32:35], v[192:195]
    ds_read_b64_tr_b16 a[110:111], v245 offset:37376
    v_mfma_f32_16x16x32_bf16 v[208:211], v[32:35], v[32:35], v[208:211]
    v_mfma_f32_16x16x32_bf16 v[196:199], a[112:115], v[36:39], v[196:199]
    v_mfma_f32_16x16x32_bf16 v[212:215], v[36:39], v[36:39], v[212:215]
    v_mfma_f32_16x16x32_bf16 v[200:203], a[112:115], v[40:43], v[200:203]
    v_mfma_f32_16x16x32_bf16 v[216:219], v[40:43], v[40:43], v[216:219]
    v_mfma_f32_16x16x32_bf16 v[204:207], a[112:115], v[44:47], v[204:207]
    v_mfma_f32_16x16x32_bf16 v[220:223], v[44:47], v[44:47], v[220:223]
    s_waitcnt vmcnt(11) lgkmcnt(0)
    s_barrier
    v_mfma_f32_16x16x32_bf16 v[64:67], a[64:67], v[48:51], v[64:67]
    v_mfma_f32_16x16x32_bf16 v[68:71], a[64:67], v[52:55], v[68:71]
    v_mfma_f32_16x16x32_bf16 v[72:75], a[64:67], v[56:59], v[72:75]
    ds_read_b128 v[0:3], v236 offset:0
    v_mfma_f32_16x16x32_bf16 v[76:79], a[64:67], v[60:63], v[76:79]
    v_mfma_f32_16x16x32_bf16 v[224:227], a[64:67], a[112:115], v[224:227]
    ds_read_b64_tr_b16 a[64:65], v238 offset:0
    v_mfma_f32_16x16x32_bf16 v[80:83], a[68:71], v[48:51], v[80:83]
    s_add_u32 m0, s38, 0x25000
    s_mov_b32 s45, 0x3c0000
    ds_read_b64_tr_b16 a[66:67], v238 offset:1024
    ds_read_b128 v[4:7], v236 offset:2048
    v_mfma_f32_16x16x32_bf16 v[84:87], a[68:71], v[52:55], v[84:87]
    buffer_load_dwordx4 v248, s[20:23], s45 offen lds
    v_mfma_f32_16x16x32_bf16 v[88:91], a[68:71], v[56:59], v[88:91]
    v_mfma_f32_16x16x32_bf16 v[92:95], a[68:71], v[60:63], v[92:95]
    ds_read_b128 v[8:11], v236 offset:4096
    v_mfma_f32_16x16x32_bf16 v[228:231], a[68:71], a[112:115], v[228:231]
    ds_read_b64_tr_b16 a[68:69], v238 offset:8
    v_mfma_f32_16x16x32_bf16 v[96:99], a[72:75], v[48:51], v[96:99]
    s_mov_b32 s46, 0x3c7c00
    ds_read_b64_tr_b16 a[70:71], v238 offset:1032
    v_mfma_f32_16x16x32_bf16 v[100:103], a[72:75], v[52:55], v[100:103]
    buffer_load_dwordx4 v248, s[20:23], s46 offen offset:1024 lds
    ds_read_b128 v[12:15], v236 offset:6144
    v_mfma_f32_16x16x32_bf16 v[104:107], a[72:75], v[56:59], v[104:107]
    v_mfma_f32_16x16x32_bf16 v[108:111], a[72:75], v[60:63], v[108:111]
    ds_read_b64_tr_b16 a[72:73], v239 offset:0
    v_mfma_f32_16x16x32_bf16 v[112:115], a[76:79], v[48:51], v[112:115]
    ds_read_b64_tr_b16 a[74:75], v239 offset:1024
    ds_read_b128 v[16:19], v237 offset:0
    v_mfma_f32_16x16x32_bf16 v[116:119], a[76:79], v[52:55], v[116:119]
    s_add_u32 m0, s37, 0x27000
    s_mov_b32 s45, 0x1a4000
    v_mfma_f32_16x16x32_bf16 v[120:123], a[76:79], v[56:59], v[120:123]
    buffer_load_dwordx4 v249, s[24:27], s45 offen lds
    v_mfma_f32_16x16x32_bf16 v[124:127], a[76:79], v[60:63], v[124:127]
    ds_read_b64_tr_b16 a[76:77], v239 offset:8
    ds_read_b128 v[20:23], v237 offset:2048
    v_mfma_f32_16x16x32_bf16 v[128:131], a[80:83], v[48:51], v[128:131]
    ds_read_b64_tr_b16 a[78:79], v239 offset:1032
    v_mfma_f32_16x16x32_bf16 v[132:135], a[80:83], v[52:55], v[132:135]
    v_mfma_f32_16x16x32_bf16 v[136:139], a[80:83], v[56:59], v[136:139]
    s_add_u32 m0, s49, 0x15000
    s_mov_b32 s45, 0x8380
    ds_read_b128 v[24:27], v237 offset:4096
    v_mfma_f32_16x16x32_bf16 v[140:143], a[80:83], v[60:63], v[140:143]
    buffer_load_dwordx4 v246, s[16:19], s45 offen offset:0 lds
    ds_read_b64_tr_b16 a[80:81], v240 offset:0
    v_mfma_f32_16x16x32_bf16 v[144:147], a[84:87], v[48:51], v[144:147]
    ds_read_b64_tr_b16 a[82:83], v240 offset:1024
    v_mfma_f32_16x16x32_bf16 v[148:151], a[84:87], v[52:55], v[148:151]
    ds_read_b128 v[28:31], v237 offset:6144
    v_mfma_f32_16x16x32_bf16 v[152:155], a[84:87], v[56:59], v[152:155]
    v_mfma_f32_16x16x32_bf16 v[156:159], a[84:87], v[60:63], v[156:159]
    s_mov_b32 s46, 0x9f80
    ds_read_b64_tr_b16 a[84:85], v240 offset:8
    v_mfma_f32_16x16x32_bf16 v[160:163], a[88:91], v[48:51], v[160:163]
    buffer_load_dwordx4 v247, s[16:19], s46 offen offset:1024 lds
    ds_read_b64_tr_b16 a[86:87], v240 offset:1032
    v_mfma_f32_16x16x32_bf16 v[164:167], a[88:91], v[52:55], v[164:167]
    v_mfma_f32_16x16x32_bf16 v[168:171], a[88:91], v[56:59], v[168:171]
    v_mfma_f32_16x16x32_bf16 v[172:175], a[88:91], v[60:63], v[172:175]
    ds_read_b64_tr_b16 a[88:89], v241 offset:0
    v_mfma_f32_16x16x32_bf16 v[176:179], a[92:95], v[48:51], v[176:179]
    s_mov_b32 s45, 0xbb80
    ds_read_b64_tr_b16 a[90:91], v241 offset:1024
    v_mfma_f32_16x16x32_bf16 v[180:183], a[92:95], v[52:55], v[180:183]
    buffer_load_dwordx4 v246, s[16:19], s45 offen offset:2048 lds
    v_mfma_f32_16x16x32_bf16 v[184:187], a[92:95], v[56:59], v[184:187]
    v_mfma_f32_16x16x32_bf16 v[188:191], a[92:95], v[60:63], v[188:191]
    ds_read_b64_tr_b16 a[92:93], v241 offset:8
    v_mfma_f32_16x16x32_bf16 a[0:3], a[96:99], v[48:51], a[0:3]
    ds_read_b64_tr_b16 a[94:95], v241 offset:1032
    v_mfma_f32_16x16x32_bf16 a[4:7], a[96:99], v[52:55], a[4:7]
    s_mov_b32 s46, 0xd780
    v_mfma_f32_16x16x32_bf16 a[8:11], a[96:99], v[56:59], a[8:11]
    buffer_load_dwordx4 v247, s[16:19], s46 offen offset:3072 lds
    v_mfma_f32_16x16x32_bf16 a[12:15], a[96:99], v[60:63], a[12:15]
    v_mfma_f32_16x16x32_bf16 a[124:127], a[96:99], a[112:115], a[124:127]
    ds_read_b64_tr_b16 a[96:97], v242 offset:0
    v_mfma_f32_16x16x32_bf16 a[16:19], a[100:103], v[48:51], a[16:19]
    ds_read_b64_tr_b16 a[98:99], v242 offset:512
    v_mfma_f32_16x16x32_bf16 a[20:23], a[100:103], v[52:55], a[20:23]
    ds_read_b64_tr_b16 a[132:133], v234 offset:16384
    v_mfma_f32_16x16x32_bf16 a[24:27], a[100:103], v[56:59], a[24:27]
    v_mfma_f32_16x16x32_bf16 a[28:31], a[100:103], v[60:63], a[28:31]
    v_mfma_f32_16x16x32_bf16 a[128:131], a[100:103], a[112:115], a[128:131]
    ds_read_b64_tr_b16 a[100:101], v243 offset:0
    ds_read_b64_tr_b16 a[134:135], v234 offset:20480
    v_mfma_f32_16x16x32_bf16 a[32:35], a[104:107], v[48:51], a[32:35]
    ds_read_b64_tr_b16 a[102:103], v243 offset:512
    v_mfma_f32_16x16x32_bf16 a[36:39], a[104:107], v[52:55], a[36:39]
    v_mfma_f32_16x16x32_bf16 a[40:43], a[104:107], v[56:59], a[40:43]
    ds_read_b64_tr_b16 a[136:137], v234 offset:16392
    v_mfma_f32_16x16x32_bf16 a[44:47], a[104:107], v[60:63], a[44:47]
    ds_read_b64_tr_b16 a[104:105], v244 offset:0
    v_mfma_f32_16x16x32_bf16 a[48:51], a[108:111], v[48:51], a[48:51]
    ds_read_b64_tr_b16 a[106:107], v244 offset:512
    v_mfma_f32_16x16x32_bf16 a[52:55], a[108:111], v[52:55], a[52:55]
    ds_read_b64_tr_b16 a[138:139], v234 offset:20488
    v_mfma_f32_16x16x32_bf16 a[56:59], a[108:111], v[56:59], a[56:59]
    v_mfma_f32_16x16x32_bf16 a[60:63], a[108:111], v[60:63], a[60:63]
    ds_read_b64_tr_b16 a[108:109], v245 offset:0
    v_mfma_f32_16x16x32_bf16 v[192:195], a[112:115], v[48:51], v[192:195]
    ds_read_b64_tr_b16 a[110:111], v245 offset:512
    v_mfma_f32_16x16x32_bf16 v[208:211], v[48:51], v[48:51], v[208:211]
    v_mfma_f32_16x16x32_bf16 v[196:199], a[112:115], v[52:55], v[196:199]
    v_mfma_f32_16x16x32_bf16 v[212:215], v[52:55], v[52:55], v[212:215]
    v_mfma_f32_16x16x32_bf16 v[200:203], a[112:115], v[56:59], v[200:203]
    v_mfma_f32_16x16x32_bf16 v[216:219], v[56:59], v[56:59], v[216:219]
    v_mfma_f32_16x16x32_bf16 v[204:207], a[112:115], v[60:63], v[204:207]
    v_mfma_f32_16x16x32_bf16 v[220:223], v[60:63], v[60:63], v[220:223]
    s_waitcnt vmcnt(16) lgkmcnt(0)
    s_barrier
    v_mfma_f32_16x16x32_bf16 v[64:67], a[64:67], v[0:3], v[64:67]
    v_mfma_f32_16x16x32_bf16 v[68:71], a[64:67], v[4:7], v[68:71]
    v_mfma_f32_16x16x32_bf16 v[72:75], a[64:67], v[8:11], v[72:75]
    v_mfma_f32_16x16x32_bf16 v[76:79], a[64:67], v[12:15], v[76:79]
    v_mfma_f32_16x16x32_bf16 v[224:227], a[64:67], a[112:115], v[224:227]
    ds_read_b64_tr_b16 a[64:65], v238 offset:12288
    v_mfma_f32_16x16x32_bf16 v[80:83], a[68:71], v[0:3], v[80:83]
    s_add_u32 s85, s84, 0
    s_lshl_b32 s85, s85, 13
    s_add_u32 s85, s85, s38
    s_nop 0
    ds_read_b64_tr_b16 a[66:67], v238 offset:13312
    v_mfma_f32_16x16x32_bf16 v[84:87], a[68:71], v[4:7], v[84:87]
    buffer_store_dwordx4 a[132:135], v235, s[92:95], s85 offen sc1
    v_mfma_f32_16x16x32_bf16 v[88:91], a[68:71], v[8:11], v[88:91]
    v_mfma_f32_16x16x32_bf16 v[92:95], a[68:71], v[12:15], v[92:95]
    v_mfma_f32_16x16x32_bf16 v[228:231], a[68:71], a[112:115], v[228:231]
    ds_read_b64_tr_b16 a[68:69], v238 offset:12296
    v_mfma_f32_16x16x32_bf16 v[96:99], a[72:75], v[0:3], v[96:99]
    ds_read_b64_tr_b16 a[70:71], v238 offset:13320
    v_mfma_f32_16x16x32_bf16 v[100:103], a[72:75], v[4:7], v[100:103]
    buffer_store_dwordx4 a[136:139], v235, s[92:95], s85 offen offset:1024 sc1
    v_mfma_f32_16x16x32_bf16 v[104:107], a[72:75], v[8:11], v[104:107]
    v_mfma_f32_16x16x32_bf16 v[108:111], a[72:75], v[12:15], v[108:111]
    ds_read_b64_tr_b16 a[72:73], v239 offset:12288
    v_mfma_f32_16x16x32_bf16 v[112:115], a[76:79], v[0:3], v[112:115]
    ds_read_b64_tr_b16 a[74:75], v239 offset:13312
    v_mfma_f32_16x16x32_bf16 v[116:119], a[76:79], v[4:7], v[116:119]
    v_mfma_f32_16x16x32_bf16 v[120:123], a[76:79], v[8:11], v[120:123]
    v_mfma_f32_16x16x32_bf16 v[124:127], a[76:79], v[12:15], v[124:127]
    ds_read_b64_tr_b16 a[76:77], v239 offset:12296
    v_mfma_f32_16x16x32_bf16 v[128:131], a[80:83], v[0:3], v[128:131]
    ds_read_b64_tr_b16 a[78:79], v239 offset:13320
    v_mfma_f32_16x16x32_bf16 v[132:135], a[80:83], v[4:7], v[132:135]
    v_mfma_f32_16x16x32_bf16 v[136:139], a[80:83], v[8:11], v[136:139]
    v_mfma_f32_16x16x32_bf16 v[140:143], a[80:83], v[12:15], v[140:143]
    ds_read_b64_tr_b16 a[80:81], v240 offset:12288
    v_mfma_f32_16x16x32_bf16 v[144:147], a[84:87], v[0:3], v[144:147]
    ds_read_b64_tr_b16 a[82:83], v240 offset:13312
    v_mfma_f32_16x16x32_bf16 v[148:151], a[84:87], v[4:7], v[148:151]
    v_mfma_f32_16x16x32_bf16 v[152:155], a[84:87], v[8:11], v[152:155]
    v_mfma_f32_16x16x32_bf16 v[156:159], a[84:87], v[12:15], v[156:159]
    ds_read_b64_tr_b16 a[84:85], v240 offset:12296
    v_mfma_f32_16x16x32_bf16 v[160:163], a[88:91], v[0:3], v[160:163]
    ds_read_b64_tr_b16 a[86:87], v240 offset:13320
    v_mfma_f32_16x16x32_bf16 v[164:167], a[88:91], v[4:7], v[164:167]
    v_mfma_f32_16x16x32_bf16 v[168:171], a[88:91], v[8:11], v[168:171]
    v_mfma_f32_16x16x32_bf16 v[172:175], a[88:91], v[12:15], v[172:175]
    ds_read_b64_tr_b16 a[88:89], v241 offset:12288
    v_mfma_f32_16x16x32_bf16 v[176:179], a[92:95], v[0:3], v[176:179]
    ds_read_b64_tr_b16 a[90:91], v241 offset:13312
    v_mfma_f32_16x16x32_bf16 v[180:183], a[92:95], v[4:7], v[180:183]
    v_mfma_f32_16x16x32_bf16 v[184:187], a[92:95], v[8:11], v[184:187]
    v_mfma_f32_16x16x32_bf16 v[188:191], a[92:95], v[12:15], v[188:191]
    ds_read_b64_tr_b16 a[92:93], v241 offset:12296
    v_mfma_f32_16x16x32_bf16 a[0:3], a[96:99], v[0:3], a[0:3]
    ds_read_b64_tr_b16 a[94:95], v241 offset:13320
    v_mfma_f32_16x16x32_bf16 a[4:7], a[96:99], v[4:7], a[4:7]
    v_mfma_f32_16x16x32_bf16 a[8:11], a[96:99], v[8:11], a[8:11]
    v_mfma_f32_16x16x32_bf16 a[12:15], a[96:99], v[12:15], a[12:15]
    v_mfma_f32_16x16x32_bf16 a[124:127], a[96:99], a[112:115], a[124:127]
    ds_read_b64_tr_b16 a[96:97], v242 offset:12288
    v_mfma_f32_16x16x32_bf16 a[16:19], a[100:103], v[0:3], a[16:19]
    ds_read_b64_tr_b16 a[98:99], v242 offset:12800
    v_mfma_f32_16x16x32_bf16 a[20:23], a[100:103], v[4:7], a[20:23]
    ds_read_b64_tr_b16 a[140:141], v234 offset:24576
    v_mfma_f32_16x16x32_bf16 a[24:27], a[100:103], v[8:11], a[24:27]
    v_mfma_f32_16x16x32_bf16 a[28:31], a[100:103], v[12:15], a[28:31]
    v_mfma_f32_16x16x32_bf16 a[128:131], a[100:103], a[112:115], a[128:131]
    ds_read_b64_tr_b16 a[100:101], v243 offset:12288
    ds_read_b64_tr_b16 a[142:143], v234 offset:28672
    v_mfma_f32_16x16x32_bf16 a[32:35], a[104:107], v[0:3], a[32:35]
    ds_read_b64_tr_b16 a[102:103], v243 offset:12800
    v_mfma_f32_16x16x32_bf16 a[36:39], a[104:107], v[4:7], a[36:39]
    v_mfma_f32_16x16x32_bf16 a[40:43], a[104:107], v[8:11], a[40:43]
    ds_read_b64_tr_b16 a[144:145], v234 offset:24584
    v_mfma_f32_16x16x32_bf16 a[44:47], a[104:107], v[12:15], a[44:47]
    ds_read_b64_tr_b16 a[104:105], v244 offset:12288
    v_mfma_f32_16x16x32_bf16 a[48:51], a[108:111], v[0:3], a[48:51]
    ds_read_b64_tr_b16 a[106:107], v244 offset:12800
    v_mfma_f32_16x16x32_bf16 a[52:55], a[108:111], v[4:7], a[52:55]
    ds_read_b64_tr_b16 a[146:147], v234 offset:28680
    v_mfma_f32_16x16x32_bf16 a[56:59], a[108:111], v[8:11], a[56:59]
    v_mfma_f32_16x16x32_bf16 a[60:63], a[108:111], v[12:15], a[60:63]
    ds_read_b64_tr_b16 a[108:109], v245 offset:12288
    v_mfma_f32_16x16x32_bf16 v[192:195], a[112:115], v[0:3], v[192:195]
    ds_read_b64_tr_b16 a[110:111], v245 offset:12800
    v_mfma_f32_16x16x32_bf16 v[208:211], v[0:3], v[0:3], v[208:211]
    v_mfma_f32_16x16x32_bf16 v[196:199], a[112:115], v[4:7], v[196:199]
    v_mfma_f32_16x16x32_bf16 v[212:215], v[4:7], v[4:7], v[212:215]
    v_mfma_f32_16x16x32_bf16 v[200:203], a[112:115], v[8:11], v[200:203]
    v_mfma_f32_16x16x32_bf16 v[216:219], v[8:11], v[8:11], v[216:219]
    v_mfma_f32_16x16x32_bf16 v[204:207], a[112:115], v[12:15], v[204:207]
    v_mfma_f32_16x16x32_bf16 v[220:223], v[12:15], v[12:15], v[220:223]
    s_waitcnt vmcnt(2) lgkmcnt(0)
    s_barrier
    v_mfma_f32_16x16x32_bf16 v[64:67], a[64:67], v[16:19], v[64:67]
    v_mfma_f32_16x16x32_bf16 v[68:71], a[64:67], v[20:23], v[68:71]
    v_add_u32 v234, 0x10000, v234
    v_mfma_f32_16x16x32_bf16 v[72:75], a[64:67], v[24:27], v[72:75]
    ds_read_b128 v[32:35], v236 offset:49152
    v_mfma_f32_16x16x32_bf16 v[76:79], a[64:67], v[28:31], v[76:79]
    v_mfma_f32_16x16x32_bf16 v[224:227], a[64:67], a[112:115], v[224:227]
    ds_read_b64_tr_b16 a[64:65], v238 offset:24576
    v_mfma_f32_16x16x32_bf16 v[80:83], a[68:71], v[16:19], v[80:83]
    s_add_u32 s85, s84, 1
    s_lshl_b32 s85, s85, 13
    s_add_u32 s85, s85, s38
    s_nop 0
    ds_read_b64_tr_b16 a[66:67], v238 offset:25600
    ds_read_b128 v[36:39], v236 offset:51200
    v_mfma_f32_16x16x32_bf16 v[84:87], a[68:71], v[20:23], v[84:87]
    buffer_store_dwordx4 a[140:143], v235, s[92:95], s85 offen sc1
    v_mfma_f32_16x16x32_bf16 v[88:91], a[68:71], v[24:27], v[88:91]
    v_mfma_f32_16x16x32_bf16 v[92:95], a[68:71], v[28:31], v[92:95]
    ds_read_b128 v[40:43], v236 offset:53248
    v_mfma_f32_16x16x32_bf16 v[228:231], a[68:71], a[112:115], v[228:231]
    ds_read_b64_tr_b16 a[68:69], v238 offset:24584
    v_mfma_f32_16x16x32_bf16 v[96:99], a[72:75], v[16:19], v[96:99]
    ds_read_b64_tr_b16 a[70:71], v238 offset:25608
    v_mfma_f32_16x16x32_bf16 v[100:103], a[72:75], v[20:23], v[100:103]
    buffer_store_dwordx4 a[144:147], v235, s[92:95], s85 offen offset:1024 sc1
    ds_read_b128 v[44:47], v236 offset:55296
    v_mfma_f32_16x16x32_bf16 v[104:107], a[72:75], v[24:27], v[104:107]
    v_mfma_f32_16x16x32_bf16 v[108:111], a[72:75], v[28:31], v[108:111]
    ds_read_b64_tr_b16 a[72:73], v239 offset:24576
    v_mfma_f32_16x16x32_bf16 v[112:115], a[76:79], v[16:19], v[112:115]
    ds_read_b64_tr_b16 a[74:75], v239 offset:25600
    ds_read_b128 v[48:51], v237 offset:49152
    v_mfma_f32_16x16x32_bf16 v[116:119], a[76:79], v[20:23], v[116:119]
    s_mov_b32 s39, 0x8000
    s_add_u32 m0, s37, 0x8000
    v_mfma_f32_16x16x32_bf16 v[120:123], a[76:79], v[24:27], v[120:123]
    buffer_load_dwordx4 v252, s[8:11], s39 offen lds
    v_mfma_f32_16x16x32_bf16 v[124:127], a[76:79], v[28:31], v[124:127]
    ds_read_b64_tr_b16 a[76:77], v239 offset:24584
    ds_read_b128 v[52:55], v237 offset:51200
    v_mfma_f32_16x16x32_bf16 v[128:131], a[80:83], v[16:19], v[128:131]
    ds_read_b64_tr_b16 a[78:79], v239 offset:25608
    v_mfma_f32_16x16x32_bf16 v[132:135], a[80:83], v[20:23], v[132:135]
    v_mfma_f32_16x16x32_bf16 v[136:139], a[80:83], v[24:27], v[136:139]
    s_add_u32 m0, s37, 0x9000
    ds_read_b128 v[56:59], v237 offset:53248
    v_mfma_f32_16x16x32_bf16 v[140:143], a[80:83], v[28:31], v[140:143]
    buffer_load_dwordx4 v253, s[8:11], s39 offen lds
    ds_read_b64_tr_b16 a[80:81], v240 offset:24576
    v_mfma_f32_16x16x32_bf16 v[144:147], a[84:87], v[16:19], v[144:147]
    ds_read_b64_tr_b16 a[82:83], v240 offset:25600
    v_mfma_f32_16x16x32_bf16 v[148:151], a[84:87], v[20:23], v[148:151]
    ds_read_b128 v[60:63], v237 offset:55296
    v_mfma_f32_16x16x32_bf16 v[152:155], a[84:87], v[24:27], v[152:155]
    v_mfma_f32_16x16x32_bf16 v[156:159], a[84:87], v[28:31], v[156:159]
    s_mov_b32 s39, 0xa000
    s_add_u32 m0, s37, 0xa000
    ds_read_b64_tr_b16 a[84:85], v240 offset:24584
    v_mfma_f32_16x16x32_bf16 v[160:163], a[88:91], v[16:19], v[160:163]
    buffer_load_dwordx4 v252, s[8:11], s39 offen lds
    ds_read_b64_tr_b16 a[86:87], v240 offset:25608
    v_mfma_f32_16x16x32_bf16 v[164:167], a[88:91], v[20:23], v[164:167]
    v_mfma_f32_16x16x32_bf16 v[168:171], a[88:91], v[24:27], v[168:171]
    v_mfma_f32_16x16x32_bf16 v[172:175], a[88:91], v[28:31], v[172:175]
    ds_read_b64_tr_b16 a[88:89], v241 offset:24576
    v_mfma_f32_16x16x32_bf16 v[176:179], a[92:95], v[16:19], v[176:179]
    s_add_u32 m0, s37, 0xb000
    ds_read_b64_tr_b16 a[90:91], v241 offset:25600
    v_mfma_f32_16x16x32_bf16 v[180:183], a[92:95], v[20:23], v[180:183]
    buffer_load_dwordx4 v253, s[8:11], s39 offen lds
    v_mfma_f32_16x16x32_bf16 v[184:187], a[92:95], v[24:27], v[184:187]
    v_mfma_f32_16x16x32_bf16 v[188:191], a[92:95], v[28:31], v[188:191]
    ds_read_b64_tr_b16 a[92:93], v241 offset:24584
    v_mfma_f32_16x16x32_bf16 a[0:3], a[96:99], v[16:19], a[0:3]
    ds_read_b64_tr_b16 a[94:95], v241 offset:25608
    v_mfma_f32_16x16x32_bf16 a[4:7], a[96:99], v[20:23], a[4:7]
    v_mfma_f32_16x16x32_bf16 a[8:11], a[96:99], v[24:27], a[8:11]
    v_mfma_f32_16x16x32_bf16 a[12:15], a[96:99], v[28:31], a[12:15]
    v_mfma_f32_16x16x32_bf16 a[124:127], a[96:99], a[112:115], a[124:127]
    ds_read_b64_tr_b16 a[96:97], v242 offset:24576
    v_mfma_f32_16x16x32_bf16 a[16:19], a[100:103], v[16:19], a[16:19]
    ds_read_b64_tr_b16 a[98:99], v242 offset:25088
    v_mfma_f32_16x16x32_bf16 a[20:23], a[100:103], v[20:23], a[20:23]
    ds_read_b64_tr_b16 a[132:133], v234 offset:8192
    v_mfma_f32_16x16x32_bf16 a[24:27], a[100:103], v[24:27], a[24:27]
    v_mfma_f32_16x16x32_bf16 a[28:31], a[100:103], v[28:31], a[28:31]
    v_mfma_f32_16x16x32_bf16 a[128:131], a[100:103], a[112:115], a[128:131]
    ds_read_b64_tr_b16 a[100:101], v243 offset:24576
    ds_read_b64_tr_b16 a[134:135], v234 offset:12288
    v_mfma_f32_16x16x32_bf16 a[32:35], a[104:107], v[16:19], a[32:35]
    ds_read_b64_tr_b16 a[102:103], v243 offset:25088
    v_mfma_f32_16x16x32_bf16 a[36:39], a[104:107], v[20:23], a[36:39]
    v_mfma_f32_16x16x32_bf16 a[40:43], a[104:107], v[24:27], a[40:43]
    ds_read_b64_tr_b16 a[136:137], v234 offset:8200
    v_mfma_f32_16x16x32_bf16 a[44:47], a[104:107], v[28:31], a[44:47]
    ds_read_b64_tr_b16 a[104:105], v244 offset:24576
    v_mfma_f32_16x16x32_bf16 a[48:51], a[108:111], v[16:19], a[48:51]
    ds_read_b64_tr_b16 a[106:107], v244 offset:25088
    v_mfma_f32_16x16x32_bf16 a[52:55], a[108:111], v[20:23], a[52:55]
    ds_read_b64_tr_b16 a[138:139], v234 offset:12296
    v_mfma_f32_16x16x32_bf16 a[56:59], a[108:111], v[24:27], a[56:59]
    v_mfma_f32_16x16x32_bf16 a[60:63], a[108:111], v[28:31], a[60:63]
    ds_read_b64_tr_b16 a[108:109], v245 offset:24576
    v_mfma_f32_16x16x32_bf16 v[192:195], a[112:115], v[16:19], v[192:195]
    ds_read_b64_tr_b16 a[110:111], v245 offset:25088
    v_mfma_f32_16x16x32_bf16 v[208:211], v[16:19], v[16:19], v[208:211]
    v_mfma_f32_16x16x32_bf16 v[196:199], a[112:115], v[20:23], v[196:199]
    v_mfma_f32_16x16x32_bf16 v[212:215], v[20:23], v[20:23], v[212:215]
    v_mfma_f32_16x16x32_bf16 v[200:203], a[112:115], v[24:27], v[200:203]
    v_mfma_f32_16x16x32_bf16 v[216:219], v[24:27], v[24:27], v[216:219]
    v_mfma_f32_16x16x32_bf16 v[204:207], a[112:115], v[28:31], v[204:207]
    v_mfma_f32_16x16x32_bf16 v[220:223], v[28:31], v[28:31], v[220:223]
    s_waitcnt vmcnt(12) lgkmcnt(0)
    s_barrier
    v_mfma_f32_16x16x32_bf16 v[64:67], a[64:67], v[32:35], v[64:67]
    v_mfma_f32_16x16x32_bf16 v[68:71], a[64:67], v[36:39], v[68:71]
    v_mfma_f32_16x16x32_bf16 v[72:75], a[64:67], v[40:43], v[72:75]
    v_mfma_f32_16x16x32_bf16 v[76:79], a[64:67], v[44:47], v[76:79]
    v_mfma_f32_16x16x32_bf16 v[224:227], a[64:67], a[112:115], v[224:227]
    ds_read_b64_tr_b16 a[64:65], v238 offset:36864
    v_mfma_f32_16x16x32_bf16 v[80:83], a[68:71], v[32:35], v[80:83]
    s_add_u32 s85, s84, 2
    s_lshl_b32 s85, s85, 13
    s_add_u32 s85, s85, s38
    s_nop 0
    ds_read_b64_tr_b16 a[66:67], v238 offset:37888
    v_mfma_f32_16x16x32_bf16 v[84:87], a[68:71], v[36:39], v[84:87]
    buffer_store_dwordx4 a[132:135], v235, s[92:95], s85 offen sc1
    v_mfma_f32_16x16x32_bf16 v[88:91], a[68:71], v[40:43], v[88:91]
    v_mfma_f32_16x16x32_bf16 v[92:95], a[68:71], v[44:47], v[92:95]
    v_mfma_f32_16x16x32_bf16 v[228:231], a[68:71], a[112:115], v[228:231]
    ds_read_b64_tr_b16 a[68:69], v238 offset:36872
    v_mfma_f32_16x16x32_bf16 v[96:99], a[72:75], v[32:35], v[96:99]
    ds_read_b64_tr_b16 a[70:71], v238 offset:37896
    v_mfma_f32_16x16x32_bf16 v[100:103], a[72:75], v[36:39], v[100:103]
    buffer_store_dwordx4 a[136:139], v235, s[92:95], s85 offen offset:1024 sc1
    v_mfma_f32_16x16x32_bf16 v[104:107], a[72:75], v[40:43], v[104:107]
    v_mfma_f32_16x16x32_bf16 v[108:111], a[72:75], v[44:47], v[108:111]
    ds_read_b64_tr_b16 a[72:73], v239 offset:36864
    v_mfma_f32_16x16x32_bf16 v[112:115], a[76:79], v[32:35], v[112:115]
    ds_read_b64_tr_b16 a[74:75], v239 offset:37888
    v_mfma_f32_16x16x32_bf16 v[116:119], a[76:79], v[36:39], v[116:119]
    s_mov_b32 s39, 0x4000
    s_add_u32 m0, s37, 0x4000
    v_mfma_f32_16x16x32_bf16 v[120:123], a[76:79], v[40:43], v[120:123]
    buffer_load_dwordx4 v252, s[8:11], s39 offen lds
    v_mfma_f32_16x16x32_bf16 v[124:127], a[76:79], v[44:47], v[124:127]
    ds_read_b64_tr_b16 a[76:77], v239 offset:36872
    v_mfma_f32_16x16x32_bf16 v[128:131], a[80:83], v[32:35], v[128:131]
    ds_read_b64_tr_b16 a[78:79], v239 offset:37896
    v_mfma_f32_16x16x32_bf16 v[132:135], a[80:83], v[36:39], v[132:135]
    v_mfma_f32_16x16x32_bf16 v[136:139], a[80:83], v[40:43], v[136:139]
    s_add_u32 m0, s37, 0x5000
    v_mfma_f32_16x16x32_bf16 v[140:143], a[80:83], v[44:47], v[140:143]
    buffer_load_dwordx4 v253, s[8:11], s39 offen lds
    ds_read_b64_tr_b16 a[80:81], v240 offset:36864
    v_mfma_f32_16x16x32_bf16 v[144:147], a[84:87], v[32:35], v[144:147]
    ds_read_b64_tr_b16 a[82:83], v240 offset:37888
    v_mfma_f32_16x16x32_bf16 v[148:151], a[84:87], v[36:39], v[148:151]
    v_mfma_f32_16x16x32_bf16 v[152:155], a[84:87], v[40:43], v[152:155]
    v_mfma_f32_16x16x32_bf16 v[156:159], a[84:87], v[44:47], v[156:159]
    s_mov_b32 s39, 0x8000
    s_add_u32 m0, s38, 0x12000
    ds_read_b64_tr_b16 a[84:85], v240 offset:36872
    v_mfma_f32_16x16x32_bf16 v[160:163], a[88:91], v[32:35], v[160:163]
    buffer_load_dwordx4 v254, s[12:15], s39 offen lds
    ds_read_b64_tr_b16 a[86:87], v240 offset:37896
    v_mfma_f32_16x16x32_bf16 v[164:167], a[88:91], v[36:39], v[164:167]
    v_mfma_f32_16x16x32_bf16 v[168:171], a[88:91], v[40:43], v[168:171]
    v_mfma_f32_16x16x32_bf16 v[172:175], a[88:91], v[44:47], v[172:175]
    ds_read_b64_tr_b16 a[88:89], v241 offset:36864
    v_mfma_f32_16x16x32_bf16 v[176:179], a[92:95], v[32:35], v[176:179]
    ds_read_b64_tr_b16 a[90:91], v241 offset:37888
    v_mfma_f32_16x16x32_bf16 v[180:183], a[92:95], v[36:39], v[180:183]
    buffer_load_dwordx4 v255, s[12:15], s39 offen offset:1024 lds
    v_mfma_f32_16x16x32_bf16 v[184:187], a[92:95], v[40:43], v[184:187]
    v_mfma_f32_16x16x32_bf16 v[188:191], a[92:95], v[44:47], v[188:191]
    ds_read_b64_tr_b16 a[92:93], v241 offset:36872
    v_mfma_f32_16x16x32_bf16 a[0:3], a[96:99], v[32:35], a[0:3]
    ds_read_b64_tr_b16 a[94:95], v241 offset:37896
    v_mfma_f32_16x16x32_bf16 a[4:7], a[96:99], v[36:39], a[4:7]
    s_mov_b32 s39, 0xa000
    s_add_u32 m0, s38, 0x14000
    v_mfma_f32_16x16x32_bf16 a[8:11], a[96:99], v[40:43], a[8:11]
    buffer_load_dwordx4 v254, s[12:15], s39 offen lds
    v_mfma_f32_16x16x32_bf16 a[12:15], a[96:99], v[44:47], a[12:15]
    v_mfma_f32_16x16x32_bf16 a[124:127], a[96:99], a[112:115], a[124:127]
    ds_read_b64_tr_b16 a[96:97], v242 offset:36864
    v_mfma_f32_16x16x32_bf16 a[16:19], a[100:103], v[32:35], a[16:19]
    ds_read_b64_tr_b16 a[98:99], v242 offset:37376
    v_mfma_f32_16x16x32_bf16 a[20:23], a[100:103], v[36:39], a[20:23]
    v_mfma_f32_16x16x32_bf16 a[24:27], a[100:103], v[40:43], a[24:27]
    buffer_load_dwordx4 v255, s[12:15], s39 offen offset:1024 lds
    v_mfma_f32_16x16x32_bf16 a[28:31], a[100:103], v[44:47], a[28:31]
    v_mfma_f32_16x16x32_bf16 a[128:131], a[100:103], a[112:115], a[128:131]
    ds_read_b64_tr_b16 a[100:101], v243 offset:36864
    v_mfma_f32_16x16x32_bf16 a[32:35], a[104:107], v[32:35], a[32:35]
    ds_read_b64_tr_b16 a[102:103], v243 offset:37376
    v_mfma_f32_16x16x32_bf16 a[36:39], a[104:107], v[36:39], a[36:39]
    v_mfma_f32_16x16x32_bf16 a[40:43], a[104:107], v[40:43], a[40:43]
    v_mfma_f32_16x16x32_bf16 a[44:47], a[104:107], v[44:47], a[44:47]
    ds_read_b64_tr_b16 a[104:105], v244 offset:36864
    v_mfma_f32_16x16x32_bf16 a[48:51], a[108:111], v[32:35], a[48:51]
    ds_read_b64_tr_b16 a[106:107], v244 offset:37376
    v_mfma_f32_16x16x32_bf16 a[52:55], a[108:111], v[36:39], a[52:55]
    v_mfma_f32_16x16x32_bf16 a[56:59], a[108:111], v[40:43], a[56:59]
    v_mfma_f32_16x16x32_bf16 a[60:63], a[108:111], v[44:47], a[60:63]
    ds_read_b64_tr_b16 a[108:109], v245 offset:36864
    v_mfma_f32_16x16x32_bf16 v[192:195], a[112:115], v[32:35], v[192:195]
    ds_read_b64_tr_b16 a[110:111], v245 offset:37376
    v_mfma_f32_16x16x32_bf16 v[208:211], v[32:35], v[32:35], v[208:211]
    v_mfma_f32_16x16x32_bf16 v[196:199], a[112:115], v[36:39], v[196:199]
    v_mfma_f32_16x16x32_bf16 v[212:215], v[36:39], v[36:39], v[212:215]
    v_mfma_f32_16x16x32_bf16 v[200:203], a[112:115], v[40:43], v[200:203]
    v_mfma_f32_16x16x32_bf16 v[216:219], v[40:43], v[40:43], v[216:219]
    v_mfma_f32_16x16x32_bf16 v[204:207], a[112:115], v[44:47], v[204:207]
    v_mfma_f32_16x16x32_bf16 v[220:223], v[44:47], v[44:47], v[220:223]
    s_waitcnt vmcnt(16) lgkmcnt(0)
    s_barrier
    v_mfma_f32_16x16x32_bf16 v[64:67], a[64:67], v[48:51], v[64:67]
    v_mfma_f32_16x16x32_bf16 v[68:71], a[64:67], v[52:55], v[68:71]
    v_mfma_f32_16x16x32_bf16 v[72:75], a[64:67], v[56:59], v[72:75]
    v_mfma_f32_16x16x32_bf16 v[76:79], a[64:67], v[60:63], v[76:79]
    v_mfma_f32_16x16x32_bf16 v[224:227], a[64:67], a[112:115], v[224:227]
    v_mfma_f32_16x16x32_bf16 v[80:83], a[68:71], v[48:51], v[80:83]
    s_mov_b32 s39, 0x6000
    s_add_u32 m0, s37, 0x6000
    v_mfma_f32_16x16x32_bf16 v[84:87], a[68:71], v[52:55], v[84:87]
    buffer_load_dwordx4 v252, s[8:11], s39 offen lds
    v_mfma_f32_16x16x32_bf16 v[88:91], a[68:71], v[56:59], v[88:91]
    v_mfma_f32_16x16x32_bf16 v[92:95], a[68:71], v[60:63], v[92:95]
    v_mfma_f32_16x16x32_bf16 v[228:231], a[68:71], a[112:115], v[228:231]
    v_mfma_f32_16x16x32_bf16 v[96:99], a[72:75], v[48:51], v[96:99]
    s_add_u32 m0, s37, 0x7000
    v_mfma_f32_16x16x32_bf16 v[100:103], a[72:75], v[52:55], v[100:103]
    buffer_load_dwordx4 v253, s[8:11], s39 offen lds
    v_mfma_f32_16x16x32_bf16 v[104:107], a[72:75], v[56:59], v[104:107]
    v_mfma_f32_16x16x32_bf16 v[108:111], a[72:75], v[60:63], v[108:111]
    v_mfma_f32_16x16x32_bf16 v[112:115], a[76:79], v[48:51], v[112:115]
    v_mfma_f32_16x16x32_bf16 v[116:119], a[76:79], v[52:55], v[116:119]
    s_mov_b32 s39, 0xc000
    s_add_u32 m0, s37, 0xc000
    v_mfma_f32_16x16x32_bf16 v[120:123], a[76:79], v[56:59], v[120:123]
    buffer_load_dwordx4 v252, s[8:11], s39 offen lds
    v_mfma_f32_16x16x32_bf16 v[124:127], a[76:79], v[60:63], v[124:127]
    v_mfma_f32_16x16x32_bf16 v[128:131], a[80:83], v[48:51], v[128:131]
    v_mfma_f32_16x16x32_bf16 v[132:135], a[80:83], v[52:55], v[132:135]
    v_mfma_f32_16x16x32_bf16 v[136:139], a[80:83], v[56:59], v[136:139]
    s_add_u32 m0, s37, 0xd000
    v_mfma_f32_16x16x32_bf16 v[140:143], a[80:83], v[60:63], v[140:143]
    buffer_load_dwordx4 v253, s[8:11], s39 offen lds
    v_mfma_f32_16x16x32_bf16 v[144:147], a[84:87], v[48:51], v[144:147]
    v_mfma_f32_16x16x32_bf16 v[148:151], a[84:87], v[52:55], v[148:151]
    v_mfma_f32_16x16x32_bf16 v[152:155], a[84:87], v[56:59], v[152:155]
    v_mfma_f32_16x16x32_bf16 v[156:159], a[84:87], v[60:63], v[156:159]
    s_mov_b32 s39, 0xe000
    s_add_u32 m0, s37, 0xe000
    v_mfma_f32_16x16x32_bf16 v[160:163], a[88:91], v[48:51], v[160:163]
    buffer_load_dwordx4 v252, s[8:11], s39 offen lds
    v_mfma_f32_16x16x32_bf16 v[164:167], a[88:91], v[52:55], v[164:167]
    v_mfma_f32_16x16x32_bf16 v[168:171], a[88:91], v[56:59], v[168:171]
    v_mfma_f32_16x16x32_bf16 v[172:175], a[88:91], v[60:63], v[172:175]
    v_mfma_f32_16x16x32_bf16 v[176:179], a[92:95], v[48:51], v[176:179]
    s_add_u32 m0, s37, 0xf000
    v_mfma_f32_16x16x32_bf16 v[180:183], a[92:95], v[52:55], v[180:183]
    buffer_load_dwordx4 v253, s[8:11], s39 offen lds
    v_mfma_f32_16x16x32_bf16 v[184:187], a[92:95], v[56:59], v[184:187]
    v_mfma_f32_16x16x32_bf16 v[188:191], a[92:95], v[60:63], v[188:191]
    v_mfma_f32_16x16x32_bf16 a[0:3], a[96:99], v[48:51], a[0:3]
    v_mfma_f32_16x16x32_bf16 a[4:7], a[96:99], v[52:55], a[4:7]
    v_mfma_f32_16x16x32_bf16 a[8:11], a[96:99], v[56:59], a[8:11]
    v_mfma_f32_16x16x32_bf16 a[12:15], a[96:99], v[60:63], a[12:15]
    v_mfma_f32_16x16x32_bf16 a[124:127], a[96:99], a[112:115], a[124:127]
    v_mfma_f32_16x16x32_bf16 a[16:19], a[100:103], v[48:51], a[16:19]
    v_mfma_f32_16x16x32_bf16 a[20:23], a[100:103], v[52:55], a[20:23]
    v_mfma_f32_16x16x32_bf16 a[24:27], a[100:103], v[56:59], a[24:27]
    v_mfma_f32_16x16x32_bf16 a[28:31], a[100:103], v[60:63], a[28:31]
    v_mfma_f32_16x16x32_bf16 a[128:131], a[100:103], a[112:115], a[128:131]
    v_mfma_f32_16x16x32_bf16 a[32:35], a[104:107], v[48:51], a[32:35]
    v_mfma_f32_16x16x32_bf16 a[36:39], a[104:107], v[52:55], a[36:39]
    v_mfma_f32_16x16x32_bf16 a[40:43], a[104:107], v[56:59], a[40:43]
    v_mfma_f32_16x16x32_bf16 a[44:47], a[104:107], v[60:63], a[44:47]
    v_mfma_f32_16x16x32_bf16 a[48:51], a[108:111], v[48:51], a[48:51]
    v_mfma_f32_16x16x32_bf16 a[52:55], a[108:111], v[52:55], a[52:55]
    v_mfma_f32_16x16x32_bf16 a[56:59], a[108:111], v[56:59], a[56:59]
    v_mfma_f32_16x16x32_bf16 a[60:63], a[108:111], v[60:63], a[60:63]
    v_mfma_f32_16x16x32_bf16 v[192:195], a[112:115], v[48:51], v[192:195]
    v_mfma_f32_16x16x32_bf16 v[208:211], v[48:51], v[48:51], v[208:211]
    v_mfma_f32_16x16x32_bf16 v[196:199], a[112:115], v[52:55], v[196:199]
    v_mfma_f32_16x16x32_bf16 v[212:215], v[52:55], v[52:55], v[212:215]
    v_mfma_f32_16x16x32_bf16 v[200:203], a[112:115], v[56:59], v[200:203]
    v_mfma_f32_16x16x32_bf16 v[216:219], v[56:59], v[56:59], v[216:219]
    v_mfma_f32_16x16x32_bf16 v[204:207], a[112:115], v[60:63], v[204:207]
    v_mfma_f32_16x16x32_bf16 v[220:223], v[60:63], v[60:63], v[220:223]
    s_add_u32 s32, s52, 0x2800000
    s_addc_u32 s33, s53, 0
    s_nop 0
    s_mov_b32 s34, 0x2000
    s_mov_b32 s35, 0x20000
    s_lshl_b32 s44, s2, 8
    s_mov_b64 s[46:47], exec
    s_mov_b64 exec, 1
    v_mov_b32 v32, 0
    buffer_store_dword v32, off, s[32:35], s44 sc1
    s_mov_b64 exec, s[46:47]
    s_nop 15
    v_lshrrev_b32 v32, 4, v250
    v_lshlrev_b32 v32, 4, v32
    v_add_u32 v32, 0x1c000, v32
    s_lshl_b32 s44, s36, 7
    v_add_u32 v33, s44, v32
    s_and_b32 s44, s36, 2
    s_lshl_b32 s44, s44, 6
    v_add_u32 v34, s44, v32
    s_waitcnt lgkmcnt(0)
    s_barrier
    s_mov_b64 s[44:45], exec
    s_mov_b32 exec_lo, 0x00010001
    s_mov_b32 exec_hi, 0x00010001
    ds_write_b128 v33, v[224:227] offset:0
    ds_write_b128 v33, v[228:231] offset:64
    ds_write_b128 v34, a[124:127] offset:512
    ds_write_b128 v34, a[128:131] offset:576
    s_mov_b64 exec, s[44:45]
    v_and_b32 v32, 3, v250
    v_lshrrev_b32 v33, 2, v250
    v_and_b32 v33, 3, v33
    v_lshrrev_b32_e64 v34, 4, v250
    v_cmp_eq_u32 s[44:45], v33, v34
    v_cmp_eq_u32 s[46:47], 1, v32
    v_cmp_eq_u32 s[48:49], 2, v32
    v_cmp_eq_u32 s[50:51], 3, v32
    s_nop 1
    s_nop 0
    v_cndmask_b32 v0, v208, v209, s[46:47]
    v_cndmask_b32 v1, v212, v213, s[46:47]
    v_cndmask_b32 v2, v216, v217, s[46:47]
    v_cndmask_b32 v3, v220, v221, s[46:47]
    v_cndmask_b32 v0, v0, v210, s[48:49]
    v_cndmask_b32 v1, v1, v214, s[48:49]
    v_cndmask_b32 v2, v2, v218, s[48:49]
    v_cndmask_b32 v3, v3, v222, s[48:49]
    v_cndmask_b32 v0, v0, v211, s[50:51]
    v_cndmask_b32 v1, v1, v215, s[50:51]
    v_cndmask_b32 v2, v2, v219, s[50:51]
    v_cndmask_b32 v3, v3, v223, s[50:51]
    v_cndmask_b32 v0, 0, v0, s[44:45]
    v_cndmask_b32 v1, 0, v1, s[44:45]
    v_cndmask_b32 v2, 0, v2, s[44:45]
    v_cndmask_b32 v3, 0, v3, s[44:45]
    v_mul_f32 v8, 0x3b000000, v192
    v_mul_f32 v9, 0x3b000000, v196
    v_mul_f32 v10, 0x3b000000, v200
    v_mul_f32 v11, 0x3b000000, v204
    v_mov_b32 v4, v0
    v_mov_b32 v5, v1
    v_mov_b32 v6, v2
    v_mov_b32 v7, v3
    v_permlane32_swap_b32 v0, v4
    v_permlane32_swap_b32 v1, v5
    v_permlane32_swap_b32 v2, v6
    v_permlane32_swap_b32 v3, v7
    v_add_f32 v0, v0, v4
    v_add_f32 v1, v1, v5
    v_add_f32 v2, v2, v6
    v_add_f32 v3, v3, v7
    v_mov_b32 v4, v0
    v_mov_b32 v5, v1
    v_mov_b32 v6, v2
    v_mov_b32 v7, v3
    v_permlane16_swap_b32 v0, v4
    v_permlane16_swap_b32 v1, v5
    v_permlane16_swap_b32 v2, v6
    v_permlane16_swap_b32 v3, v7
    v_add_f32 v0, v0, v4
    v_add_f32 v1, v1, v5
    v_add_f32 v2, v2, v6
    v_add_f32 v3, v3, v7
    v_mul_f32 v0, 0x3b000000, v0
    v_mul_f32 v1, 0x3b000000, v1
    v_mul_f32 v2, 0x3b000000, v2
    v_mul_f32 v3, 0x3b000000, v3
    v_fma_f32 v0, -v8, v8, v0
    v_fma_f32 v1, -v9, v9, v1
    v_fma_f32 v2, -v10, v10, v2
    v_fma_f32 v3, -v11, v11, v3
    v_max_f32 v0, 0, v0
    v_max_f32 v1, 0, v1
    v_max_f32 v2, 0, v2
    v_max_f32 v3, 0, v3
    v_add_f32 v0, 0x3727c5ac, v0
    v_add_f32 v1, 0x3727c5ac, v1
    v_add_f32 v2, 0x3727c5ac, v2
    v_add_f32 v3, 0x3727c5ac, v3
    v_rsq_f32 v44, v0
    v_rsq_f32 v46, v1
    v_rsq_f32 v48, v2
    v_rsq_f32_e64 v50, v3
    s_nop 0
    v_mul_f32 v36, 0x3e0293ee, v44
    v_mul_f32 v38, 0x3e0293ee, v46
    v_mul_f32 v40, 0x3e0293ee, v48
    v_mul_f32 v42, 0x3e0293ee, v50
    v_mul_f32_e64 v52, -v8, v44
    v_mul_f32_e64 v54, -v9, v46
    v_mul_f32_e64 v56, -v10, v48
    v_mul_f32_e64 v58, -v11, v50
    v_mul_f32_e64 v240, -v8, v36
    v_mul_f32_e64 v242, -v9, v38
    v_mul_f32_e64 v244, -v10, v40
    v_mul_f32_e64 v246, -v11, v42
    s_waitcnt lgkmcnt(0)
    s_barrier
    s_mov_b32 s39, 0xc000
    s_add_u32 m0, s38, 0x16000
    s_nop 0
    s_nop 0
    buffer_load_dwordx4 v254, s[12:15], s39 offen lds
    buffer_load_dwordx4 v255, s[12:15], s39 offen offset:1024 lds
    s_mov_b32 s39, 0xe000
    s_add_u32 m0, s38, 0x18000
    s_nop 0
    s_nop 0
    buffer_load_dwordx4 v254, s[12:15], s39 offen lds
    buffer_load_dwordx4 v255, s[12:15], s39 offen offset:1024 lds
    v_lshrrev_b32 v32, 4, v250
    v_lshlrev_b32 v32, 4, v32
    v_add_u32 v32, 0x1c000, v32
    s_lshl_b32 s44, s36, 7
    v_xor_b32 v33, s44, v32
    s_and_b32 s44, s36, 2
    s_lshl_b32 s44, s44, 6
    v_xor_b32 v34, s44, v32
    v_xor_b32 v35, 0x0, v33
    ds_read_b128 v[192:195], v35 offset:0
    ds_read_b128 v[196:199], v35 offset:64
    v_xor_b32 v35, 0x80, v33
    ds_read_b128 v[200:203], v35 offset:0
    ds_read_b128 v[204:207], v35 offset:64
    v_xor_b32 v35, 0x100, v33
    ds_read_b128 v[208:211], v35 offset:0
    ds_read_b128 v[212:215], v35 offset:64
    v_xor_b32 v35, 0x180, v33
    ds_read_b128 v[216:219], v35 offset:0
    ds_read_b128 v[220:223], v35 offset:64
    v_xor_b32_e64 v35, 0x0, v34
    ds_read_b128 v[224:227], v35 offset:512
    v_xor_b32_e64 v35, 0x40, v34
    ds_read_b128 v[228:231], v35 offset:512
    v_xor_b32 v35, 0x80, v34
    ds_read_b128 v[232:235], v35 offset:512
    v_xor_b32 v35, 0xc0, v34
    ds_read_b128 v[236:239], v35 offset:512
    s_waitcnt lgkmcnt(0)
    v_mov_b32 v28, 0
    v_mov_b32 v29, 0
    v_mov_b32 v30, 0
    v_mov_b32 v31, 0
    s_lshl_b32 s44, s43, 4
    s_lshl_b32 s45, s36, 2
    s_add_u32 s44, s44, s45
    s_mul_i32 s44, s44, 184
    s_lshl_b32 s45, s42, 1
    s_add_u32 s44, s44, s45
    s_add_u32 s44, s44, 128
    s_lshr_b32 s45, s36, 1
    s_lshl_b32 s44, s44, 10
    s_lshl_b32 s45, s45, 10
    s_nop 0
    v_mfma_f32_32x32x16_bf16 a[64:79], v[28:31], v[28:31], 0
    v_mfma_f32_32x32x16_bf16 a[80:95], v[28:31], v[28:31], 0
    v_mfma_f32_32x32x16_bf16 a[96:111], v[28:31], v[28:31], 0
    v_mfma_f32_32x32x16_bf16 a[112:127], v[28:31], v[28:31], 0
    v_mfma_f32_32x32x16_bf16 a[192:207], v[28:31], v[28:31], 0
    v_mfma_f32_32x32x16_bf16 a[208:223], v[28:31], v[28:31], 0
    v_mfma_f32_32x32x16_bf16 a[224:239], v[28:31], v[28:31], 0
    v_mfma_f32_32x32x16_bf16 a[240:255], v[28:31], v[28:31], 0
    s_cmp_ge_u32 s42, 28
    s_cbranch_scc1 K1_NOH
    v_accvgpr_read_b32 v0, a0
    v_accvgpr_read_b32 v1, a1
    v_accvgpr_read_b32 v2, a2
    v_accvgpr_read_b32 v3, a3
    v_accvgpr_read_b32 v4, a16
    v_accvgpr_read_b32 v5, a17
    v_accvgpr_read_b32 v6, a18
    v_accvgpr_read_b32 v7, a19
    v_pk_mul_f32 v[0:1], v[0:1], v[44:45] op_sel_hi:[1,0]
    v_pk_mul_f32 v[2:3], v[2:3], v[44:45] op_sel_hi:[1,0]
    v_pk_mul_f32 v[4:5], v[4:5], v[44:45] op_sel_hi:[1,0]
    v_pk_mul_f32 v[6:7], v[6:7], v[44:45] op_sel_hi:[1,0]
    v_pk_fma_f32 v[0:1], v[224:225], v[52:53], v[0:1] op_sel_hi:[1,0,1]
    v_pk_fma_f32 v[2:3], v[226:227], v[52:53], v[2:3] op_sel_hi:[1,0,1]
    v_pk_fma_f32 v[4:5], v[228:229], v[52:53], v[4:5] op_sel_hi:[1,0,1]
    v_pk_fma_f32 v[6:7], v[230:231], v[52:53], v[6:7] op_sel_hi:[1,0,1]
    v_cvt_pk_bf16_f32 v8, v0, v1
    v_cvt_pk_bf16_f32 v9, v2, v3
    v_cvt_pk_bf16_f32 v10, v4, v5
    v_cvt_pk_bf16_f32 v11, v6, v7
    v_pk_max_i16 v8, v8, 0
    v_pk_max_i16 v9, v9, 0
    v_pk_max_i16 v10, v10, 0
    v_pk_max_i16 v11, v11, 0
    s_xor_b32 s46, s45, 0x0
    s_add_u32 s46, s46, s44
    s_add_u32 s46, s46, 0x0
    s_nop 0
    buffer_store_dwordx4 v[8:11], v251, s[28:31], s46 offen sc1
    v_accvgpr_read_b32 v12, a32
    v_accvgpr_read_b32 v13, a33
    v_accvgpr_read_b32 v14, a34
    v_accvgpr_read_b32 v15, a35
    v_accvgpr_read_b32 v16, a48
    v_accvgpr_read_b32 v17, a49
    v_accvgpr_read_b32 v18, a50
    v_accvgpr_read_b32 v19, a51
    v_pk_mul_f32 v[12:13], v[12:13], v[44:45] op_sel_hi:[1,0]
    v_pk_mul_f32 v[14:15], v[14:15], v[44:45] op_sel_hi:[1,0]
    v_pk_mul_f32 v[16:17], v[16:17], v[44:45] op_sel_hi:[1,0]
    v_pk_mul_f32 v[18:19], v[18:19], v[44:45] op_sel_hi:[1,0]
    v_pk_fma_f32 v[12:13], v[232:233], v[52:53], v[12:13] op_sel_hi:[1,0,1]
    v_pk_fma_f32 v[14:15], v[234:235], v[52:53], v[14:15] op_sel_hi:[1,0,1]
    v_pk_fma_f32 v[16:17], v[236:237], v[52:53], v[16:17] op_sel_hi:[1,0,1]
    v_pk_fma_f32 v[18:19], v[238:239], v[52:53], v[18:19] op_sel_hi:[1,0,1]
    v_cvt_pk_bf16_f32 v20, v12, v13
    v_cvt_pk_bf16_f32 v21, v14, v15
    v_cvt_pk_bf16_f32 v22, v16, v17
    v_cvt_pk_bf16_f32 v23, v18, v19
    v_pk_max_i16 v20, v20, 0
    v_pk_max_i16 v21, v21, 0
    v_pk_max_i16 v22, v22, 0
    v_pk_max_i16 v23, v23, 0
    s_xor_b32 s46, s45, 0x400
    s_add_u32 s46, s46, s44
    s_add_u32 s46, s46, 0x0
    buffer_store_dwordx4 v[20:23], v251, s[28:31], s46 offen sc1
    v_accvgpr_read_b32 v0, a4
    v_accvgpr_read_b32 v1, a5
    v_accvgpr_read_b32 v2, a6
    v_accvgpr_read_b32 v3, a7
    v_accvgpr_read_b32 v4, a20
    v_accvgpr_read_b32 v5, a21
    v_accvgpr_read_b32 v6, a22
    v_accvgpr_read_b32 v7, a23
    v_pk_mul_f32 v[0:1], v[0:1], v[46:47] op_sel_hi:[1,0]
    v_pk_mul_f32 v[2:3], v[2:3], v[46:47] op_sel_hi:[1,0]
    v_pk_mul_f32 v[4:5], v[4:5], v[46:47] op_sel_hi:[1,0]
    v_pk_mul_f32 v[6:7], v[6:7], v[46:47] op_sel_hi:[1,0]
    v_pk_fma_f32 v[0:1], v[224:225], v[54:55], v[0:1] op_sel_hi:[1,0,1]
    v_pk_fma_f32 v[2:3], v[226:227], v[54:55], v[2:3] op_sel_hi:[1,0,1]
    v_pk_fma_f32 v[4:5], v[228:229], v[54:55], v[4:5] op_sel_hi:[1,0,1]
    v_pk_fma_f32 v[6:7], v[230:231], v[54:55], v[6:7] op_sel_hi:[1,0,1]
    v_cvt_pk_bf16_f32 v8, v0, v1
    v_cvt_pk_bf16_f32 v9, v2, v3
    v_cvt_pk_bf16_f32 v10, v4, v5
    v_cvt_pk_bf16_f32 v11, v6, v7
    v_pk_max_i16 v8, v8, 0
    v_pk_max_i16 v9, v9, 0
    v_pk_max_i16 v10, v10, 0
    v_pk_max_i16 v11, v11, 0
    s_xor_b32 s46, s45, 0x0
    s_add_u32 s46, s46, s44
    s_add_u32 s46, s46, 0x2e000
    buffer_store_dwordx4 v[8:11], v251, s[28:31], s46 offen sc1
    v_accvgpr_read_b32 v12, a36
    v_accvgpr_read_b32 v13, a37
    v_accvgpr_read_b32 v14, a38
    v_accvgpr_read_b32 v15, a39
    v_accvgpr_read_b32 v16, a52
    v_accvgpr_read_b32 v17, a53
    v_accvgpr_read_b32 v18, a54
    v_accvgpr_read_b32 v19, a55
    v_pk_mul_f32 v[12:13], v[12:13], v[46:47] op_sel_hi:[1,0]
    v_pk_mul_f32 v[14:15], v[14:15], v[46:47] op_sel_hi:[1,0]
    v_pk_mul_f32 v[16:17], v[16:17], v[46:47] op_sel_hi:[1,0]
    v_pk_mul_f32 v[18:19], v[18:19], v[46:47] op_sel_hi:[1,0]
    v_pk_fma_f32 v[12:13], v[232:233], v[54:55], v[12:13] op_sel_hi:[1,0,1]
    v_pk_fma_f32 v[14:15], v[234:235], v[54:55], v[14:15] op_sel_hi:[1,0,1]
    v_pk_fma_f32 v[16:17], v[236:237], v[54:55], v[16:17] op_sel_hi:[1,0,1]
    v_pk_fma_f32 v[18:19], v[238:239], v[54:55], v[18:19] op_sel_hi:[1,0,1]
    v_cvt_pk_bf16_f32 v20, v12, v13
    v_cvt_pk_bf16_f32 v21, v14, v15
    v_cvt_pk_bf16_f32 v22, v16, v17
    v_cvt_pk_bf16_f32 v23, v18, v19
    v_pk_max_i16 v20, v20, 0
    v_pk_max_i16 v21, v21, 0
    v_pk_max_i16 v22, v22, 0
    v_pk_max_i16 v23, v23, 0
    s_xor_b32 s46, s45, 0x400
    s_add_u32 s46, s46, s44
    s_nop 0
    s_add_u32 s46, s46, 0x2e000
    buffer_store_dwordx4 v[20:23], v251, s[28:31], s46 offen sc1
    v_accvgpr_read_b32 v0, a8
    v_accvgpr_read_b32 v1, a9
    v_accvgpr_read_b32 v2, a10
    v_accvgpr_read_b32 v3, a11
    v_accvgpr_read_b32 v4, a24
    v_accvgpr_read_b32 v5, a25
    v_accvgpr_read_b32 v6, a26
    v_accvgpr_read_b32 v7, a27
    v_pk_mul_f32 v[0:1], v[0:1], v[48:49] op_sel_hi:[1,0]
    v_pk_mul_f32 v[2:3], v[2:3], v[48:49] op_sel_hi:[1,0]
    v_pk_mul_f32 v[4:5], v[4:5], v[48:49] op_sel_hi:[1,0]
    v_pk_mul_f32 v[6:7], v[6:7], v[48:49] op_sel_hi:[1,0]
    v_pk_fma_f32 v[0:1], v[224:225], v[56:57], v[0:1] op_sel_hi:[1,0,1]
    v_pk_fma_f32 v[2:3], v[226:227], v[56:57], v[2:3] op_sel_hi:[1,0,1]
    v_pk_fma_f32 v[4:5], v[228:229], v[56:57], v[4:5] op_sel_hi:[1,0,1]
    v_pk_fma_f32 v[6:7], v[230:231], v[56:57], v[6:7] op_sel_hi:[1,0,1]
    v_cvt_pk_bf16_f32 v8, v0, v1
    v_cvt_pk_bf16_f32 v9, v2, v3
    v_cvt_pk_bf16_f32 v10, v4, v5
    v_cvt_pk_bf16_f32 v11, v6, v7
    v_pk_max_i16 v8, v8, 0
    v_pk_max_i16 v9, v9, 0
    v_pk_max_i16 v10, v10, 0
    v_pk_max_i16 v11, v11, 0
    s_xor_b32 s46, s45, 0x0
    s_add_u32 s46, s46, s44
    s_add_u32 s46, s46, 0x5c000
    buffer_store_dwordx4 v[8:11], v251, s[28:31], s46 offen sc1
    v_accvgpr_read_b32 v12, a40
    v_accvgpr_read_b32 v13, a41
    v_accvgpr_read_b32 v14, a42
    v_accvgpr_read_b32 v15, a43
    v_accvgpr_read_b32 v16, a56
    v_accvgpr_read_b32 v17, a57
    v_accvgpr_read_b32 v18, a58
    v_accvgpr_read_b32 v19, a59
    v_pk_mul_f32 v[12:13], v[12:13], v[48:49] op_sel_hi:[1,0]
    v_pk_mul_f32 v[14:15], v[14:15], v[48:49] op_sel_hi:[1,0]
    v_pk_mul_f32 v[16:17], v[16:17], v[48:49] op_sel_hi:[1,0]
    v_pk_mul_f32 v[18:19], v[18:19], v[48:49] op_sel_hi:[1,0]
    v_pk_fma_f32 v[12:13], v[232:233], v[56:57], v[12:13] op_sel_hi:[1,0,1]
    v_pk_fma_f32 v[14:15], v[234:235], v[56:57], v[14:15] op_sel_hi:[1,0,1]
    v_pk_fma_f32 v[16:17], v[236:237], v[56:57], v[16:17] op_sel_hi:[1,0,1]
    v_pk_fma_f32 v[18:19], v[238:239], v[56:57], v[18:19] op_sel_hi:[1,0,1]
    v_cvt_pk_bf16_f32 v20, v12, v13
    v_cvt_pk_bf16_f32 v21, v14, v15
    v_cvt_pk_bf16_f32 v22, v16, v17
    v_cvt_pk_bf16_f32 v23, v18, v19
    v_pk_max_i16 v20, v20, 0
    v_pk_max_i16 v21, v21, 0
    v_pk_max_i16 v22, v22, 0
    v_pk_max_i16 v23, v23, 0
    s_xor_b32 s46, s45, 0x400
    s_add_u32 s46, s46, s44
    s_nop 0
    s_add_u32 s46, s46, 0x5c000
    buffer_store_dwordx4 v[20:23], v251, s[28:31], s46 offen sc1
    v_accvgpr_read_b32 v0, a12
    v_accvgpr_read_b32 v1, a13
    v_accvgpr_read_b32 v2, a14
    v_accvgpr_read_b32 v3, a15
    v_accvgpr_read_b32 v4, a28
    v_accvgpr_read_b32 v5, a29
    v_accvgpr_read_b32 v6, a30
    v_accvgpr_read_b32 v7, a31
    v_pk_mul_f32 v[0:1], v[0:1], v[50:51] op_sel_hi:[1,0]
    v_pk_mul_f32 v[2:3], v[2:3], v[50:51] op_sel_hi:[1,0]
    v_pk_mul_f32 v[4:5], v[4:5], v[50:51] op_sel_hi:[1,0]
    v_pk_mul_f32 v[6:7], v[6:7], v[50:51] op_sel_hi:[1,0]
    v_pk_fma_f32 v[0:1], v[224:225], v[58:59], v[0:1] op_sel_hi:[1,0,1]
    v_pk_fma_f32 v[2:3], v[226:227], v[58:59], v[2:3] op_sel_hi:[1,0,1]
    v_pk_fma_f32 v[4:5], v[228:229], v[58:59], v[4:5] op_sel_hi:[1,0,1]
    v_pk_fma_f32 v[6:7], v[230:231], v[58:59], v[6:7] op_sel_hi:[1,0,1]
    v_cvt_pk_bf16_f32 v8, v0, v1
    v_cvt_pk_bf16_f32 v9, v2, v3
    v_cvt_pk_bf16_f32 v10, v4, v5
    v_cvt_pk_bf16_f32 v11, v6, v7
    v_pk_max_i16 v8, v8, 0
    v_pk_max_i16 v9, v9, 0
    v_pk_max_i16 v10, v10, 0
    v_pk_max_i16 v11, v11, 0
    s_xor_b32 s46, s45, 0x0
    s_add_u32 s46, s46, s44
    s_add_u32 s46, s46, 0x8a000
    buffer_store_dwordx4 v[8:11], v251, s[28:31], s46 offen sc1
    v_accvgpr_read_b32 v12, a44
    v_accvgpr_read_b32 v13, a45
    v_accvgpr_read_b32 v14, a46
    v_accvgpr_read_b32 v15, a47
    v_accvgpr_read_b32 v16, a60
    v_accvgpr_read_b32 v17, a61
    v_accvgpr_read_b32 v18, a62
    v_accvgpr_read_b32 v19, a63
    v_pk_mul_f32 v[12:13], v[12:13], v[50:51] op_sel_hi:[1,0]
    v_pk_mul_f32 v[14:15], v[14:15], v[50:51] op_sel_hi:[1,0]
    v_pk_mul_f32 v[16:17], v[16:17], v[50:51] op_sel_hi:[1,0]
    v_pk_mul_f32 v[18:19], v[18:19], v[50:51] op_sel_hi:[1,0]
    v_pk_fma_f32 v[12:13], v[232:233], v[58:59], v[12:13] op_sel_hi:[1,0,1]
    v_pk_fma_f32 v[14:15], v[234:235], v[58:59], v[14:15] op_sel_hi:[1,0,1]
    v_pk_fma_f32 v[16:17], v[236:237], v[58:59], v[16:17] op_sel_hi:[1,0,1]
    v_pk_fma_f32 v[18:19], v[238:239], v[58:59], v[18:19] op_sel_hi:[1,0,1]
    v_cvt_pk_bf16_f32 v20, v12, v13
    v_cvt_pk_bf16_f32 v21, v14, v15
    v_cvt_pk_bf16_f32 v22, v16, v17
    v_cvt_pk_bf16_f32 v23, v18, v19
    v_pk_max_i16 v20, v20, 0
    v_pk_max_i16 v21, v21, 0
    v_pk_max_i16 v22, v22, 0
    v_pk_max_i16 v23, v23, 0
    s_xor_b32 s46, s45, 0x400
    s_add_u32 s46, s46, s44
    s_nop 0
    s_add_u32 s46, s46, 0x8a000
    buffer_store_dwordx4 v[20:23], v251, s[28:31], s46 offen sc1
K1_NOH:
    v_mfma_f32_32x32x16_bf16 a[0:15], v[28:31], v[28:31], 0
    v_mfma_f32_32x32x16_bf16 a[16:31], v[28:31], v[28:31], 0
    v_mfma_f32_32x32x16_bf16 a[32:47], v[28:31], v[28:31], 0
    v_mfma_f32_32x32x16_bf16 a[48:63], v[28:31], v[28:31], 0
    v_pk_mul_f32 v[64:65], v[64:65], v[36:37] op_sel_hi:[1,0]
    v_pk_mul_f32 v[66:67], v[66:67], v[36:37] op_sel_hi:[1,0]
    v_pk_fma_f32 v[64:65], v[192:193], v[240:241], v[64:65] op_sel_hi:[1,0,1]
    v_pk_fma_f32 v[66:67], v[194:195], v[240:241], v[66:67] op_sel_hi:[1,0,1]
    v_pk_mul_f32 v[80:81], v[80:81], v[36:37] op_sel_hi:[1,0]
    v_pk_mul_f32 v[82:83], v[82:83], v[36:37] op_sel_hi:[1,0]
    v_pk_fma_f32 v[80:81], v[196:197], v[240:241], v[80:81] op_sel_hi:[1,0,1]
    v_pk_fma_f32 v[82:83], v[198:199], v[240:241], v[82:83] op_sel_hi:[1,0,1]
    v_pk_mul_f32 v[96:97], v[96:97], v[36:37] op_sel_hi:[1,0]
    v_pk_mul_f32 v[98:99], v[98:99], v[36:37] op_sel_hi:[1,0]
    v_pk_fma_f32 v[96:97], v[200:201], v[240:241], v[96:97] op_sel_hi:[1,0,1]
    v_pk_fma_f32 v[98:99], v[202:203], v[240:241], v[98:99] op_sel_hi:[1,0,1]
    v_pk_mul_f32 v[112:113], v[112:113], v[36:37] op_sel_hi:[1,0]
    v_pk_mul_f32 v[114:115], v[114:115], v[36:37] op_sel_hi:[1,0]
    v_pk_fma_f32 v[112:113], v[204:205], v[240:241], v[112:113] op_sel_hi:[1,0,1]
    v_pk_fma_f32 v[114:115], v[206:207], v[240:241], v[114:115] op_sel_hi:[1,0,1]
    v_pk_mul_f32 v[128:129], v[128:129], v[36:37] op_sel_hi:[1,0]
    v_pk_mul_f32 v[130:131], v[130:131], v[36:37] op_sel_hi:[1,0]
    v_pk_fma_f32 v[128:129], v[208:209], v[240:241], v[128:129] op_sel_hi:[1,0,1]
    v_pk_fma_f32 v[130:131], v[210:211], v[240:241], v[130:131] op_sel_hi:[1,0,1]
    v_pk_mul_f32 v[144:145], v[144:145], v[36:37] op_sel_hi:[1,0]
    v_pk_mul_f32 v[146:147], v[146:147], v[36:37] op_sel_hi:[1,0]
    v_pk_fma_f32 v[144:145], v[212:213], v[240:241], v[144:145] op_sel_hi:[1,0,1]
    v_pk_fma_f32 v[146:147], v[214:215], v[240:241], v[146:147] op_sel_hi:[1,0,1]
    v_pk_mul_f32 v[160:161], v[160:161], v[36:37] op_sel_hi:[1,0]
    v_pk_mul_f32 v[162:163], v[162:163], v[36:37] op_sel_hi:[1,0]
    v_pk_fma_f32 v[160:161], v[216:217], v[240:241], v[160:161] op_sel_hi:[1,0,1]
    v_pk_fma_f32 v[162:163], v[218:219], v[240:241], v[162:163] op_sel_hi:[1,0,1]
    v_pk_mul_f32 v[176:177], v[176:177], v[36:37] op_sel_hi:[1,0]
    v_pk_mul_f32 v[178:179], v[178:179], v[36:37] op_sel_hi:[1,0]
    v_pk_fma_f32 v[176:177], v[220:221], v[240:241], v[176:177] op_sel_hi:[1,0,1]
    v_pk_fma_f32 v[178:179], v[222:223], v[240:241], v[178:179] op_sel_hi:[1,0,1]
    v_pk_mul_f32 v[68:69], v[68:69], v[38:39] op_sel_hi:[1,0]
    v_pk_mul_f32 v[70:71], v[70:71], v[38:39] op_sel_hi:[1,0]
    v_pk_fma_f32 v[68:69], v[192:193], v[242:243], v[68:69] op_sel_hi:[1,0,1]
    v_pk_fma_f32 v[70:71], v[194:195], v[242:243], v[70:71] op_sel_hi:[1,0,1]
    v_pk_mul_f32 v[84:85], v[84:85], v[38:39] op_sel_hi:[1,0]
    v_pk_mul_f32 v[86:87], v[86:87], v[38:39] op_sel_hi:[1,0]
    v_pk_fma_f32 v[84:85], v[196:197], v[242:243], v[84:85] op_sel_hi:[1,0,1]
    v_pk_fma_f32 v[86:87], v[198:199], v[242:243], v[86:87] op_sel_hi:[1,0,1]
    v_pk_mul_f32 v[100:101], v[100:101], v[38:39] op_sel_hi:[1,0]
    v_pk_mul_f32 v[102:103], v[102:103], v[38:39] op_sel_hi:[1,0]
    v_pk_fma_f32 v[100:101], v[200:201], v[242:243], v[100:101] op_sel_hi:[1,0,1]
    v_pk_fma_f32 v[102:103], v[202:203], v[242:243], v[102:103] op_sel_hi:[1,0,1]
    v_pk_mul_f32 v[116:117], v[116:117], v[38:39] op_sel_hi:[1,0]
    v_pk_mul_f32 v[118:119], v[118:119], v[38:39] op_sel_hi:[1,0]
    v_pk_fma_f32 v[116:117], v[204:205], v[242:243], v[116:117] op_sel_hi:[1,0,1]
    v_pk_fma_f32 v[118:119], v[206:207], v[242:243], v[118:119] op_sel_hi:[1,0,1]
    v_pk_mul_f32 v[132:133], v[132:133], v[38:39] op_sel_hi:[1,0]
    v_pk_mul_f32 v[134:135], v[134:135], v[38:39] op_sel_hi:[1,0]
    v_pk_fma_f32 v[132:133], v[208:209], v[242:243], v[132:133] op_sel_hi:[1,0,1]
    v_pk_fma_f32 v[134:135], v[210:211], v[242:243], v[134:135] op_sel_hi:[1,0,1]
    v_pk_mul_f32 v[148:149], v[148:149], v[38:39] op_sel_hi:[1,0]
    v_pk_mul_f32 v[150:151], v[150:151], v[38:39] op_sel_hi:[1,0]
    v_pk_fma_f32 v[148:149], v[212:213], v[242:243], v[148:149] op_sel_hi:[1,0,1]
    v_pk_fma_f32 v[150:151], v[214:215], v[242:243], v[150:151] op_sel_hi:[1,0,1]
    v_pk_mul_f32 v[164:165], v[164:165], v[38:39] op_sel_hi:[1,0]
    v_pk_mul_f32 v[166:167], v[166:167], v[38:39] op_sel_hi:[1,0]
    v_pk_fma_f32 v[164:165], v[216:217], v[242:243], v[164:165] op_sel_hi:[1,0,1]
    v_pk_fma_f32 v[166:167], v[218:219], v[242:243], v[166:167] op_sel_hi:[1,0,1]
    v_pk_mul_f32 v[180:181], v[180:181], v[38:39] op_sel_hi:[1,0]
    v_pk_mul_f32 v[182:183], v[182:183], v[38:39] op_sel_hi:[1,0]
    v_pk_fma_f32 v[180:181], v[220:221], v[242:243], v[180:181] op_sel_hi:[1,0,1]
    v_pk_fma_f32 v[182:183], v[222:223], v[242:243], v[182:183] op_sel_hi:[1,0,1]
    v_pk_mul_f32 v[72:73], v[72:73], v[40:41] op_sel_hi:[1,0]
    v_pk_mul_f32 v[74:75], v[74:75], v[40:41] op_sel_hi:[1,0]
    v_pk_fma_f32 v[72:73], v[192:193], v[244:245], v[72:73] op_sel_hi:[1,0,1]
    v_pk_fma_f32 v[74:75], v[194:195], v[244:245], v[74:75] op_sel_hi:[1,0,1]
    v_pk_mul_f32 v[88:89], v[88:89], v[40:41] op_sel_hi:[1,0]
    v_pk_mul_f32 v[90:91], v[90:91], v[40:41] op_sel_hi:[1,0]
    v_pk_fma_f32 v[88:89], v[196:197], v[244:245], v[88:89] op_sel_hi:[1,0,1]
    v_pk_fma_f32 v[90:91], v[198:199], v[244:245], v[90:91] op_sel_hi:[1,0,1]
    v_pk_mul_f32 v[104:105], v[104:105], v[40:41] op_sel_hi:[1,0]
    v_pk_mul_f32 v[106:107], v[106:107], v[40:41] op_sel_hi:[1,0]
    v_pk_fma_f32 v[104:105], v[200:201], v[244:245], v[104:105] op_sel_hi:[1,0,1]
    v_pk_fma_f32 v[106:107], v[202:203], v[244:245], v[106:107] op_sel_hi:[1,0,1]
    v_pk_mul_f32 v[120:121], v[120:121], v[40:41] op_sel_hi:[1,0]
    v_pk_mul_f32 v[122:123], v[122:123], v[40:41] op_sel_hi:[1,0]
    v_pk_fma_f32 v[120:121], v[204:205], v[244:245], v[120:121] op_sel_hi:[1,0,1]
    v_pk_fma_f32 v[122:123], v[206:207], v[244:245], v[122:123] op_sel_hi:[1,0,1]
    v_pk_mul_f32 v[136:137], v[136:137], v[40:41] op_sel_hi:[1,0]
    v_pk_mul_f32 v[138:139], v[138:139], v[40:41] op_sel_hi:[1,0]
    v_pk_fma_f32 v[136:137], v[208:209], v[244:245], v[136:137] op_sel_hi:[1,0,1]
    v_pk_fma_f32 v[138:139], v[210:211], v[244:245], v[138:139] op_sel_hi:[1,0,1]
    v_pk_mul_f32 v[152:153], v[152:153], v[40:41] op_sel_hi:[1,0]
    v_pk_mul_f32 v[154:155], v[154:155], v[40:41] op_sel_hi:[1,0]
    v_pk_fma_f32 v[152:153], v[212:213], v[244:245], v[152:153] op_sel_hi:[1,0,1]
    v_pk_fma_f32 v[154:155], v[214:215], v[244:245], v[154:155] op_sel_hi:[1,0,1]
    v_pk_mul_f32 v[168:169], v[168:169], v[40:41] op_sel_hi:[1,0]
    v_pk_mul_f32 v[170:171], v[170:171], v[40:41] op_sel_hi:[1,0]
    v_pk_fma_f32 v[168:169], v[216:217], v[244:245], v[168:169] op_sel_hi:[1,0,1]
    v_pk_fma_f32 v[170:171], v[218:219], v[244:245], v[170:171] op_sel_hi:[1,0,1]
    v_pk_mul_f32 v[184:185], v[184:185], v[40:41] op_sel_hi:[1,0]
    v_pk_mul_f32 v[186:187], v[186:187], v[40:41] op_sel_hi:[1,0]
    v_pk_fma_f32 v[184:185], v[220:221], v[244:245], v[184:185] op_sel_hi:[1,0,1]
    v_pk_fma_f32 v[186:187], v[222:223], v[244:245], v[186:187] op_sel_hi:[1,0,1]
    v_pk_mul_f32 v[76:77], v[76:77], v[42:43] op_sel_hi:[1,0]
    v_pk_mul_f32 v[78:79], v[78:79], v[42:43] op_sel_hi:[1,0]
    v_pk_fma_f32 v[76:77], v[192:193], v[246:247], v[76:77] op_sel_hi:[1,0,1]
    v_pk_fma_f32 v[78:79], v[194:195], v[246:247], v[78:79] op_sel_hi:[1,0,1]
    v_pk_mul_f32 v[92:93], v[92:93], v[42:43] op_sel_hi:[1,0]
    v_pk_mul_f32 v[94:95], v[94:95], v[42:43] op_sel_hi:[1,0]
    v_pk_fma_f32 v[92:93], v[196:197], v[246:247], v[92:93] op_sel_hi:[1,0,1]
    v_pk_fma_f32 v[94:95], v[198:199], v[246:247], v[94:95] op_sel_hi:[1,0,1]
    v_pk_mul_f32 v[108:109], v[108:109], v[42:43] op_sel_hi:[1,0]
    v_pk_mul_f32 v[110:111], v[110:111], v[42:43] op_sel_hi:[1,0]
    v_pk_fma_f32 v[108:109], v[200:201], v[246:247], v[108:109] op_sel_hi:[1,0,1]
    v_pk_fma_f32 v[110:111], v[202:203], v[246:247], v[110:111] op_sel_hi:[1,0,1]
    v_pk_mul_f32 v[124:125], v[124:125], v[42:43] op_sel_hi:[1,0]
    v_pk_mul_f32 v[126:127], v[126:127], v[42:43] op_sel_hi:[1,0]
    v_pk_fma_f32 v[124:125], v[204:205], v[246:247], v[124:125] op_sel_hi:[1,0,1]
    v_pk_fma_f32 v[126:127], v[206:207], v[246:247], v[126:127] op_sel_hi:[1,0,1]
    v_pk_mul_f32 v[140:141], v[140:141], v[42:43] op_sel_hi:[1,0]
    v_pk_mul_f32 v[142:143], v[142:143], v[42:43] op_sel_hi:[1,0]
    v_pk_fma_f32 v[140:141], v[208:209], v[246:247], v[140:141] op_sel_hi:[1,0,1]
    v_pk_fma_f32 v[142:143], v[210:211], v[246:247], v[142:143] op_sel_hi:[1,0,1]
    v_pk_mul_f32 v[156:157], v[156:157], v[42:43] op_sel_hi:[1,0]
    v_pk_mul_f32 v[158:159], v[158:159], v[42:43] op_sel_hi:[1,0]
    v_pk_fma_f32 v[156:157], v[212:213], v[246:247], v[156:157] op_sel_hi:[1,0,1]
    v_pk_fma_f32 v[158:159], v[214:215], v[246:247], v[158:159] op_sel_hi:[1,0,1]
    v_pk_mul_f32 v[172:173], v[172:173], v[42:43] op_sel_hi:[1,0]
    v_pk_mul_f32 v[174:175], v[174:175], v[42:43] op_sel_hi:[1,0]
    v_pk_fma_f32 v[172:173], v[216:217], v[246:247], v[172:173] op_sel_hi:[1,0,1]
    v_pk_fma_f32 v[174:175], v[218:219], v[246:247], v[174:175] op_sel_hi:[1,0,1]
    v_pk_mul_f32 v[188:189], v[188:189], v[42:43] op_sel_hi:[1,0]
    v_pk_mul_f32 v[190:191], v[190:191], v[42:43] op_sel_hi:[1,0]
    v_pk_fma_f32 v[188:189], v[220:221], v[246:247], v[188:189] op_sel_hi:[1,0,1]
    v_pk_fma_f32 v[190:191], v[222:223], v[246:247], v[190:191] op_sel_hi:[1,0,1]
    v_cvt_pk_bf16_f32 v0, v64, v65
    v_cvt_pk_bf16_f32 v1, v66, v67
    v_cvt_pk_bf16_f32 v2, v80, v81
    v_cvt_pk_bf16_f32 v3, v82, v83
    v_cvt_pk_bf16_f32 v4, v96, v97
    v_cvt_pk_bf16_f32 v5, v98, v99
    v_cvt_pk_bf16_f32 v6, v112, v113
    v_cvt_pk_bf16_f32 v7, v114, v115
    v_cvt_pk_bf16_f32 v8, v128, v129
    v_cvt_pk_bf16_f32 v9, v130, v131
    v_cvt_pk_bf16_f32 v10, v144, v145
    v_cvt_pk_bf16_f32 v11, v146, v147
    v_cvt_pk_bf16_f32 v12, v160, v161
    v_cvt_pk_bf16_f32 v13, v162, v163
    v_cvt_pk_bf16_f32 v14, v176, v177
    v_cvt_pk_bf16_f32 v15, v178, v179
    v_cvt_pk_bf16_f32 v16, v68, v69
    v_cvt_pk_bf16_f32 v17, v70, v71
    v_cvt_pk_bf16_f32 v18, v84, v85
    v_cvt_pk_bf16_f32 v19, v86, v87
    v_cvt_pk_bf16_f32 v20, v100, v101
    v_cvt_pk_bf16_f32 v21, v102, v103
    v_cvt_pk_bf16_f32 v22, v116, v117
    v_cvt_pk_bf16_f32 v23, v118, v119
    v_cvt_pk_bf16_f32 v24, v132, v133
    v_cvt_pk_bf16_f32 v25, v134, v135
    v_cvt_pk_bf16_f32 v26, v148, v149
    v_cvt_pk_bf16_f32 v27, v150, v151
    v_cvt_pk_bf16_f32 v28, v164, v165
    v_cvt_pk_bf16_f32 v29, v166, v167
    v_cvt_pk_bf16_f32 v30, v180, v181
    v_cvt_pk_bf16_f32 v31, v182, v183
    v_cvt_pk_bf16_f32 v32, v72, v73
    v_cvt_pk_bf16_f32 v33, v74, v75
    v_cvt_pk_bf16_f32 v34, v88, v89
    v_cvt_pk_bf16_f32 v35, v90, v91
    v_cvt_pk_bf16_f32 v36, v104, v105
    v_cvt_pk_bf16_f32 v37, v106, v107
    v_cvt_pk_bf16_f32 v38, v120, v121
    v_cvt_pk_bf16_f32 v39, v122, v123
    v_cvt_pk_bf16_f32 v40, v136, v137
    v_cvt_pk_bf16_f32 v41, v138, v139
    v_cvt_pk_bf16_f32 v42, v152, v153
    v_cvt_pk_bf16_f32 v43, v154, v155
    v_cvt_pk_bf16_f32 v44, v168, v169
    v_cvt_pk_bf16_f32 v45, v170, v171
    v_cvt_pk_bf16_f32 v46, v184, v185
    v_cvt_pk_bf16_f32 v47, v186, v187
    v_cvt_pk_bf16_f32 v48, v76, v77
    v_cvt_pk_bf16_f32 v49, v78, v79
    v_cvt_pk_bf16_f32 v50, v92, v93
    v_cvt_pk_bf16_f32 v51, v94, v95
    v_cvt_pk_bf16_f32 v52, v108, v109
    v_cvt_pk_bf16_f32 v53, v110, v111
    v_cvt_pk_bf16_f32 v54, v124, v125
    v_cvt_pk_bf16_f32 v55, v126, v127
    v_cvt_pk_bf16_f32 v56, v140, v141
    v_cvt_pk_bf16_f32 v57, v142, v143
    v_cvt_pk_bf16_f32 v58, v156, v157
    v_cvt_pk_bf16_f32 v59, v158, v159
    v_cvt_pk_bf16_f32 v60, v172, v173
    v_cvt_pk_bf16_f32 v61, v174, v175
    v_cvt_pk_bf16_f32 v62, v188, v189
    v_cvt_pk_bf16_f32 v63, v190, v191
    v_and_b32 v216, 15, v250
    v_lshrrev_b32 v217, 4, v250
    v_xor_b32 v218, v217, v216
    v_lshlrev_b32 v218, 4, v218
    v_lshl_add_u32 v218, v216, 8, v218
    s_lshl_b32 s44, s36, 6
    v_xor_b32 v218, s44, v218
    v_xor_b32 v204, 0x0, v218
    v_xor_b32 v205, 0x40, v218
    v_xor_b32 v206, 0x80, v218
    v_xor_b32 v207, 0xc0, v218
    v_and_b32 v216, 15, v250
    v_lshrrev_b32 v216, 2, v216
    v_lshrrev_b32_e64 v217, 4, v250
    v_lshl_add_u32 v218, v217, 2, v216
    v_and_b32 v219, 7, v218
    v_lshlrev_b32 v218, 8, v218
    v_lshl_add_u32 v218, v219, 5, v218
    v_and_b32_e64 v219, 3, v250
    v_lshl_add_u32 v218, v219, 3, v218
    v_add_u32 v218, 0x10000, v218
    v_xor_b32 v208, 0x0, v218
    v_xor_b32 v209, 0x20, v218
    v_xor_b32_e64 v210, 0x40, v218
    v_xor_b32 v211, 0x60, v218
    v_xor_b32 v212, 0x80, v218
    v_xor_b32 v213, 0xa0, v218
    v_xor_b32 v214, 0xc0, v218
    v_xor_b32 v215, 0xe0, v218
    v_mov_b32 v224, 0x46800000
    v_mov_b32 v192, 0
    v_mov_b32 v193, 0
    v_mov_b32 v194, 0
    v_mov_b32_e64 v195, 0
    s_and_b32 s44, s2, 7
    s_lshl_b32 s44, s44, 2
    s_lshr_b32 s45, s2, 6
    s_add_u32 s98, s44, s45
    s_lshr_b32 s45, s2, 3
    s_and_b32 s99, s45, 7
    s_mul_i32 s44, s36, 14
    s_add_u32 s44, s44, 128
    s_lshl_b32 s20, s44, 15
    s_lshl_b32 s45, s99, 12
    s_add_u32 s20, s20, s45
    s_nop 0
    s_mul_i32 s45, s98, 0xb8000
    s_lshl_b32 s44, s44, 10
    s_add_u32 s21, s45, s44
    s_add_u32 s22, s21, 0x2e000
    s_add_u32 s23, s22, 0x2e000
    s_add_u32 s24, s23, 0x2e000
    s_mov_b32 s25, 0
    s_mov_b32 s26, 0
    s_mov_b32 s16, s92
    s_mov_b32 s17, s93
    s_mov_b32 s18, 0
    s_nop 0
    s_mov_b32 s19, 0x20000
    s_mov_b32 s32, s52
    s_mov_b32 s33, s53
    s_mov_b32 s34, 0
    s_nop 0
    s_mov_b32 s35, 0x20000
    s_mov_b32 s88, s96
    s_mov_b32 s89, s97
    s_mov_b32 s90, 256
    s_mov_b32 s91, 0x20000
    s_waitcnt vmcnt(8)
    s_barrier
    ds_read_b128 a[128:131], v204 offset:0
    ds_read_b128 a[132:135], v205 offset:0
    ds_read_b128 a[136:139], v206 offset:0
    ds_read_b128 a[140:143], v207 offset:0
    ds_read_b128 a[144:147], v204 offset:4096
    ds_read_b128 a[148:151], v205 offset:4096
    ds_read_b128 a[152:155], v206 offset:4096
    ds_read_b128 a[156:159], v207 offset:4096
    s_waitcnt lgkmcnt(0)
    s_nop 0
    v_mfma_f32_16x16x32_bf16 v[64:67], a[128:131], v[0:3], 0
    v_mfma_f32_16x16x32_bf16 v[68:71], a[128:131], v[16:19], 0
    v_mfma_f32_16x16x32_bf16 v[72:75], a[128:131], v[32:35], 0
    v_mfma_f32_16x16x32_bf16 v[76:79], a[128:131], v[48:51], 0
    v_mfma_f32_16x16x32_bf16 v[64:67], a[132:135], v[4:7], v[64:67]
    v_mfma_f32_16x16x32_bf16 v[68:71], a[132:135], v[20:23], v[68:71]
    v_mfma_f32_16x16x32_bf16 v[72:75], a[132:135], v[36:39], v[72:75]
    v_mfma_f32_16x16x32_bf16 v[76:79], a[132:135], v[52:55], v[76:79]
    v_mfma_f32_16x16x32_bf16 v[64:67], a[136:139], v[8:11], v[64:67]
    v_mfma_f32_16x16x32_bf16 v[68:71], a[136:139], v[24:27], v[68:71]
    v_mfma_f32_16x16x32_bf16 v[72:75], a[136:139], v[40:43], v[72:75]
    v_mfma_f32_16x16x32_bf16 v[76:79], a[136:139], v[56:59], v[76:79]
    v_mfma_f32_16x16x32_bf16 v[64:67], a[140:143], v[12:15], v[64:67]
    v_mfma_f32_16x16x32_bf16 v[68:71], a[140:143], v[28:31], v[68:71]
    v_mfma_f32_16x16x32_bf16 v[72:75], a[140:143], v[44:47], v[72:75]
    v_mfma_f32_16x16x32_bf16 v[76:79], a[140:143], v[60:63], v[76:79]
    v_mfma_f32_16x16x32_bf16 v[80:83], a[144:147], v[0:3], 0
    v_mfma_f32_16x16x32_bf16 v[84:87], a[144:147], v[16:19], 0
    v_mfma_f32_16x16x32_bf16 v[88:91], a[144:147], v[32:35], 0
    v_mfma_f32_16x16x32_bf16 v[92:95], a[144:147], v[48:51], 0
    v_mfma_f32_16x16x32_bf16 v[80:83], a[148:151], v[4:7], v[80:83]
    v_mfma_f32_16x16x32_bf16 v[84:87], a[148:151], v[20:23], v[84:87]
    v_mfma_f32_16x16x32_bf16 v[88:91], a[148:151], v[36:39], v[88:91]
    v_mfma_f32_16x16x32_bf16 v[92:95], a[148:151], v[52:55], v[92:95]
    v_mfma_f32_16x16x32_bf16 v[80:83], a[152:155], v[8:11], v[80:83]
    v_mfma_f32_16x16x32_bf16 v[84:87], a[152:155], v[24:27], v[84:87]
    v_mfma_f32_16x16x32_bf16 v[88:91], a[152:155], v[40:43], v[88:91]
    v_mfma_f32_16x16x32_bf16 v[92:95], a[152:155], v[56:59], v[92:95]
    v_mfma_f32_16x16x32_bf16 v[80:83], a[156:159], v[12:15], v[80:83]
    v_mfma_f32_16x16x32_bf16 v[84:87], a[156:159], v[28:31], v[84:87]
    v_mfma_f32_16x16x32_bf16 v[88:91], a[156:159], v[44:47], v[88:91]
    v_mfma_f32_16x16x32_bf16 v[92:95], a[156:159], v[60:63], v[92:95]
    ds_read_b128 a[128:131], v204 offset:8192
    ds_read_b128 a[132:135], v205 offset:8192
    ds_read_b128 a[136:139], v206 offset:8192
    ds_read_b128 a[140:143], v207 offset:8192
    ds_read_b128 a[144:147], v204 offset:12288
    ds_read_b128 a[148:151], v205 offset:12288
    ds_read_b128 a[152:155], v206 offset:12288
    ds_read_b128 a[156:159], v207 offset:12288
    s_nop 15
    s_nop 0
    v_max3_f32 v216, v64, v65, v66
    v_max3_f32 v217, v68, v69, v70
    v_max3_f32 v218, v72, v73, v74
    v_max3_f32 v219, v76, v77, v78
    v_max3_f32 v216, v216, v67, v80
    v_max3_f32 v217, v217, v71, v84
    v_max3_f32 v218, v218, v75, v88
    v_max3_f32 v219, v219, v79, v92
    v_max3_f32 v216, v216, v81, v82
    v_max3_f32 v217, v217, v85, v86
    v_max3_f32 v218, v218, v89, v90
    v_max3_f32 v219, v219, v93, v94
    v_max_f32 v216, v216, v83
    v_max_f32 v217, v217, v87
    v_max_f32 v218, v218, v91
    v_max_f32 v219, v219, v95
    v_mov_b32 v220, v216
    v_mov_b32 v221, v217
    v_mov_b32 v222, v218
    v_mov_b32 v223, v219
    v_permlane32_swap_b32 v216, v220
    v_permlane32_swap_b32 v217, v221
    v_permlane32_swap_b32 v218, v222
    v_permlane32_swap_b32 v219, v223
    v_max_f32 v216, v216, v220
    v_max_f32 v217, v217, v221
    v_max_f32 v218, v218, v222
    v_max_f32 v219, v219, v223
    v_mov_b32 v220, v216
    v_mov_b32 v221, v217
    v_mov_b32 v222, v218
    v_mov_b32 v223, v219
    v_permlane16_swap_b32 v216, v220
    v_permlane16_swap_b32 v217, v221
    v_permlane16_swap_b32 v218, v222
    v_permlane16_swap_b32 v219, v223
    v_max_f32 v216, v216, v220
    v_max_f32 v217, v217, v221
    v_max_f32 v218, v218, v222
    v_max_f32 v219, v219, v223
    v_sub_f32 v128, 0, v216
    v_sub_f32 v129, 0, v216
    v_sub_f32 v130, 0, v216
    v_sub_f32 v131, 0, v216
    v_sub_f32 v132, 0, v217
    v_sub_f32 v133, 0, v217
    v_sub_f32 v134, 0, v217
    v_sub_f32 v135, 0, v217
    v_sub_f32 v136, 0, v218
    v_sub_f32 v137, 0, v218
    v_sub_f32 v138, 0, v218
    v_sub_f32 v139, 0, v218
    v_sub_f32 v140, 0, v219
    v_sub_f32 v141, 0, v219
    v_sub_f32 v142, 0, v219
    v_sub_f32 v143, 0, v219
    v_pk_add_f32 v[64:65], v[64:65], v[128:129]
    v_pk_add_f32 v[66:67], v[66:67], v[128:129]
    v_pk_add_f32 v[80:81], v[80:81], v[128:129]
    v_pk_add_f32 v[82:83], v[82:83], v[128:129]
    v_pk_add_f32 v[68:69], v[68:69], v[132:133]
    v_pk_add_f32 v[70:71], v[70:71], v[132:133]
    v_pk_add_f32 v[84:85], v[84:85], v[132:133]
    v_pk_add_f32 v[86:87], v[86:87], v[132:133]
    v_pk_add_f32 v[72:73], v[72:73], v[136:137]
    v_pk_add_f32 v[74:75], v[74:75], v[136:137]
    v_pk_add_f32 v[88:89], v[88:89], v[136:137]
    v_pk_add_f32 v[90:91], v[90:91], v[136:137]
    v_pk_add_f32 v[76:77], v[76:77], v[140:141]
    v_pk_add_f32 v[78:79], v[78:79], v[140:141]
    v_pk_add_f32 v[92:93], v[92:93], v[140:141]
    v_pk_add_f32 v[94:95], v[94:95], v[140:141]
    s_mov_b32 s39, 0x10000
    s_waitcnt lgkmcnt(0)
    s_nop 1
    v_mfma_f32_16x16x32_bf16 v[96:99], a[128:131], v[0:3], v[128:131]
    v_exp_f32_e64 v176, v64
    v_mfma_f32_16x16x32_bf16 v[96:99], a[132:135], v[4:7], v[96:99]
    v_mfma_f32_16x16x32_bf16 v[96:99], a[136:139], v[8:11], v[96:99]
    v_exp_f32_e64 v177, v65
    v_mfma_f32_16x16x32_bf16 v[96:99], a[140:143], v[12:15], v[96:99]
    v_add_f32_e64 v196, v176, v177
    v_cvt_pk_bf16_f32 v144, v176, v177
    v_mfma_f32_16x16x32_bf16 v[112:115], a[144:147], v[0:3], v[128:131]
    v_exp_f32_e64 v178, v66
    v_mfma_f32_16x16x32_bf16 v[112:115], a[148:151], v[4:7], v[112:115]
    v_add_f32_e64 v196, v196, v178
    v_mfma_f32_16x16x32_bf16 v[112:115], a[152:155], v[8:11], v[112:115]
    v_exp_f32_e64 v179, v67
    v_mfma_f32_16x16x32_bf16 v[112:115], a[156:159], v[12:15], v[112:115]
    v_add_f32_e64 v196, v196, v179
    v_cvt_pk_bf16_f32 v145, v178, v179
    v_mfma_f32_16x16x32_bf16 v[100:103], a[128:131], v[16:19], v[132:135]
    v_exp_f32_e64 v180, v80
    v_mfma_f32_16x16x32_bf16 v[100:103], a[132:135], v[20:23], v[100:103]
    v_add_f32_e64 v196, v196, v180
    v_mfma_f32_16x16x32_bf16 v[100:103], a[136:139], v[24:27], v[100:103]
    v_exp_f32_e64 v181, v81
    v_mfma_f32_16x16x32_bf16 v[100:103], a[140:143], v[28:31], v[100:103]
    v_add_f32_e64 v196, v196, v181
    v_cvt_pk_bf16_f32 v146, v180, v181
    v_mfma_f32_16x16x32_bf16 v[116:119], a[144:147], v[16:19], v[132:135]
    v_exp_f32_e64 v182, v82
    v_mfma_f32_16x16x32_bf16 v[116:119], a[148:151], v[20:23], v[116:119]
    v_add_f32_e64 v196, v196, v182
    v_mfma_f32_16x16x32_bf16 v[116:119], a[152:155], v[24:27], v[116:119]
    v_exp_f32_e64 v183, v83
    v_mfma_f32_16x16x32_bf16 v[116:119], a[156:159], v[28:31], v[116:119]
    v_add_f32_e64 v196, v196, v183
    v_cvt_pk_bf16_f32 v147, v182, v183
    v_mfma_f32_16x16x32_bf16 v[104:107], a[128:131], v[32:35], v[136:139]
    v_exp_f32_e64 v176, v68
    v_mfma_f32_16x16x32_bf16 v[104:107], a[132:135], v[36:39], v[104:107]
    v_mfma_f32_16x16x32_bf16 v[104:107], a[136:139], v[40:43], v[104:107]
    v_exp_f32_e64 v177, v69
    v_mfma_f32_16x16x32_bf16 v[104:107], a[140:143], v[44:47], v[104:107]
    v_add_f32_e64 v197, v176, v177
    v_cvt_pk_bf16_f32 v148, v176, v177
    v_mfma_f32_16x16x32_bf16 v[120:123], a[144:147], v[32:35], v[136:139]
    v_exp_f32_e64 v178, v70
    v_mfma_f32_16x16x32_bf16 v[120:123], a[148:151], v[36:39], v[120:123]
    v_add_f32_e64 v197, v197, v178
    v_mfma_f32_16x16x32_bf16 v[120:123], a[152:155], v[40:43], v[120:123]
    v_exp_f32_e64 v179, v71
    v_mfma_f32_16x16x32_bf16 v[120:123], a[156:159], v[44:47], v[120:123]
    v_add_f32_e64 v197, v197, v179
    v_cvt_pk_bf16_f32 v149, v178, v179
    v_mfma_f32_16x16x32_bf16 v[108:111], a[128:131], v[48:51], v[140:143]
    v_exp_f32_e64 v180, v84
    v_mfma_f32_16x16x32_bf16 v[108:111], a[132:135], v[52:55], v[108:111]
    v_add_f32_e64 v197, v197, v180
    v_mfma_f32_16x16x32_bf16 v[108:111], a[136:139], v[56:59], v[108:111]
    v_exp_f32_e64 v181, v85
    v_mfma_f32_16x16x32_bf16 v[108:111], a[140:143], v[60:63], v[108:111]
    v_add_f32_e64 v197, v197, v181
    v_cvt_pk_bf16_f32 v150, v180, v181
    v_mfma_f32_16x16x32_bf16 v[124:127], a[144:147], v[48:51], v[140:143]
    v_exp_f32_e64 v182, v86
    v_mfma_f32_16x16x32_bf16 v[124:127], a[148:151], v[52:55], v[124:127]
    v_add_f32_e64 v197, v197, v182
    v_mfma_f32_16x16x32_bf16 v[124:127], a[152:155], v[56:59], v[124:127]
    v_exp_f32_e64 v183, v87
    v_mfma_f32_16x16x32_bf16 v[124:127], a[156:159], v[60:63], v[124:127]
    v_add_f32_e64 v197, v197, v183
    v_cvt_pk_bf16_f32 v151, v182, v183
    v_exp_f32_e64 v176, v72
    ds_read_b128 a[128:131], v204 offset:16384
    v_exp_f32_e64 v177, v73
    ds_read_b128 a[132:135], v205 offset:16384
    v_add_f32 v198, v176, v177
    v_exp_f32 v178, v74
    ds_read_b128 a[136:139], v206 offset:16384
    v_cvt_pk_bf16_f32 v152, v176, v177
    v_exp_f32_e64 v179, v75
    ds_read_b128 a[140:143], v207 offset:16384
    v_add_f32 v198, v198, v178
    v_add_f32 v198, v198, v179
    v_exp_f32_e64 v180, v88
    ds_read_b128 a[144:147], v204 offset:20480
    v_cvt_pk_bf16_f32 v153, v178, v179
    v_exp_f32_e64 v181, v89
    ds_read_b128 a[148:151], v205 offset:20480
    v_add_f32 v198, v198, v180
    v_add_f32 v198, v198, v181
    v_exp_f32_e64 v182, v90
    ds_read_b128 a[152:155], v206 offset:20480
    v_cvt_pk_bf16_f32 v154, v180, v181
    v_exp_f32 v183, v91
    v_exp_f32 v176, v76
    v_exp_f32_e64 v177, v77
    ds_read_b128 a[156:159], v207 offset:20480
    v_add_f32 v198, v198, v182
    v_add_f32 v198, v198, v183
    v_exp_f32 v178, v78
    v_exp_f32 v179, v79
    s_add_u32 m0, s37, 0x0
    v_exp_f32 v180, v92
    buffer_load_dwordx4 v252, s[8:11], s39 offen lds
    v_cvt_pk_bf16_f32 v155, v182, v183
    v_add_f32 v199, v176, v177
    v_exp_f32 v181, v93
    v_exp_f32_e64 v182, v94
    s_add_u32 m0, s37, 0x1000
    v_exp_f32_e64 v183, v95
    buffer_load_dwordx4 v253, s[8:11], s39 offen lds
    v_cvt_pk_bf16_f32 v156, v176, v177
    v_add_f32 v199, v199, v178
    v_add_f32 v199, v199, v179
    s_add_u32 m0, s38, 0x1a000
    v_cvt_pk_bf16_f32 v157, v178, v179
    v_add_f32 v199, v199, v180
    v_add_f32 v199, v199, v181
    buffer_load_dwordx4 v254, s[12:15], s39 offen lds
    v_cvt_pk_bf16_f32 v158, v180, v181
    v_add_f32 v199, v199, v182
    v_add_f32 v199, v199, v183
    v_cvt_pk_bf16_f32 v159, v182, v183
    v_max3_f32 v216, v196, v197, v198
    v_max_f32_e64 v216, v216, v199
    buffer_load_dwordx4 v255, s[12:15], s39 offen offset:1024 lds
    v_cmp_lt_f32 vcc, v224, v216
    s_addk_i32 s39, 0x2000
    s_cbranch_vccnz RARE_1
BACK_2:
    s_waitcnt lgkmcnt(0)
    s_waitcnt vmcnt(4)
    s_barrier
    s_cmp_lg_u32 s36, 0
    s_cbranch_scc1 K1_NOSIG
    s_mov_b64 s[44:45], exec
    s_mov_b64 exec, 1
    v_mov_b32_e64 v225, 1
    buffer_atomic_add v225, off, s[88:91], 0 sc1
    s_mov_b64 exec, s[44:45]
K1_NOSIG:
    s_nop 0
    s_nop 0
    s_nop 0
    s_nop 0
    s_nop 0
K1_LOOP:
    v_mfma_f32_16x16x32_bf16 v[64:67], a[128:131], v[0:3], v[128:131]
    v_exp_f32_e64 v176, v96
    v_mfma_f32_16x16x32_bf16 v[64:67], a[132:135], v[4:7], v[64:67]
    ds_read_b64_tr_b16 a[160:161], v208 offset:0
    v_add_f32_e64 v192, v192, v196
    v_mfma_f32_16x16x32_bf16 v[64:67], a[136:139], v[8:11], v[64:67]
    buffer_load_dwordx4 v[226:229], v251, s[16:19], s20 offen offset:0 sc1
    v_exp_f32_e64 v177, v97
    v_mfma_f32_16x16x32_bf16 v[64:67], a[140:143], v[12:15], v[64:67]
    ds_read_b64_tr_b16 a[162:163], v208 offset:4096
    v_add_f32_e64 v200, v176, v177
    v_mfma_f32_16x16x32_bf16 v[80:83], a[144:147], v[0:3], v[128:131]
    v_exp_f32_e64 v178, v98
    v_mfma_f32_16x16x32_bf16 v[80:83], a[148:151], v[4:7], v[80:83]
    ds_read_b64_tr_b16 a[164:165], v209 offset:0
    v_cvt_pk_bf16_f32 v160, v176, v177
    v_mfma_f32_16x16x32_bf16 v[80:83], a[152:155], v[8:11], v[80:83]
    buffer_load_dwordx4 v[230:233], v251, s[16:19], s20 offen offset:1024 sc1
    v_exp_f32_e64 v179, v99
    v_mfma_f32_16x16x32_bf16 v[80:83], a[156:159], v[12:15], v[80:83]
    ds_read_b64_tr_b16 a[166:167], v209 offset:4096
    v_add_f32 v200, v200, v178
    v_add_f32 v200, v200, v179
    v_mfma_f32_16x16x32_bf16 v[68:71], a[128:131], v[16:19], v[132:135]
    v_exp_f32_e64 v180, v112
    v_mfma_f32_16x16x32_bf16 v[68:71], a[132:135], v[20:23], v[68:71]
    ds_read_b64_tr_b16 a[168:169], v210 offset:0
    v_cvt_pk_bf16_f32 v161, v178, v179
    v_mfma_f32_16x16x32_bf16 v[68:71], a[136:139], v[24:27], v[68:71]
    buffer_load_dwordx4 v[234:237], v251, s[16:19], s20 offen offset:2048 sc1
    v_exp_f32_e64 v181, v113
    v_mfma_f32_16x16x32_bf16 v[68:71], a[140:143], v[28:31], v[68:71]
    ds_read_b64_tr_b16 a[170:171], v210 offset:4096
    v_add_f32 v200, v200, v180
    v_add_f32 v200, v200, v181
    v_mfma_f32_16x16x32_bf16 v[84:87], a[144:147], v[16:19], v[132:135]
    v_exp_f32_e64 v182, v114
    v_mfma_f32_16x16x32_bf16 v[84:87], a[148:151], v[20:23], v[84:87]
    ds_read_b64_tr_b16 a[172:173], v211 offset:0
    v_cvt_pk_bf16_f32 v162, v180, v181
    v_mfma_f32_16x16x32_bf16 v[84:87], a[152:155], v[24:27], v[84:87]
    buffer_load_dwordx4 v[238:241], v251, s[16:19], s20 offen offset:3072 sc1
    v_exp_f32_e64 v183, v115
    v_mfma_f32_16x16x32_bf16 v[84:87], a[156:159], v[28:31], v[84:87]
    ds_read_b64_tr_b16 a[174:175], v211 offset:4096
    v_add_f32 v200, v200, v182
    v_add_f32 v200, v200, v183
    v_mfma_f32_16x16x32_bf16 v[72:75], a[128:131], v[32:35], v[136:139]
    v_exp_f32_e64 v176, v100
    v_mfma_f32_16x16x32_bf16 v[72:75], a[132:135], v[36:39], v[72:75]
    ds_read_b64_tr_b16 a[176:177], v212 offset:0
    v_cvt_pk_bf16_f32 v163, v182, v183
    v_mfma_f32_16x16x32_bf16 v[72:75], a[136:139], v[40:43], v[72:75]
    buffer_load_dwordx4 v[242:245], v251, s[32:35], s21 offen sc1
    v_exp_f32_e64 v177, v101
    v_mfma_f32_16x16x32_bf16 v[72:75], a[140:143], v[44:47], v[72:75]
    ds_read_b64_tr_b16 a[178:179], v212 offset:4096
    v_add_f32_e64 v201, v176, v177
    v_mfma_f32_16x16x32_bf16 v[88:91], a[144:147], v[32:35], v[136:139]
    v_exp_f32_e64 v178, v102
    v_mfma_f32_16x16x32_bf16 v[88:91], a[148:151], v[36:39], v[88:91]
    ds_read_b64_tr_b16 a[180:181], v213 offset:0
    v_cvt_pk_bf16_f32 v164, v176, v177
    v_mfma_f32_16x16x32_bf16 v[88:91], a[152:155], v[40:43], v[88:91]
    buffer_load_dwordx4 v[246:249], v251, s[32:35], s22 offen sc1
    v_exp_f32_e64 v179, v103
    v_mfma_f32_16x16x32_bf16 v[88:91], a[156:159], v[44:47], v[88:91]
    ds_read_b64_tr_b16 a[182:183], v213 offset:4096
    v_add_f32 v201, v201, v178
    v_add_f32 v201, v201, v179
    v_mfma_f32_16x16x32_bf16 v[76:79], a[128:131], v[48:51], v[140:143]
    v_exp_f32_e64 v180, v116
    v_mfma_f32_16x16x32_bf16 v[76:79], a[132:135], v[52:55], v[76:79]
    ds_read_b64_tr_b16 a[184:185], v214 offset:0
    v_cvt_pk_bf16_f32 v165, v178, v179
    v_mfma_f32_16x16x32_bf16 v[76:79], a[136:139], v[56:59], v[76:79]
    buffer_load_dwordx4 v[184:187], v251, s[32:35], s23 offen sc1
    v_exp_f32_e64 v181, v117
    v_mfma_f32_16x16x32_bf16 v[76:79], a[140:143], v[60:63], v[76:79]
    ds_read_b64_tr_b16 a[186:187], v214 offset:4096
    v_add_f32 v201, v201, v180
    v_add_f32 v201, v201, v181
    v_mfma_f32_16x16x32_bf16 v[92:95], a[144:147], v[48:51], v[140:143]
    v_exp_f32_e64 v182, v118
    v_mfma_f32_16x16x32_bf16 v[92:95], a[148:151], v[52:55], v[92:95]
    ds_read_b64_tr_b16 a[188:189], v215 offset:0
    v_cvt_pk_bf16_f32 v166, v180, v181
    v_mfma_f32_16x16x32_bf16 v[92:95], a[152:155], v[56:59], v[92:95]
    s_waitcnt lgkmcnt(3)
    s_nop 0
    buffer_load_dwordx4 v[188:191], v251, s[32:35], s24 offen sc1
    v_exp_f32_e64 v183, v119
    v_mfma_f32_16x16x32_bf16 v[92:95], a[156:159], v[60:63], v[92:95]
    ds_read_b64_tr_b16 a[190:191], v215 offset:4096
    v_add_f32 v201, v201, v182
    v_add_f32 v201, v201, v183
    v_mfma_f32_16x16x32_bf16 a[0:3], a[160:163], v[144:147], a[0:3]
    v_exp_f32_e64 v176, v104
    v_mfma_f32_16x16x32_bf16 a[4:7], a[160:163], v[148:151], a[4:7]
    ds_read_b128 a[128:131], v204 offset:24576
    v_cvt_pk_bf16_f32 v167, v182, v183
    v_mfma_f32_16x16x32_bf16 a[8:11], a[160:163], v[152:155], a[8:11]
    s_add_u32 s20, s20, s25
    v_exp_f32 v177, v105
    v_mfma_f32_16x16x32_bf16 a[12:15], a[160:163], v[156:159], a[12:15]
    s_add_u32 s21, s21, s26
    s_nop 0
    ds_read_b128 a[132:135], v205 offset:24576
    v_add_f32_e64 v202, v176, v177
    v_mfma_f32_16x16x32_bf16 a[16:19], a[164:167], v[144:147], a[16:19]
    s_add_u32 s22, s22, s26
    v_exp_f32 v178, v106
    v_mfma_f32_16x16x32_bf16 a[20:23], a[164:167], v[148:151], a[20:23]
    s_add_u32 s23, s23, s26
    s_nop 0
    ds_read_b128 a[136:139], v206 offset:24576
    v_cvt_pk_bf16_f32 v168, v176, v177
    v_mfma_f32_16x16x32_bf16 a[24:27], a[164:167], v[152:155], a[24:27]
    s_add_u32 s24, s24, s26
    v_exp_f32 v179, v107
    v_mfma_f32_16x16x32_bf16 a[28:31], a[164:167], v[156:159], a[28:31]
    ds_read_b128 a[140:143], v207 offset:24576
    v_add_f32 v202, v202, v178
    v_add_f32 v202, v202, v179
    v_mfma_f32_16x16x32_bf16 a[32:35], a[168:171], v[144:147], a[32:35]
    v_exp_f32_e64 v180, v120
    v_mfma_f32_16x16x32_bf16 a[36:39], a[168:171], v[148:151], a[36:39]
    ds_read_b128 a[144:147], v204 offset:28672
    v_cvt_pk_bf16_f32 v169, v178, v179
    v_mfma_f32_16x16x32_bf16 a[40:43], a[168:171], v[152:155], a[40:43]
    v_exp_f32_e64 v181, v121
    v_mfma_f32_16x16x32_bf16 a[44:47], a[168:171], v[156:159], a[44:47]
    ds_read_b128 a[148:151], v205 offset:28672
    v_add_f32 v202, v202, v180
    v_add_f32 v202, v202, v181
    v_mfma_f32_16x16x32_bf16 a[48:51], a[172:175], v[144:147], a[48:51]
    v_exp_f32_e64 v182, v122
    v_mfma_f32_16x16x32_bf16 a[52:55], a[172:175], v[148:151], a[52:55]
    ds_read_b128 a[152:155], v206 offset:28672
    v_cvt_pk_bf16_f32 v170, v180, v181
    v_mfma_f32_16x16x32_bf16 a[56:59], a[172:175], v[152:155], a[56:59]
    v_exp_f32_e64 v183, v123
    v_mfma_f32_16x16x32_bf16 a[60:63], a[172:175], v[156:159], a[60:63]
    v_exp_f32_e64 v176, v108
    v_mfma_f32_16x16x32_bf16 a[64:67], a[176:179], v[144:147], a[64:67]
    v_exp_f32_e64 v177, v109
    v_mfma_f32_16x16x32_bf16 a[68:71], a[176:179], v[148:151], a[68:71]
    ds_read_b128 a[156:159], v207 offset:28672
    v_add_f32 v202, v202, v182
    v_add_f32 v202, v202, v183
    v_mfma_f32_16x16x32_bf16 a[72:75], a[176:179], v[152:155], a[72:75]
    v_exp_f32_e64 v178, v110
    v_mfma_f32_16x16x32_bf16 a[76:79], a[176:179], v[156:159], a[76:79]
    v_exp_f32_e64 v179, v111
    v_mfma_f32_16x16x32_bf16 a[80:83], a[180:183], v[144:147], a[80:83]
    s_add_u32 m0, s37, 0x2000
    v_exp_f32_e64 v180, v124
    v_mfma_f32_16x16x32_bf16 a[84:87], a[180:183], v[148:151], a[84:87]
    buffer_load_dwordx4 v252, s[8:11], s39 offen lds
    v_cvt_pk_bf16_f32 v171, v182, v183
    v_add_f32_e64 v203, v176, v177
    v_mfma_f32_16x16x32_bf16 a[88:91], a[180:183], v[152:155], a[88:91]
    v_exp_f32_e64 v181, v125
    v_mfma_f32_16x16x32_bf16 a[92:95], a[180:183], v[156:159], a[92:95]
    s_waitcnt lgkmcnt(8)
    v_exp_f32 v182, v126
    v_mfma_f32_16x16x32_bf16 a[96:99], a[184:187], v[144:147], a[96:99]
    s_add_u32 m0, s37, 0x3000
    v_exp_f32_e64 v183, v127
    v_mfma_f32_16x16x32_bf16 a[100:103], a[184:187], v[148:151], a[100:103]
    buffer_load_dwordx4 v253, s[8:11], s39 offen lds
    v_cvt_pk_bf16_f32 v172, v176, v177
    v_add_f32 v203, v203, v178
    v_add_f32 v203, v203, v179
    v_mfma_f32_16x16x32_bf16 a[104:107], a[184:187], v[152:155], a[104:107]
    s_add_u32 m0, s38, 0x1c000
    v_cvt_pk_bf16_f32 v173, v178, v179
    v_add_f32 v203, v203, v180
    v_add_f32 v203, v203, v181
    v_mfma_f32_16x16x32_bf16 a[108:111], a[184:187], v[156:159], a[108:111]
    buffer_load_dwordx4 v254, s[12:15], s39 offen lds
    v_cvt_pk_bf16_f32 v174, v180, v181
    v_add_f32 v203, v203, v182
    v_add_f32 v203, v203, v183
    v_mfma_f32_16x16x32_bf16 a[112:115], a[188:191], v[144:147], a[112:115]
    v_cvt_pk_bf16_f32 v175, v182, v183
    v_max3_f32 v216, v200, v201, v202
    v_max_f32_e64 v216, v216, v203
    v_mfma_f32_16x16x32_bf16 a[116:119], a[188:191], v[148:151], a[116:119]
    buffer_load_dwordx4 v255, s[12:15], s39 offen offset:1024 lds
    v_cmp_lt_f32 vcc, v224, v216
    v_add_f32 v193, v193, v197
    v_mfma_f32_16x16x32_bf16 a[120:123], a[188:191], v[152:155], a[120:123]
    s_addk_i32 s39, 0x2000
    v_add_f32 v194, v194, v198
    v_add_f32_e64 v195, v195, v199
    v_mfma_f32_16x16x32_bf16 a[124:127], a[188:191], v[156:159], a[124:127]
    s_cbranch_vccnz RARE_3
BACK_4:
    s_waitcnt vmcnt(16) lgkmcnt(0)
    s_barrier
    s_nop 0
    v_mfma_f32_16x16x32_bf16 v[96:99], a[128:131], v[0:3], v[128:131]
    v_exp_f32_e64 v176, v64
    v_mfma_f32_16x16x32_bf16 v[96:99], a[132:135], v[4:7], v[96:99]
    ds_read_b64_tr_b16 a[160:161], v208 offset:8192
    v_add_f32_e64 v192, v192, v200
    v_mfma_f32_16x16x32_bf16 v[96:99], a[136:139], v[8:11], v[96:99]
    v_exp_f32_e64 v177, v65
    v_mfma_f32_16x16x32_bf16 v[96:99], a[140:143], v[12:15], v[96:99]
    ds_read_b64_tr_b16 a[162:163], v208 offset:12288
    v_add_f32_e64 v196, v176, v177
    v_mfma_f32_16x16x32_bf16 v[112:115], a[144:147], v[0:3], v[128:131]
    v_exp_f32_e64 v178, v66
    v_mfma_f32_16x16x32_bf16 v[112:115], a[148:151], v[4:7], v[112:115]
    ds_read_b64_tr_b16 a[164:165], v209 offset:8192
    v_cvt_pk_bf16_f32 v144, v176, v177
    v_mfma_f32_16x16x32_bf16 v[112:115], a[152:155], v[8:11], v[112:115]
    v_exp_f32_e64 v179, v67
    v_mfma_f32_16x16x32_bf16 v[112:115], a[156:159], v[12:15], v[112:115]
    ds_read_b64_tr_b16 a[166:167], v209 offset:12288
    v_add_f32 v196, v196, v178
    v_add_f32 v196, v196, v179
    v_mfma_f32_16x16x32_bf16 v[100:103], a[128:131], v[16:19], v[132:135]
    v_exp_f32_e64 v180, v80
    v_mfma_f32_16x16x32_bf16 v[100:103], a[132:135], v[20:23], v[100:103]
    ds_read_b64_tr_b16 a[168:169], v210 offset:8192
    v_cvt_pk_bf16_f32 v145, v178, v179
    v_mfma_f32_16x16x32_bf16 v[100:103], a[136:139], v[24:27], v[100:103]
    v_exp_f32_e64 v181, v81
    v_mfma_f32_16x16x32_bf16 v[100:103], a[140:143], v[28:31], v[100:103]
    ds_read_b64_tr_b16 a[170:171], v210 offset:12288
    v_add_f32 v196, v196, v180
    v_add_f32 v196, v196, v181
    v_mfma_f32_16x16x32_bf16 v[116:119], a[144:147], v[16:19], v[132:135]
    v_exp_f32_e64 v182, v82
    v_mfma_f32_16x16x32_bf16 v[116:119], a[148:151], v[20:23], v[116:119]
    ds_read_b64_tr_b16 a[172:173], v211 offset:8192
    v_cvt_pk_bf16_f32 v146, v180, v181
    v_mfma_f32_16x16x32_bf16 v[116:119], a[152:155], v[24:27], v[116:119]
    v_exp_f32_e64 v183, v83
    v_mfma_f32_16x16x32_bf16 v[116:119], a[156:159], v[28:31], v[116:119]
    ds_read_b64_tr_b16 a[174:175], v211 offset:12288
    v_add_f32 v196, v196, v182
    v_add_f32 v196, v196, v183
    v_mfma_f32_16x16x32_bf16 v[104:107], a[128:131], v[32:35], v[136:139]
    v_exp_f32_e64 v176, v68
    v_mfma_f32_16x16x32_bf16 v[104:107], a[132:135], v[36:39], v[104:107]
    ds_read_b64_tr_b16 a[176:177], v212 offset:8192
    v_cvt_pk_bf16_f32 v147, v182, v183
    v_mfma_f32_16x16x32_bf16 v[104:107], a[136:139], v[40:43], v[104:107]
    v_exp_f32_e64 v177, v69
    v_mfma_f32_16x16x32_bf16 v[104:107], a[140:143], v[44:47], v[104:107]
    ds_read_b64_tr_b16 a[178:179], v212 offset:12288
    v_add_f32_e64 v197, v176, v177
    v_mfma_f32_16x16x32_bf16 v[120:123], a[144:147], v[32:35], v[136:139]
    v_exp_f32_e64 v178, v70
    v_mfma_f32_16x16x32_bf16 v[120:123], a[148:151], v[36:39], v[120:123]
    ds_read_b64_tr_b16 a[180:181], v213 offset:8192
    v_cvt_pk_bf16_f32 v148, v176, v177
    v_mfma_f32_16x16x32_bf16 v[120:123], a[152:155], v[40:43], v[120:123]
    v_exp_f32_e64 v179, v71
    v_mfma_f32_16x16x32_bf16 v[120:123], a[156:159], v[44:47], v[120:123]
    ds_read_b64_tr_b16 a[182:183], v213 offset:12288
    v_add_f32 v197, v197, v178
    v_add_f32 v197, v197, v179
    v_mfma_f32_16x16x32_bf16 v[108:111], a[128:131], v[48:51], v[140:143]
    v_exp_f32_e64 v180, v84
    v_mfma_f32_16x16x32_bf16 v[108:111], a[132:135], v[52:55], v[108:111]
    ds_read_b64_tr_b16 a[184:185], v214 offset:8192
    v_cvt_pk_bf16_f32 v149, v178, v179
    v_mfma_f32_16x16x32_bf16 v[108:111], a[136:139], v[56:59], v[108:111]
    v_exp_f32_e64 v181, v85
    v_mfma_f32_16x16x32_bf16 v[108:111], a[140:143], v[60:63], v[108:111]
    ds_read_b64_tr_b16 a[186:187], v214 offset:12288
    v_add_f32 v197, v197, v180
    v_add_f32 v197, v197, v181
    v_mfma_f32_16x16x32_bf16 v[124:127], a[144:147], v[48:51], v[140:143]
    v_exp_f32_e64 v182, v86
    v_mfma_f32_16x16x32_bf16 v[124:127], a[148:151], v[52:55], v[124:127]
    ds_read_b64_tr_b16 a[188:189], v215 offset:8192
    v_cvt_pk_bf16_f32 v150, v180, v181
    v_mfma_f32_16x16x32_bf16 v[124:127], a[152:155], v[56:59], v[124:127]
    s_waitcnt lgkmcnt(3)
    v_exp_f32 v183, v87
    v_mfma_f32_16x16x32_bf16 v[124:127], a[156:159], v[60:63], v[124:127]
    ds_read_b64_tr_b16 a[190:191], v215 offset:12288
    v_add_f32 v197, v197, v182
    v_add_f32 v197, v197, v183
    v_mfma_f32_16x16x32_bf16 a[0:3], a[160:163], v[160:163], a[0:3]
    v_exp_f32_e64 v176, v72
    v_mfma_f32_16x16x32_bf16 a[4:7], a[160:163], v[164:167], a[4:7]
    ds_read_b128 a[128:131], v204 offset:32768
    v_cvt_pk_bf16_f32 v151, v182, v183
    v_mfma_f32_16x16x32_bf16 a[8:11], a[160:163], v[168:171], a[8:11]
    v_exp_f32_e64 v177, v73
    v_mfma_f32_16x16x32_bf16 a[12:15], a[160:163], v[172:175], a[12:15]
    ds_read_b128 a[132:135], v205 offset:32768
    v_add_f32_e64 v198, v176, v177
    v_mfma_f32_16x16x32_bf16 a[16:19], a[164:167], v[160:163], a[16:19]
    v_exp_f32_e64 v178, v74
    v_mfma_f32_16x16x32_bf16 a[20:23], a[164:167], v[164:167], a[20:23]
    ds_read_b128 a[136:139], v206 offset:32768
    v_cvt_pk_bf16_f32 v152, v176, v177
    v_mfma_f32_16x16x32_bf16 a[24:27], a[164:167], v[168:171], a[24:27]
    v_exp_f32_e64 v179, v75
    v_mfma_f32_16x16x32_bf16 a[28:31], a[164:167], v[172:175], a[28:31]
    ds_read_b128 a[140:143], v207 offset:32768
    v_add_f32 v198, v198, v178
    v_add_f32 v198, v198, v179
    v_mfma_f32_16x16x32_bf16 a[32:35], a[168:171], v[160:163], a[32:35]
    v_exp_f32_e64 v180, v88
    v_mfma_f32_16x16x32_bf16 a[36:39], a[168:171], v[164:167], a[36:39]
    ds_read_b128 a[144:147], v204 offset:36864
    v_cvt_pk_bf16_f32 v153, v178, v179
    v_mfma_f32_16x16x32_bf16 a[40:43], a[168:171], v[168:171], a[40:43]
    v_exp_f32_e64 v181, v89
    v_mfma_f32_16x16x32_bf16 a[44:47], a[168:171], v[172:175], a[44:47]
    ds_read_b128 a[148:151], v205 offset:36864
    v_add_f32 v198, v198, v180
    v_add_f32 v198, v198, v181
    v_mfma_f32_16x16x32_bf16 a[48:51], a[172:175], v[160:163], a[48:51]
    v_exp_f32_e64 v182, v90
    v_mfma_f32_16x16x32_bf16 a[52:55], a[172:175], v[164:167], a[52:55]
    ds_read_b128 a[152:155], v206 offset:36864
    v_cvt_pk_bf16_f32 v154, v180, v181
    v_mfma_f32_16x16x32_bf16 a[56:59], a[172:175], v[168:171], a[56:59]
    v_exp_f32_e64 v183, v91
    v_mfma_f32_16x16x32_bf16 a[60:63], a[172:175], v[172:175], a[60:63]
    v_exp_f32_e64 v176, v76
    v_mfma_f32_16x16x32_bf16 a[64:67], a[176:179], v[160:163], a[64:67]
    v_exp_f32_e64 v177, v77
    v_mfma_f32_16x16x32_bf16 a[68:71], a[176:179], v[164:167], a[68:71]
    ds_read_b128 a[156:159], v207 offset:36864
    v_add_f32 v198, v198, v182
    v_add_f32 v198, v198, v183
    v_mfma_f32_16x16x32_bf16 a[72:75], a[176:179], v[168:171], a[72:75]
    v_exp_f32_e64 v178, v78
    v_mfma_f32_16x16x32_bf16 a[76:79], a[176:179], v[172:175], a[76:79]
    v_exp_f32_e64 v179, v79
    v_mfma_f32_16x16x32_bf16 a[80:83], a[180:183], v[160:163], a[80:83]
    s_add_u32 m0, s37, 0x4000
    v_exp_f32_e64 v180, v92
    v_mfma_f32_16x16x32_bf16 a[84:87], a[180:183], v[164:167], a[84:87]
    buffer_load_dwordx4 v252, s[8:11], s39 offen lds
    v_cvt_pk_bf16_f32 v155, v182, v183
    v_add_f32_e64 v199, v176, v177
    v_mfma_f32_16x16x32_bf16 a[88:91], a[180:183], v[168:171], a[88:91]
    v_exp_f32_e64 v181, v93
    v_mfma_f32_16x16x32_bf16 a[92:95], a[180:183], v[172:175], a[92:95]
    s_waitcnt lgkmcnt(8)
    v_exp_f32 v182, v94
    v_mfma_f32_16x16x32_bf16 a[96:99], a[184:187], v[160:163], a[96:99]
    s_add_u32 m0, s37, 0x5000
    v_exp_f32_e64 v183, v95
    v_mfma_f32_16x16x32_bf16 a[100:103], a[184:187], v[164:167], a[100:103]
    buffer_load_dwordx4 v253, s[8:11], s39 offen lds
    v_cvt_pk_bf16_f32 v156, v176, v177
    v_add_f32 v199, v199, v178
    v_add_f32 v199, v199, v179
    v_mfma_f32_16x16x32_bf16 a[104:107], a[184:187], v[168:171], a[104:107]
    s_add_u32 m0, s38, 0x1e000
    v_cvt_pk_bf16_f32 v157, v178, v179
    v_add_f32 v199, v199, v180
    v_add_f32 v199, v199, v181
    v_mfma_f32_16x16x32_bf16 a[108:111], a[184:187], v[172:175], a[108:111]
    buffer_load_dwordx4 v254, s[12:15], s39 offen lds
    v_cvt_pk_bf16_f32 v158, v180, v181
    v_add_f32 v199, v199, v182
    v_add_f32 v199, v199, v183
    v_mfma_f32_16x16x32_bf16 a[112:115], a[188:191], v[160:163], a[112:115]
    v_cvt_pk_bf16_f32 v159, v182, v183
    v_max3_f32 v216, v196, v197, v198
    v_max_f32_e64 v216, v216, v199
    v_mfma_f32_16x16x32_bf16 a[116:119], a[188:191], v[164:167], a[116:119]
    buffer_load_dwordx4 v255, s[12:15], s39 offen offset:1024 lds
    v_cmp_lt_f32 vcc, v224, v216
    v_add_f32 v193, v193, v201
    v_mfma_f32_16x16x32_bf16 a[120:123], a[188:191], v[168:171], a[120:123]
    s_addk_i32 s39, 0x2000
    v_add_f32 v194, v194, v202
    v_add_f32_e64 v195, v195, v203
    v_mfma_f32_16x16x32_bf16 a[124:127], a[188:191], v[172:175], a[124:127]
    s_cbranch_vccnz RARE_5
BACK_6:
    s_waitcnt lgkmcnt(0)
    v_mfma_f32_16x16x32_bf16 v[64:67], a[128:131], v[0:3], v[128:131]
    s_waitcnt vmcnt(8)
    v_exp_f32 v176, v96
    v_mfma_f32_16x16x32_bf16 v[64:67], a[132:135], v[4:7], v[64:67]
    ds_read_b64_tr_b16 a[160:161], v208 offset:16384
    v_add_f32_e64 v192, v192, v196
    v_mfma_f32_16x16x32_bf16 v[64:67], a[136:139], v[8:11], v[64:67]
    v_exp_f32_e64 v177, v97
    v_mfma_f32_16x16x32_bf16 v[64:67], a[140:143], v[12:15], v[64:67]
    ds_read_b64_tr_b16 a[162:163], v208 offset:20480
    v_add_f32_e64 v200, v176, v177
    v_mfma_f32_16x16x32_bf16 a[192:195], v[226:229], v[242:245], a[192:195]
    v_cvt_pk_bf16_f32 v160, v176, v177
    v_add_f32_e64 v193, v193, v197
    v_mfma_f32_16x16x32_bf16 v[80:83], a[144:147], v[0:3], v[128:131]
    v_exp_f32_e64 v178, v98
    v_mfma_f32_16x16x32_bf16 v[80:83], a[148:151], v[4:7], v[80:83]
    ds_read_b64_tr_b16 a[164:165], v209 offset:16384
    v_add_f32_e64 v200, v200, v178
    v_mfma_f32_16x16x32_bf16 v[80:83], a[152:155], v[8:11], v[80:83]
    v_exp_f32_e64 v179, v99
    v_mfma_f32_16x16x32_bf16 v[80:83], a[156:159], v[12:15], v[80:83]
    ds_read_b64_tr_b16 a[166:167], v209 offset:20480
    v_add_f32_e64 v200, v200, v179
    v_mfma_f32_16x16x32_bf16 a[196:199], v[226:229], v[246:249], a[196:199]
    v_cvt_pk_bf16_f32 v161, v178, v179
    v_add_f32_e64 v194, v194, v198
    v_mfma_f32_16x16x32_bf16 v[68:71], a[128:131], v[16:19], v[132:135]
    v_exp_f32_e64 v180, v112
    v_mfma_f32_16x16x32_bf16 v[68:71], a[132:135], v[20:23], v[68:71]
    ds_read_b64_tr_b16 a[168:169], v210 offset:16384
    v_add_f32_e64 v200, v200, v180
    v_mfma_f32_16x16x32_bf16 v[68:71], a[136:139], v[24:27], v[68:71]
    v_exp_f32_e64 v181, v113
    v_mfma_f32_16x16x32_bf16 v[68:71], a[140:143], v[28:31], v[68:71]
    ds_read_b64_tr_b16 a[170:171], v210 offset:20480
    v_add_f32_e64 v200, v200, v181
    v_mfma_f32_16x16x32_bf16 a[200:203], v[226:229], v[184:187], a[200:203]
    v_cvt_pk_bf16_f32 v162, v180, v181
    v_add_f32_e64 v195, v195, v199
    v_mfma_f32_16x16x32_bf16 v[84:87], a[144:147], v[16:19], v[132:135]
    v_exp_f32_e64 v182, v114
    v_mfma_f32_16x16x32_bf16 v[84:87], a[148:151], v[20:23], v[84:87]
    ds_read_b64_tr_b16 a[172:173], v211 offset:16384
    v_add_f32_e64 v200, v200, v182
    v_mfma_f32_16x16x32_bf16 v[84:87], a[152:155], v[24:27], v[84:87]
    v_exp_f32_e64 v183, v115
    v_mfma_f32_16x16x32_bf16 v[84:87], a[156:159], v[28:31], v[84:87]
    ds_read_b64_tr_b16 a[174:175], v211 offset:20480
    v_add_f32_e64 v200, v200, v183
    v_mfma_f32_16x16x32_bf16 a[204:207], v[226:229], v[188:191], a[204:207]
    v_cvt_pk_bf16_f32 v163, v182, v183
    v_mfma_f32_16x16x32_bf16 v[72:75], a[128:131], v[32:35], v[136:139]
    v_exp_f32_e64 v176, v100
    v_mfma_f32_16x16x32_bf16 v[72:75], a[132:135], v[36:39], v[72:75]
    ds_read_b64_tr_b16 a[176:177], v212 offset:16384
    v_mfma_f32_16x16x32_bf16 v[72:75], a[136:139], v[40:43], v[72:75]
    v_exp_f32_e64 v177, v101
    v_mfma_f32_16x16x32_bf16 v[72:75], a[140:143], v[44:47], v[72:75]
    ds_read_b64_tr_b16 a[178:179], v212 offset:20480
    v_add_f32_e64 v201, v176, v177
    v_mfma_f32_16x16x32_bf16 a[208:211], v[230:233], v[242:245], a[208:211]
    v_cvt_pk_bf16_f32 v164, v176, v177
    v_mfma_f32_16x16x32_bf16 v[88:91], a[144:147], v[32:35], v[136:139]
    v_exp_f32_e64 v178, v102
    v_mfma_f32_16x16x32_bf16 v[88:91], a[148:151], v[36:39], v[88:91]
    ds_read_b64_tr_b16 a[180:181], v213 offset:16384
    v_add_f32_e64 v201, v201, v178
    v_mfma_f32_16x16x32_bf16 v[88:91], a[152:155], v[40:43], v[88:91]
    v_exp_f32_e64 v179, v103
    v_mfma_f32_16x16x32_bf16 v[88:91], a[156:159], v[44:47], v[88:91]
    ds_read_b64_tr_b16 a[182:183], v213 offset:20480
    v_add_f32_e64 v201, v201, v179
    v_mfma_f32_16x16x32_bf16 a[212:215], v[230:233], v[246:249], a[212:215]
    v_cvt_pk_bf16_f32 v165, v178, v179
    v_mfma_f32_16x16x32_bf16 v[76:79], a[128:131], v[48:51], v[140:143]
    v_exp_f32_e64 v180, v116
    v_mfma_f32_16x16x32_bf16 v[76:79], a[132:135], v[52:55], v[76:79]
    ds_read_b64_tr_b16 a[184:185], v214 offset:16384
    v_add_f32_e64 v201, v201, v180
    v_mfma_f32_16x16x32_bf16 v[76:79], a[136:139], v[56:59], v[76:79]
    v_exp_f32_e64 v181, v117
    v_mfma_f32_16x16x32_bf16 v[76:79], a[140:143], v[60:63], v[76:79]
    ds_read_b64_tr_b16 a[186:187], v214 offset:20480
    v_add_f32_e64 v201, v201, v181
    v_mfma_f32_16x16x32_bf16 a[216:219], v[230:233], v[184:187], a[216:219]
    v_cvt_pk_bf16_f32 v166, v180, v181
    v_mfma_f32_16x16x32_bf16 v[92:95], a[144:147], v[48:51], v[140:143]
    v_exp_f32_e64 v182, v118
    v_mfma_f32_16x16x32_bf16 v[92:95], a[148:151], v[52:55], v[92:95]
    ds_read_b64_tr_b16 a[188:189], v215 offset:16384
    v_add_f32_e64 v201, v201, v182
    v_mfma_f32_16x16x32_bf16 v[92:95], a[152:155], v[56:59], v[92:95]
    s_waitcnt lgkmcnt(3)
    v_exp_f32 v183, v119
    v_mfma_f32_16x16x32_bf16 v[92:95], a[156:159], v[60:63], v[92:95]
    ds_read_b64_tr_b16 a[190:191], v215 offset:20480
    v_add_f32_e64 v201, v201, v183
    v_mfma_f32_16x16x32_bf16 a[220:223], v[230:233], v[188:191], a[220:223]
    v_cvt_pk_bf16_f32 v167, v182, v183
    v_mfma_f32_16x16x32_bf16 a[0:3], a[160:163], v[144:147], a[0:3]
    v_exp_f32_e64 v176, v104
    v_mfma_f32_16x16x32_bf16 a[4:7], a[160:163], v[148:151], a[4:7]
    ds_read_b128 a[128:131], v204 offset:40960
    v_mfma_f32_16x16x32_bf16 a[8:11], a[160:163], v[152:155], a[8:11]
    v_exp_f32_e64 v177, v105
    v_mfma_f32_16x16x32_bf16 a[12:15], a[160:163], v[156:159], a[12:15]
    ds_read_b128 a[132:135], v205 offset:40960
    v_add_f32_e64 v202, v176, v177
    v_mfma_f32_16x16x32_bf16 a[224:227], v[234:237], v[242:245], a[224:227]
    v_cvt_pk_bf16_f32 v168, v176, v177
    v_mfma_f32_16x16x32_bf16 a[16:19], a[164:167], v[144:147], a[16:19]
    v_exp_f32_e64 v178, v106
    v_mfma_f32_16x16x32_bf16 a[20:23], a[164:167], v[148:151], a[20:23]
    ds_read_b128 a[136:139], v206 offset:40960
    v_add_f32_e64 v202, v202, v178
    v_mfma_f32_16x16x32_bf16 a[24:27], a[164:167], v[152:155], a[24:27]
    v_exp_f32_e64 v179, v107
    v_mfma_f32_16x16x32_bf16 a[28:31], a[164:167], v[156:159], a[28:31]
    ds_read_b128 a[140:143], v207 offset:40960
    v_add_f32_e64 v202, v202, v179
    v_mfma_f32_16x16x32_bf16 a[228:231], v[234:237], v[246:249], a[228:231]
    v_cvt_pk_bf16_f32 v169, v178, v179
    v_mfma_f32_16x16x32_bf16 a[32:35], a[168:171], v[144:147], a[32:35]
    v_exp_f32_e64 v180, v120
    v_mfma_f32_16x16x32_bf16 a[36:39], a[168:171], v[148:151], a[36:39]
    ds_read_b128 a[144:147], v204 offset:45056
    v_add_f32_e64 v202, v202, v180
    v_mfma_f32_16x16x32_bf16 a[40:43], a[168:171], v[152:155], a[40:43]
    v_exp_f32_e64 v181, v121
    v_mfma_f32_16x16x32_bf16 a[44:47], a[168:171], v[156:159], a[44:47]
    ds_read_b128 a[148:151], v205 offset:45056
    v_add_f32_e64 v202, v202, v181
    v_mfma_f32_16x16x32_bf16 a[232:235], v[234:237], v[184:187], a[232:235]
    v_cvt_pk_bf16_f32 v170, v180, v181
    v_mfma_f32_16x16x32_bf16 a[48:51], a[172:175], v[144:147], a[48:51]
    v_exp_f32_e64 v182, v122
    v_mfma_f32_16x16x32_bf16 a[52:55], a[172:175], v[148:151], a[52:55]
    ds_read_b128 a[152:155], v206 offset:45056
    v_add_f32_e64 v202, v202, v182
    v_mfma_f32_16x16x32_bf16 a[56:59], a[172:175], v[152:155], a[56:59]
    v_exp_f32_e64 v183, v123
    v_mfma_f32_16x16x32_bf16 a[60:63], a[172:175], v[156:159], a[60:63]
    v_exp_f32_e64 v176, v108
    v_mfma_f32_16x16x32_bf16 a[236:239], v[234:237], v[188:191], a[236:239]
    v_add_f32_e64 v202, v202, v183
    v_cvt_pk_bf16_f32 v171, v182, v183
    v_mfma_f32_16x16x32_bf16 a[64:67], a[176:179], v[144:147], a[64:67]
    v_exp_f32_e64 v177, v109
    v_mfma_f32_16x16x32_bf16 a[68:71], a[176:179], v[148:151], a[68:71]
    ds_read_b128 a[156:159], v207 offset:45056
    v_add_f32_e64 v203, v176, v177
    v_mfma_f32_16x16x32_bf16 a[72:75], a[176:179], v[152:155], a[72:75]
    v_exp_f32_e64 v178, v110
    v_mfma_f32_16x16x32_bf16 a[76:79], a[176:179], v[156:159], a[76:79]
    v_exp_f32_e64 v179, v111
    v_mfma_f32_16x16x32_bf16 a[240:243], v[238:241], v[242:245], a[240:243]
    v_cvt_pk_bf16_f32 v172, v176, v177
    v_add_f32 v203, v203, v178
    v_add_f32 v203, v203, v179
    v_mfma_f32_16x16x32_bf16 a[80:83], a[180:183], v[144:147], a[80:83]
    s_add_u32 m0, s37, 0x6000
    v_exp_f32_e64 v180, v124
    v_mfma_f32_16x16x32_bf16 a[84:87], a[180:183], v[148:151], a[84:87]
    buffer_load_dwordx4 v252, s[8:11], s39 offen lds
    v_cvt_pk_bf16_f32 v173, v178, v179
    v_mfma_f32_16x16x32_bf16 a[88:91], a[180:183], v[152:155], a[88:91]
    v_exp_f32_e64 v181, v125
    v_mfma_f32_16x16x32_bf16 a[92:95], a[180:183], v[156:159], a[92:95]
    s_waitcnt lgkmcnt(8)
    v_exp_f32 v182, v126
    v_mfma_f32_16x16x32_bf16 a[244:247], v[238:241], v[246:249], a[244:247]
    v_add_f32 v203, v203, v180
    v_add_f32 v203, v203, v181
    v_cvt_pk_bf16_f32 v174, v180, v181
    v_mfma_f32_16x16x32_bf16 a[96:99], a[184:187], v[144:147], a[96:99]
    s_add_u32 m0, s37, 0x7000
    v_exp_f32_e64 v183, v127
    v_mfma_f32_16x16x32_bf16 a[100:103], a[184:187], v[148:151], a[100:103]
    buffer_load_dwordx4 v253, s[8:11], s39 offen lds
    v_add_f32 v203, v203, v182
    v_add_f32 v203, v203, v183
    v_mfma_f32_16x16x32_bf16 a[104:107], a[184:187], v[152:155], a[104:107]
    s_add_u32 m0, s38, 0x10000
    v_cvt_pk_bf16_f32 v175, v182, v183
    v_max3_f32 v216, v200, v201, v202
    v_max_f32_e64 v216, v216, v203
    v_mfma_f32_16x16x32_bf16 a[108:111], a[184:187], v[156:159], a[108:111]
    buffer_load_dwordx4 v254, s[12:15], s39 offen lds
    v_cmp_lt_f32 vcc, v224, v216
    s_nop 0
    v_mfma_f32_16x16x32_bf16 a[248:251], v[238:241], v[184:187], a[248:251]
    v_mfma_f32_16x16x32_bf16 a[112:115], a[188:191], v[144:147], a[112:115]
    v_mfma_f32_16x16x32_bf16 a[116:119], a[188:191], v[148:151], a[116:119]
    buffer_load_dwordx4 v255, s[12:15], s39 offen offset:1024 lds
    v_mfma_f32_16x16x32_bf16 a[120:123], a[188:191], v[152:155], a[120:123]
    s_addk_i32 s39, 0x2000
    s_nop 0
    v_mfma_f32_16x16x32_bf16 a[124:127], a[188:191], v[156:159], a[124:127]
    v_mfma_f32_16x16x32_bf16 a[252:255], v[238:241], v[188:191], a[252:255]
    s_cbranch_vccnz RARE_7
BACK_8:
    s_waitcnt vmcnt(16) lgkmcnt(0)
    s_barrier
    s_nop 0
    v_mfma_f32_16x16x32_bf16 v[96:99], a[128:131], v[0:3], v[128:131]
    v_exp_f32_e64 v176, v64
    v_mfma_f32_16x16x32_bf16 v[96:99], a[132:135], v[4:7], v[96:99]
    ds_read_b64_tr_b16 a[160:161], v208 offset:24576
    v_add_f32_e64 v192, v192, v200
    v_mfma_f32_16x16x32_bf16 v[96:99], a[136:139], v[8:11], v[96:99]
    v_exp_f32_e64 v177, v65
    v_mfma_f32_16x16x32_bf16 v[96:99], a[140:143], v[12:15], v[96:99]
    ds_read_b64_tr_b16 a[162:163], v208 offset:28672
    v_add_f32_e64 v196, v176, v177
    v_mfma_f32_16x16x32_bf16 v[112:115], a[144:147], v[0:3], v[128:131]
    v_exp_f32_e64 v178, v66
    v_mfma_f32_16x16x32_bf16 v[112:115], a[148:151], v[4:7], v[112:115]
    ds_read_b64_tr_b16 a[164:165], v209 offset:24576
    v_cvt_pk_bf16_f32 v144, v176, v177
    v_mfma_f32_16x16x32_bf16 v[112:115], a[152:155], v[8:11], v[112:115]
    v_exp_f32_e64 v179, v67
    v_mfma_f32_16x16x32_bf16 v[112:115], a[156:159], v[12:15], v[112:115]
    ds_read_b64_tr_b16 a[166:167], v209 offset:28672
    v_add_f32 v196, v196, v178
    v_add_f32 v196, v196, v179
    v_mfma_f32_16x16x32_bf16 v[100:103], a[128:131], v[16:19], v[132:135]
    v_exp_f32_e64 v180, v80
    v_mfma_f32_16x16x32_bf16 v[100:103], a[132:135], v[20:23], v[100:103]
    ds_read_b64_tr_b16 a[168:169], v210 offset:24576
    v_cvt_pk_bf16_f32 v145, v178, v179
    v_mfma_f32_16x16x32_bf16 v[100:103], a[136:139], v[24:27], v[100:103]
    v_exp_f32_e64 v181, v81
    v_mfma_f32_16x16x32_bf16 v[100:103], a[140:143], v[28:31], v[100:103]
    ds_read_b64_tr_b16 a[170:171], v210 offset:28672
    v_add_f32 v196, v196, v180
    v_add_f32 v196, v196, v181
    v_mfma_f32_16x16x32_bf16 v[116:119], a[144:147], v[16:19], v[132:135]
    v_exp_f32_e64 v182, v82
    v_mfma_f32_16x16x32_bf16 v[116:119], a[148:151], v[20:23], v[116:119]
    ds_read_b64_tr_b16 a[172:173], v211 offset:24576
    v_cvt_pk_bf16_f32 v146, v180, v181
    v_mfma_f32_16x16x32_bf16 v[116:119], a[152:155], v[24:27], v[116:119]
    v_exp_f32_e64 v183, v83
    v_mfma_f32_16x16x32_bf16 v[116:119], a[156:159], v[28:31], v[116:119]
    ds_read_b64_tr_b16 a[174:175], v211 offset:28672
    v_add_f32 v196, v196, v182
    v_add_f32 v196, v196, v183
    v_mfma_f32_16x16x32_bf16 v[104:107], a[128:131], v[32:35], v[136:139]
    v_exp_f32_e64 v176, v68
    v_mfma_f32_16x16x32_bf16 v[104:107], a[132:135], v[36:39], v[104:107]
    ds_read_b64_tr_b16 a[176:177], v212 offset:24576
    v_cvt_pk_bf16_f32 v147, v182, v183
    v_mfma_f32_16x16x32_bf16 v[104:107], a[136:139], v[40:43], v[104:107]
    v_exp_f32_e64 v177, v69
    v_mfma_f32_16x16x32_bf16 v[104:107], a[140:143], v[44:47], v[104:107]
    ds_read_b64_tr_b16 a[178:179], v212 offset:28672
    v_add_f32_e64 v197, v176, v177
    v_mfma_f32_16x16x32_bf16 v[120:123], a[144:147], v[32:35], v[136:139]
    v_exp_f32_e64 v178, v70
    v_mfma_f32_16x16x32_bf16 v[120:123], a[148:151], v[36:39], v[120:123]
    ds_read_b64_tr_b16 a[180:181], v213 offset:24576
    v_cvt_pk_bf16_f32 v148, v176, v177
    v_mfma_f32_16x16x32_bf16 v[120:123], a[152:155], v[40:43], v[120:123]
    v_exp_f32_e64 v179, v71
    v_mfma_f32_16x16x32_bf16 v[120:123], a[156:159], v[44:47], v[120:123]
    ds_read_b64_tr_b16 a[182:183], v213 offset:28672
    v_add_f32 v197, v197, v178
    v_add_f32 v197, v197, v179
    v_mfma_f32_16x16x32_bf16 v[108:111], a[128:131], v[48:51], v[140:143]
    v_exp_f32_e64 v180, v84
    v_mfma_f32_16x16x32_bf16 v[108:111], a[132:135], v[52:55], v[108:111]
    ds_read_b64_tr_b16 a[184:185], v214 offset:24576
    v_cvt_pk_bf16_f32 v149, v178, v179
    v_mfma_f32_16x16x32_bf16 v[108:111], a[136:139], v[56:59], v[108:111]
    v_exp_f32_e64 v181, v85
    v_mfma_f32_16x16x32_bf16 v[108:111], a[140:143], v[60:63], v[108:111]
    ds_read_b64_tr_b16 a[186:187], v214 offset:28672
    v_add_f32 v197, v197, v180
    v_add_f32 v197, v197, v181
    v_mfma_f32_16x16x32_bf16 v[124:127], a[144:147], v[48:51], v[140:143]
    v_exp_f32_e64 v182, v86
    v_mfma_f32_16x16x32_bf16 v[124:127], a[148:151], v[52:55], v[124:127]
    ds_read_b64_tr_b16 a[188:189], v215 offset:24576
    v_cvt_pk_bf16_f32 v150, v180, v181
    v_mfma_f32_16x16x32_bf16 v[124:127], a[152:155], v[56:59], v[124:127]
    s_waitcnt lgkmcnt(3)
    v_exp_f32 v183, v87
    v_mfma_f32_16x16x32_bf16 v[124:127], a[156:159], v[60:63], v[124:127]
    ds_read_b64_tr_b16 a[190:191], v215 offset:28672
    v_add_f32 v197, v197, v182
    v_add_f32 v197, v197, v183
    v_mfma_f32_16x16x32_bf16 a[0:3], a[160:163], v[160:163], a[0:3]
    v_exp_f32_e64 v176, v72
    v_mfma_f32_16x16x32_bf16 a[4:7], a[160:163], v[164:167], a[4:7]
    ds_read_b128 a[128:131], v204 offset:49152
    v_cvt_pk_bf16_f32 v151, v182, v183
    v_mfma_f32_16x16x32_bf16 a[8:11], a[160:163], v[168:171], a[8:11]
    v_exp_f32_e64 v177, v73
    v_mfma_f32_16x16x32_bf16 a[12:15], a[160:163], v[172:175], a[12:15]
    ds_read_b128 a[132:135], v205 offset:49152
    v_add_f32_e64 v198, v176, v177
    v_mfma_f32_16x16x32_bf16 a[16:19], a[164:167], v[160:163], a[16:19]
    v_exp_f32_e64 v178, v74
    v_mfma_f32_16x16x32_bf16 a[20:23], a[164:167], v[164:167], a[20:23]
    ds_read_b128 a[136:139], v206 offset:49152
    v_cvt_pk_bf16_f32 v152, v176, v177
    v_mfma_f32_16x16x32_bf16 a[24:27], a[164:167], v[168:171], a[24:27]
    v_exp_f32_e64 v179, v75
    v_mfma_f32_16x16x32_bf16 a[28:31], a[164:167], v[172:175], a[28:31]
    ds_read_b128 a[140:143], v207 offset:49152
    v_add_f32 v198, v198, v178
    v_add_f32 v198, v198, v179
    v_mfma_f32_16x16x32_bf16 a[32:35], a[168:171], v[160:163], a[32:35]
    v_exp_f32_e64 v180, v88
    v_mfma_f32_16x16x32_bf16 a[36:39], a[168:171], v[164:167], a[36:39]
    ds_read_b128 a[144:147], v204 offset:53248
    v_cvt_pk_bf16_f32 v153, v178, v179
    v_mfma_f32_16x16x32_bf16 a[40:43], a[168:171], v[168:171], a[40:43]
    v_exp_f32_e64 v181, v89
    v_mfma_f32_16x16x32_bf16 a[44:47], a[168:171], v[172:175], a[44:47]
    ds_read_b128 a[148:151], v205 offset:53248
    v_add_f32 v198, v198, v180
    v_add_f32 v198, v198, v181
    v_mfma_f32_16x16x32_bf16 a[48:51], a[172:175], v[160:163], a[48:51]
    v_exp_f32_e64 v182, v90
    v_mfma_f32_16x16x32_bf16 a[52:55], a[172:175], v[164:167], a[52:55]
    ds_read_b128 a[152:155], v206 offset:53248
    v_cvt_pk_bf16_f32 v154, v180, v181
    v_mfma_f32_16x16x32_bf16 a[56:59], a[172:175], v[168:171], a[56:59]
    v_exp_f32_e64 v183, v91
    v_mfma_f32_16x16x32_bf16 a[60:63], a[172:175], v[172:175], a[60:63]
    v_exp_f32_e64 v176, v76
    v_mfma_f32_16x16x32_bf16 a[64:67], a[176:179], v[160:163], a[64:67]
    v_exp_f32_e64 v177, v77
    v_mfma_f32_16x16x32_bf16 a[68:71], a[176:179], v[164:167], a[68:71]
    ds_read_b128 a[156:159], v207 offset:53248
    v_add_f32 v198, v198, v182
    v_add_f32 v198, v198, v183
    v_mfma_f32_16x16x32_bf16 a[72:75], a[176:179], v[168:171], a[72:75]
    v_exp_f32_e64 v178, v78
    v_mfma_f32_16x16x32_bf16 a[76:79], a[176:179], v[172:175], a[76:79]
    v_exp_f32_e64 v179, v79
    v_mfma_f32_16x16x32_bf16 a[80:83], a[180:183], v[160:163], a[80:83]
    s_add_u32 m0, s37, 0x8000
    v_exp_f32_e64 v180, v92
    v_mfma_f32_16x16x32_bf16 a[84:87], a[180:183], v[164:167], a[84:87]
    buffer_load_dwordx4 v252, s[8:11], s39 offen lds
    v_cvt_pk_bf16_f32 v155, v182, v183
    v_add_f32_e64 v199, v176, v177
    v_mfma_f32_16x16x32_bf16 a[88:91], a[180:183], v[168:171], a[88:91]
    v_exp_f32_e64 v181, v93
    v_mfma_f32_16x16x32_bf16 a[92:95], a[180:183], v[172:175], a[92:95]
    s_waitcnt lgkmcnt(8)
    v_exp_f32 v182, v94
    v_mfma_f32_16x16x32_bf16 a[96:99], a[184:187], v[160:163], a[96:99]
    s_add_u32 m0, s37, 0x9000
    v_exp_f32_e64 v183, v95
    v_mfma_f32_16x16x32_bf16 a[100:103], a[184:187], v[164:167], a[100:103]
    buffer_load_dwordx4 v253, s[8:11], s39 offen lds
    v_cvt_pk_bf16_f32 v156, v176, v177
    v_add_f32 v199, v199, v178
    v_add_f32 v199, v199, v179
    v_mfma_f32_16x16x32_bf16 a[104:107], a[184:187], v[168:171], a[104:107]
    s_add_u32 m0, s38, 0x12000
    v_cvt_pk_bf16_f32 v157, v178, v179
    v_add_f32 v199, v199, v180
    v_add_f32 v199, v199, v181
    v_mfma_f32_16x16x32_bf16 a[108:111], a[184:187], v[172:175], a[108:111]
    buffer_load_dwordx4 v254, s[12:15], s39 offen lds
    v_cvt_pk_bf16_f32 v158, v180, v181
    v_add_f32 v199, v199, v182
    v_add_f32 v199, v199, v183
    v_mfma_f32_16x16x32_bf16 a[112:115], a[188:191], v[160:163], a[112:115]
    v_cvt_pk_bf16_f32 v159, v182, v183
    v_max3_f32 v216, v196, v197, v198
    v_max_f32_e64 v216, v216, v199
    v_mfma_f32_16x16x32_bf16 a[116:119], a[188:191], v[164:167], a[116:119]
    buffer_load_dwordx4 v255, s[12:15], s39 offen offset:1024 lds
    v_cmp_lt_f32 vcc, v224, v216
    v_add_f32 v193, v193, v201
    v_mfma_f32_16x16x32_bf16 a[120:123], a[188:191], v[168:171], a[120:123]
    s_addk_i32 s39, 0x2000
    v_add_f32 v194, v194, v202
    v_add_f32_e64 v195, v195, v203
    v_mfma_f32_16x16x32_bf16 a[124:127], a[188:191], v[172:175], a[124:127]
    s_cbranch_vccnz RARE_9
BACK_10:
    s_waitcnt lgkmcnt(0)
    v_mfma_f32_16x16x32_bf16 v[64:67], a[128:131], v[0:3], v[128:131]
    v_exp_f32_e64 v176, v96
    v_mfma_f32_16x16x32_bf16 v[64:67], a[132:135], v[4:7], v[64:67]
    ds_read_b64_tr_b16 a[160:161], v208 offset:32768
    v_add_f32_e64 v192, v192, v196
    v_mfma_f32_16x16x32_bf16 v[64:67], a[136:139], v[8:11], v[64:67]
    buffer_load_dwordx4 v[226:229], v251, s[16:19], s20 offen offset:0 sc1
    v_exp_f32_e64 v177, v97
    v_mfma_f32_16x16x32_bf16 v[64:67], a[140:143], v[12:15], v[64:67]
    ds_read_b64_tr_b16 a[162:163], v208 offset:36864
    v_add_f32_e64 v200, v176, v177
    v_mfma_f32_16x16x32_bf16 v[80:83], a[144:147], v[0:3], v[128:131]
    v_exp_f32_e64 v178, v98
    v_mfma_f32_16x16x32_bf16 v[80:83], a[148:151], v[4:7], v[80:83]
    ds_read_b64_tr_b16 a[164:165], v209 offset:32768
    v_cvt_pk_bf16_f32 v160, v176, v177
    v_mfma_f32_16x16x32_bf16 v[80:83], a[152:155], v[8:11], v[80:83]
    buffer_load_dwordx4 v[230:233], v251, s[16:19], s20 offen offset:1024 sc1
    v_exp_f32_e64 v179, v99
    v_mfma_f32_16x16x32_bf16 v[80:83], a[156:159], v[12:15], v[80:83]
    ds_read_b64_tr_b16 a[166:167], v209 offset:36864
    v_add_f32 v200, v200, v178
    v_add_f32 v200, v200, v179
    v_mfma_f32_16x16x32_bf16 v[68:71], a[128:131], v[16:19], v[132:135]
    v_exp_f32_e64 v180, v112
    v_mfma_f32_16x16x32_bf16 v[68:71], a[132:135], v[20:23], v[68:71]
    ds_read_b64_tr_b16 a[168:169], v210 offset:32768
    v_cvt_pk_bf16_f32 v161, v178, v179
    v_mfma_f32_16x16x32_bf16 v[68:71], a[136:139], v[24:27], v[68:71]
    buffer_load_dwordx4 v[234:237], v251, s[16:19], s20 offen offset:2048 sc1
    v_exp_f32_e64 v181, v113
    v_mfma_f32_16x16x32_bf16 v[68:71], a[140:143], v[28:31], v[68:71]
    ds_read_b64_tr_b16 a[170:171], v210 offset:36864
    v_add_f32 v200, v200, v180
    v_add_f32 v200, v200, v181
    v_mfma_f32_16x16x32_bf16 v[84:87], a[144:147], v[16:19], v[132:135]
    v_exp_f32_e64 v182, v114
    v_mfma_f32_16x16x32_bf16 v[84:87], a[148:151], v[20:23], v[84:87]
    ds_read_b64_tr_b16 a[172:173], v211 offset:32768
    v_cvt_pk_bf16_f32 v162, v180, v181
    v_mfma_f32_16x16x32_bf16 v[84:87], a[152:155], v[24:27], v[84:87]
    buffer_load_dwordx4 v[238:241], v251, s[16:19], s20 offen offset:3072 sc1
    v_exp_f32_e64 v183, v115
    v_mfma_f32_16x16x32_bf16 v[84:87], a[156:159], v[28:31], v[84:87]
    ds_read_b64_tr_b16 a[174:175], v211 offset:36864
    v_add_f32 v200, v200, v182
    v_add_f32 v200, v200, v183
    v_mfma_f32_16x16x32_bf16 v[72:75], a[128:131], v[32:35], v[136:139]
    v_exp_f32_e64 v176, v100
    v_mfma_f32_16x16x32_bf16 v[72:75], a[132:135], v[36:39], v[72:75]
    ds_read_b64_tr_b16 a[176:177], v212 offset:32768
    v_cvt_pk_bf16_f32 v163, v182, v183
    v_mfma_f32_16x16x32_bf16 v[72:75], a[136:139], v[40:43], v[72:75]
    buffer_load_dwordx4 v[242:245], v251, s[32:35], s21 offen sc1
    v_exp_f32_e64 v177, v101
    v_mfma_f32_16x16x32_bf16 v[72:75], a[140:143], v[44:47], v[72:75]
    ds_read_b64_tr_b16 a[178:179], v212 offset:36864
    v_add_f32_e64 v201, v176, v177
    v_mfma_f32_16x16x32_bf16 v[88:91], a[144:147], v[32:35], v[136:139]
    v_exp_f32_e64 v178, v102
    v_mfma_f32_16x16x32_bf16 v[88:91], a[148:151], v[36:39], v[88:91]
    ds_read_b64_tr_b16 a[180:181], v213 offset:32768
    v_cvt_pk_bf16_f32 v164, v176, v177
    v_mfma_f32_16x16x32_bf16 v[88:91], a[152:155], v[40:43], v[88:91]
    buffer_load_dwordx4 v[246:249], v251, s[32:35], s22 offen sc1
    v_exp_f32_e64 v179, v103
    v_mfma_f32_16x16x32_bf16 v[88:91], a[156:159], v[44:47], v[88:91]
    ds_read_b64_tr_b16 a[182:183], v213 offset:36864
    v_add_f32 v201, v201, v178
    v_add_f32 v201, v201, v179
    v_mfma_f32_16x16x32_bf16 v[76:79], a[128:131], v[48:51], v[140:143]
    v_exp_f32_e64 v180, v116
    v_mfma_f32_16x16x32_bf16 v[76:79], a[132:135], v[52:55], v[76:79]
    ds_read_b64_tr_b16 a[184:185], v214 offset:32768
    v_cvt_pk_bf16_f32 v165, v178, v179
    v_mfma_f32_16x16x32_bf16 v[76:79], a[136:139], v[56:59], v[76:79]
    buffer_load_dwordx4 v[184:187], v251, s[32:35], s23 offen sc1
    v_exp_f32_e64 v181, v117
    v_mfma_f32_16x16x32_bf16 v[76:79], a[140:143], v[60:63], v[76:79]
    ds_read_b64_tr_b16 a[186:187], v214 offset:36864
    v_add_f32 v201, v201, v180
    v_add_f32 v201, v201, v181
    v_mfma_f32_16x16x32_bf16 v[92:95], a[144:147], v[48:51], v[140:143]
    v_exp_f32_e64 v182, v118
    v_mfma_f32_16x16x32_bf16 v[92:95], a[148:151], v[52:55], v[92:95]
    ds_read_b64_tr_b16 a[188:189], v215 offset:32768
    v_cvt_pk_bf16_f32 v166, v180, v181
    v_mfma_f32_16x16x32_bf16 v[92:95], a[152:155], v[56:59], v[92:95]
    s_waitcnt lgkmcnt(3)
    s_nop 0
    buffer_load_dwordx4 v[188:191], v251, s[32:35], s24 offen sc1
    v_exp_f32_e64 v183, v119
    v_mfma_f32_16x16x32_bf16 v[92:95], a[156:159], v[60:63], v[92:95]
    ds_read_b64_tr_b16 a[190:191], v215 offset:36864
    v_add_f32 v201, v201, v182
    v_add_f32 v201, v201, v183
    v_mfma_f32_16x16x32_bf16 a[0:3], a[160:163], v[144:147], a[0:3]
    v_exp_f32_e64 v176, v104
    v_mfma_f32_16x16x32_bf16 a[4:7], a[160:163], v[148:151], a[4:7]
    ds_read_b128 a[128:131], v204 offset:57344
    v_cvt_pk_bf16_f32 v167, v182, v183
    v_mfma_f32_16x16x32_bf16 a[8:11], a[160:163], v[152:155], a[8:11]
    s_add_u32 s20, s20, s25
    v_exp_f32 v177, v105
    v_mfma_f32_16x16x32_bf16 a[12:15], a[160:163], v[156:159], a[12:15]
    s_add_u32 s21, s21, s26
    s_nop 0
    ds_read_b128 a[132:135], v205 offset:57344
    v_add_f32_e64 v202, v176, v177
    v_mfma_f32_16x16x32_bf16 a[16:19], a[164:167], v[144:147], a[16:19]
    s_add_u32 s22, s22, s26
    v_exp_f32 v178, v106
    v_mfma_f32_16x16x32_bf16 a[20:23], a[164:167], v[148:151], a[20:23]
    s_add_u32 s23, s23, s26
    s_nop 0
    ds_read_b128 a[136:139], v206 offset:57344
    v_cvt_pk_bf16_f32 v168, v176, v177
    v_mfma_f32_16x16x32_bf16 a[24:27], a[164:167], v[152:155], a[24:27]
    s_add_u32 s24, s24, s26
    v_exp_f32 v179, v107
    v_mfma_f32_16x16x32_bf16 a[28:31], a[164:167], v[156:159], a[28:31]
    ds_read_b128 a[140:143], v207 offset:57344
    v_add_f32 v202, v202, v178
    v_add_f32 v202, v202, v179
    v_mfma_f32_16x16x32_bf16 a[32:35], a[168:171], v[144:147], a[32:35]
    buffer_load_dword v225, off, s[88:91], 0 sc1
    v_exp_f32_e64 v180, v120
    v_mfma_f32_16x16x32_bf16 a[36:39], a[168:171], v[148:151], a[36:39]
    ds_read_b128 a[144:147], v204 offset:61440
    v_cvt_pk_bf16_f32 v169, v178, v179
    v_mfma_f32_16x16x32_bf16 a[40:43], a[168:171], v[152:155], a[40:43]
    v_exp_f32_e64 v181, v121
    v_mfma_f32_16x16x32_bf16 a[44:47], a[168:171], v[156:159], a[44:47]
    ds_read_b128 a[148:151], v205 offset:61440
    v_add_f32 v202, v202, v180
    v_add_f32 v202, v202, v181
    v_mfma_f32_16x16x32_bf16 a[48:51], a[172:175], v[144:147], a[48:51]
    v_exp_f32_e64 v182, v122
    v_mfma_f32_16x16x32_bf16 a[52:55], a[172:175], v[148:151], a[52:55]
    ds_read_b128 a[152:155], v206 offset:61440
    v_cvt_pk_bf16_f32 v170, v180, v181
    v_mfma_f32_16x16x32_bf16 a[56:59], a[172:175], v[152:155], a[56:59]
    v_exp_f32_e64 v183, v123
    v_mfma_f32_16x16x32_bf16 a[60:63], a[172:175], v[156:159], a[60:63]
    v_exp_f32_e64 v176, v108
    v_mfma_f32_16x16x32_bf16 a[64:67], a[176:179], v[144:147], a[64:67]
    v_exp_f32_e64 v177, v109
    v_mfma_f32_16x16x32_bf16 a[68:71], a[176:179], v[148:151], a[68:71]
    ds_read_b128 a[156:159], v207 offset:61440
    v_add_f32 v202, v202, v182
    v_add_f32 v202, v202, v183
    v_mfma_f32_16x16x32_bf16 a[72:75], a[176:179], v[152:155], a[72:75]
    v_exp_f32_e64 v178, v110
    v_mfma_f32_16x16x32_bf16 a[76:79], a[176:179], v[156:159], a[76:79]
    v_exp_f32_e64 v179, v111
    v_mfma_f32_16x16x32_bf16 a[80:83], a[180:183], v[144:147], a[80:83]
    s_add_u32 m0, s37, 0xa000
    v_exp_f32_e64 v180, v124
    v_mfma_f32_16x16x32_bf16 a[84:87], a[180:183], v[148:151], a[84:87]
    buffer_load_dwordx4 v252, s[8:11], s39 offen lds
    v_cvt_pk_bf16_f32 v171, v182, v183
    v_add_f32_e64 v203, v176, v177
    v_mfma_f32_16x16x32_bf16 a[88:91], a[180:183], v[152:155], a[88:91]
    v_exp_f32_e64 v181, v125
    v_mfma_f32_16x16x32_bf16 a[92:95], a[180:183], v[156:159], a[92:95]
    s_waitcnt lgkmcnt(8)
    v_exp_f32 v182, v126
    v_mfma_f32_16x16x32_bf16 a[96:99], a[184:187], v[144:147], a[96:99]
    s_add_u32 m0, s37, 0xb000
    v_exp_f32_e64 v183, v127
    v_mfma_f32_16x16x32_bf16 a[100:103], a[184:187], v[148:151], a[100:103]
    buffer_load_dwordx4 v253, s[8:11], s39 offen lds
    v_cvt_pk_bf16_f32 v172, v176, v177
    v_add_f32 v203, v203, v178
    v_add_f32 v203, v203, v179
    v_mfma_f32_16x16x32_bf16 a[104:107], a[184:187], v[152:155], a[104:107]
    s_add_u32 m0, s38, 0x14000
    v_cvt_pk_bf16_f32 v173, v178, v179
    v_add_f32 v203, v203, v180
    v_add_f32 v203, v203, v181
    v_mfma_f32_16x16x32_bf16 a[108:111], a[184:187], v[156:159], a[108:111]
    buffer_load_dwordx4 v254, s[12:15], s39 offen lds
    v_cvt_pk_bf16_f32 v174, v180, v181
    v_add_f32 v203, v203, v182
    v_add_f32 v203, v203, v183
    v_mfma_f32_16x16x32_bf16 a[112:115], a[188:191], v[144:147], a[112:115]
    v_cvt_pk_bf16_f32 v175, v182, v183
    v_max3_f32 v216, v200, v201, v202
    v_max_f32_e64 v216, v216, v203
    v_mfma_f32_16x16x32_bf16 a[116:119], a[188:191], v[148:151], a[116:119]
    buffer_load_dwordx4 v255, s[12:15], s39 offen offset:1024 lds
    v_cmp_lt_f32 vcc, v224, v216
    v_add_f32 v193, v193, v197
    v_mfma_f32_16x16x32_bf16 a[120:123], a[188:191], v[152:155], a[120:123]
    s_addk_i32 s39, 0x2000
    v_add_f32 v194, v194, v198
    v_add_f32_e64 v195, v195, v199
    v_mfma_f32_16x16x32_bf16 a[124:127], a[188:191], v[156:159], a[124:127]
    s_cbranch_vccnz RARE_11
BACK_12:
    s_waitcnt vmcnt(16) lgkmcnt(0)
    s_barrier
    s_nop 0
    v_mfma_f32_16x16x32_bf16 v[96:99], a[128:131], v[0:3], v[128:131]
    v_exp_f32_e64 v176, v64
    v_mfma_f32_16x16x32_bf16 v[96:99], a[132:135], v[4:7], v[96:99]
    ds_read_b64_tr_b16 a[160:161], v208 offset:40960
    v_add_f32_e64 v192, v192, v200
    v_mfma_f32_16x16x32_bf16 v[96:99], a[136:139], v[8:11], v[96:99]
    v_exp_f32_e64 v177, v65
    v_mfma_f32_16x16x32_bf16 v[96:99], a[140:143], v[12:15], v[96:99]
    ds_read_b64_tr_b16 a[162:163], v208 offset:45056
    v_add_f32_e64 v196, v176, v177
    v_mfma_f32_16x16x32_bf16 v[112:115], a[144:147], v[0:3], v[128:131]
    v_exp_f32_e64 v178, v66
    v_mfma_f32_16x16x32_bf16 v[112:115], a[148:151], v[4:7], v[112:115]
    ds_read_b64_tr_b16 a[164:165], v209 offset:40960
    v_cvt_pk_bf16_f32 v144, v176, v177
    v_mfma_f32_16x16x32_bf16 v[112:115], a[152:155], v[8:11], v[112:115]
    v_exp_f32_e64 v179, v67
    v_mfma_f32_16x16x32_bf16 v[112:115], a[156:159], v[12:15], v[112:115]
    ds_read_b64_tr_b16 a[166:167], v209 offset:45056
    v_add_f32 v196, v196, v178
    v_add_f32 v196, v196, v179
    v_mfma_f32_16x16x32_bf16 v[100:103], a[128:131], v[16:19], v[132:135]
    v_exp_f32_e64 v180, v80
    v_mfma_f32_16x16x32_bf16 v[100:103], a[132:135], v[20:23], v[100:103]
    ds_read_b64_tr_b16 a[168:169], v210 offset:40960
    v_cvt_pk_bf16_f32 v145, v178, v179
    v_mfma_f32_16x16x32_bf16 v[100:103], a[136:139], v[24:27], v[100:103]
    v_exp_f32_e64 v181, v81
    v_mfma_f32_16x16x32_bf16 v[100:103], a[140:143], v[28:31], v[100:103]
    ds_read_b64_tr_b16 a[170:171], v210 offset:45056
    v_add_f32 v196, v196, v180
    v_add_f32 v196, v196, v181
    v_mfma_f32_16x16x32_bf16 v[116:119], a[144:147], v[16:19], v[132:135]
    v_exp_f32_e64 v182, v82
    v_mfma_f32_16x16x32_bf16 v[116:119], a[148:151], v[20:23], v[116:119]
    ds_read_b64_tr_b16 a[172:173], v211 offset:40960
    v_cvt_pk_bf16_f32 v146, v180, v181
    v_mfma_f32_16x16x32_bf16 v[116:119], a[152:155], v[24:27], v[116:119]
    v_exp_f32_e64 v183, v83
    v_mfma_f32_16x16x32_bf16 v[116:119], a[156:159], v[28:31], v[116:119]
    ds_read_b64_tr_b16 a[174:175], v211 offset:45056
    v_add_f32 v196, v196, v182
    v_add_f32 v196, v196, v183
    v_mfma_f32_16x16x32_bf16 v[104:107], a[128:131], v[32:35], v[136:139]
    v_exp_f32_e64 v176, v68
    v_mfma_f32_16x16x32_bf16 v[104:107], a[132:135], v[36:39], v[104:107]
    ds_read_b64_tr_b16 a[176:177], v212 offset:40960
    v_cvt_pk_bf16_f32 v147, v182, v183
    v_mfma_f32_16x16x32_bf16 v[104:107], a[136:139], v[40:43], v[104:107]
    v_exp_f32_e64 v177, v69
    v_mfma_f32_16x16x32_bf16 v[104:107], a[140:143], v[44:47], v[104:107]
    ds_read_b64_tr_b16 a[178:179], v212 offset:45056
    v_add_f32_e64 v197, v176, v177
    v_mfma_f32_16x16x32_bf16 v[120:123], a[144:147], v[32:35], v[136:139]
    v_exp_f32_e64 v178, v70
    v_mfma_f32_16x16x32_bf16 v[120:123], a[148:151], v[36:39], v[120:123]
    ds_read_b64_tr_b16 a[180:181], v213 offset:40960
    v_cvt_pk_bf16_f32 v148, v176, v177
    v_mfma_f32_16x16x32_bf16 v[120:123], a[152:155], v[40:43], v[120:123]
    v_exp_f32_e64 v179, v71
    v_mfma_f32_16x16x32_bf16 v[120:123], a[156:159], v[44:47], v[120:123]
    ds_read_b64_tr_b16 a[182:183], v213 offset:45056
    v_add_f32 v197, v197, v178
    v_add_f32 v197, v197, v179
    v_mfma_f32_16x16x32_bf16 v[108:111], a[128:131], v[48:51], v[140:143]
    v_exp_f32_e64 v180, v84
    v_mfma_f32_16x16x32_bf16 v[108:111], a[132:135], v[52:55], v[108:111]
    ds_read_b64_tr_b16 a[184:185], v214 offset:40960
    v_cvt_pk_bf16_f32 v149, v178, v179
    v_mfma_f32_16x16x32_bf16 v[108:111], a[136:139], v[56:59], v[108:111]
    v_exp_f32_e64 v181, v85
    v_mfma_f32_16x16x32_bf16 v[108:111], a[140:143], v[60:63], v[108:111]
    ds_read_b64_tr_b16 a[186:187], v214 offset:45056
    v_add_f32 v197, v197, v180
    v_add_f32 v197, v197, v181
    v_mfma_f32_16x16x32_bf16 v[124:127], a[144:147], v[48:51], v[140:143]
    v_exp_f32_e64 v182, v86
    v_mfma_f32_16x16x32_bf16 v[124:127], a[148:151], v[52:55], v[124:127]
    ds_read_b64_tr_b16 a[188:189], v215 offset:40960
    v_cvt_pk_bf16_f32 v150, v180, v181
    v_mfma_f32_16x16x32_bf16 v[124:127], a[152:155], v[56:59], v[124:127]
    s_waitcnt lgkmcnt(3)
    v_exp_f32 v183, v87
    v_mfma_f32_16x16x32_bf16 v[124:127], a[156:159], v[60:63], v[124:127]
    ds_read_b64_tr_b16 a[190:191], v215 offset:45056
    v_add_f32 v197, v197, v182
    v_add_f32 v197, v197, v183
    v_mfma_f32_16x16x32_bf16 a[0:3], a[160:163], v[160:163], a[0:3]
    v_exp_f32_e64 v176, v72
    v_mfma_f32_16x16x32_bf16 a[4:7], a[160:163], v[164:167], a[4:7]
    ds_read_b128 a[128:131], v204 offset:0
    v_cvt_pk_bf16_f32 v151, v182, v183
    v_mfma_f32_16x16x32_bf16 a[8:11], a[160:163], v[168:171], a[8:11]
    v_exp_f32_e64 v177, v73
    v_mfma_f32_16x16x32_bf16 a[12:15], a[160:163], v[172:175], a[12:15]
    ds_read_b128 a[132:135], v205 offset:0
    v_add_f32_e64 v198, v176, v177
    v_mfma_f32_16x16x32_bf16 a[16:19], a[164:167], v[160:163], a[16:19]
    v_exp_f32_e64 v178, v74
    v_mfma_f32_16x16x32_bf16 a[20:23], a[164:167], v[164:167], a[20:23]
    ds_read_b128 a[136:139], v206 offset:0
    v_cvt_pk_bf16_f32 v152, v176, v177
    v_mfma_f32_16x16x32_bf16 a[24:27], a[164:167], v[168:171], a[24:27]
    v_exp_f32_e64 v179, v75
    v_mfma_f32_16x16x32_bf16 a[28:31], a[164:167], v[172:175], a[28:31]
    ds_read_b128 a[140:143], v207 offset:0
    v_add_f32 v198, v198, v178
    v_add_f32 v198, v198, v179
    v_mfma_f32_16x16x32_bf16 a[32:35], a[168:171], v[160:163], a[32:35]
    v_exp_f32_e64 v180, v88
    v_mfma_f32_16x16x32_bf16 a[36:39], a[168:171], v[164:167], a[36:39]
    ds_read_b128 a[144:147], v204 offset:4096
    v_cvt_pk_bf16_f32 v153, v178, v179
    v_mfma_f32_16x16x32_bf16 a[40:43], a[168:171], v[168:171], a[40:43]
    v_exp_f32_e64 v181, v89
    v_mfma_f32_16x16x32_bf16 a[44:47], a[168:171], v[172:175], a[44:47]
    ds_read_b128 a[148:151], v205 offset:4096
    v_add_f32 v198, v198, v180
    v_add_f32 v198, v198, v181
    v_mfma_f32_16x16x32_bf16 a[48:51], a[172:175], v[160:163], a[48:51]
    v_exp_f32_e64 v182, v90
    v_mfma_f32_16x16x32_bf16 a[52:55], a[172:175], v[164:167], a[52:55]
    ds_read_b128 a[152:155], v206 offset:4096
    v_cvt_pk_bf16_f32 v154, v180, v181
    v_mfma_f32_16x16x32_bf16 a[56:59], a[172:175], v[168:171], a[56:59]
    v_exp_f32_e64 v183, v91
    v_mfma_f32_16x16x32_bf16 a[60:63], a[172:175], v[172:175], a[60:63]
    v_exp_f32_e64 v176, v76
    v_mfma_f32_16x16x32_bf16 a[64:67], a[176:179], v[160:163], a[64:67]
    v_exp_f32_e64 v177, v77
    v_mfma_f32_16x16x32_bf16 a[68:71], a[176:179], v[164:167], a[68:71]
    ds_read_b128 a[156:159], v207 offset:4096
    v_add_f32 v198, v198, v182
    v_add_f32 v198, v198, v183
    v_mfma_f32_16x16x32_bf16 a[72:75], a[176:179], v[168:171], a[72:75]
    v_exp_f32_e64 v178, v78
    v_mfma_f32_16x16x32_bf16 a[76:79], a[176:179], v[172:175], a[76:79]
    v_exp_f32_e64 v179, v79
    v_mfma_f32_16x16x32_bf16 a[80:83], a[180:183], v[160:163], a[80:83]
    s_add_u32 m0, s37, 0xc000
    v_exp_f32_e64 v180, v92
    v_mfma_f32_16x16x32_bf16 a[84:87], a[180:183], v[164:167], a[84:87]
    buffer_load_dwordx4 v252, s[8:11], s39 offen lds
    v_cvt_pk_bf16_f32 v155, v182, v183
    v_add_f32_e64 v199, v176, v177
    v_mfma_f32_16x16x32_bf16 a[88:91], a[180:183], v[168:171], a[88:91]
    v_exp_f32_e64 v181, v93
    v_mfma_f32_16x16x32_bf16 a[92:95], a[180:183], v[172:175], a[92:95]
    s_waitcnt lgkmcnt(8)
    v_exp_f32 v182, v94
    v_mfma_f32_16x16x32_bf16 a[96:99], a[184:187], v[160:163], a[96:99]
    s_add_u32 m0, s37, 0xd000
    v_exp_f32_e64 v183, v95
    v_mfma_f32_16x16x32_bf16 a[100:103], a[184:187], v[164:167], a[100:103]
    buffer_load_dwordx4 v253, s[8:11], s39 offen lds
    v_cvt_pk_bf16_f32 v156, v176, v177
    v_add_f32 v199, v199, v178
    v_add_f32 v199, v199, v179
    v_mfma_f32_16x16x32_bf16 a[104:107], a[184:187], v[168:171], a[104:107]
    s_add_u32 m0, s38, 0x16000
    v_cvt_pk_bf16_f32 v157, v178, v179
    v_add_f32 v199, v199, v180
    v_add_f32 v199, v199, v181
    v_mfma_f32_16x16x32_bf16 a[108:111], a[184:187], v[172:175], a[108:111]
    buffer_load_dwordx4 v254, s[12:15], s39 offen lds
    v_cvt_pk_bf16_f32 v158, v180, v181
    v_add_f32 v199, v199, v182
    v_add_f32 v199, v199, v183
    v_mfma_f32_16x16x32_bf16 a[112:115], a[188:191], v[160:163], a[112:115]
    v_cvt_pk_bf16_f32 v159, v182, v183
    v_max3_f32 v216, v196, v197, v198
    v_max_f32_e64 v216, v216, v199
    v_mfma_f32_16x16x32_bf16 a[116:119], a[188:191], v[164:167], a[116:119]
    buffer_load_dwordx4 v255, s[12:15], s39 offen offset:1024 lds
    v_cmp_lt_f32 vcc, v224, v216
    v_add_f32 v193, v193, v201
    v_mfma_f32_16x16x32_bf16 a[120:123], a[188:191], v[168:171], a[120:123]
    s_addk_i32 s39, 0x2000
    v_add_f32 v194, v194, v202
    v_add_f32_e64 v195, v195, v203
    v_mfma_f32_16x16x32_bf16 a[124:127], a[188:191], v[172:175], a[124:127]
    s_cbranch_vccnz RARE_13
BACK_14:
    s_waitcnt lgkmcnt(0)
    v_mfma_f32_16x16x32_bf16 v[64:67], a[128:131], v[0:3], v[128:131]
    s_waitcnt vmcnt(8)
    v_exp_f32 v176, v96
    v_mfma_f32_16x16x32_bf16 v[64:67], a[132:135], v[4:7], v[64:67]
    ds_read_b64_tr_b16 a[160:161], v208 offset:49152
    v_add_f32_e64 v192, v192, v196
    v_mfma_f32_16x16x32_bf16 v[64:67], a[136:139], v[8:11], v[64:67]
    v_exp_f32_e64 v177, v97
    v_mfma_f32_16x16x32_bf16 v[64:67], a[140:143], v[12:15], v[64:67]
    ds_read_b64_tr_b16 a[162:163], v208 offset:53248
    v_add_f32_e64 v200, v176, v177
    v_mfma_f32_16x16x32_bf16 a[192:195], v[226:229], v[242:245], a[192:195]
    v_cvt_pk_bf16_f32 v160, v176, v177
    v_add_f32_e64 v193, v193, v197
    v_mfma_f32_16x16x32_bf16 v[80:83], a[144:147], v[0:3], v[128:131]
    v_exp_f32_e64 v178, v98
    v_mfma_f32_16x16x32_bf16 v[80:83], a[148:151], v[4:7], v[80:83]
    ds_read_b64_tr_b16 a[164:165], v209 offset:49152
    v_add_f32_e64 v200, v200, v178
    v_mfma_f32_16x16x32_bf16 v[80:83], a[152:155], v[8:11], v[80:83]
    v_exp_f32_e64 v179, v99
    v_mfma_f32_16x16x32_bf16 v[80:83], a[156:159], v[12:15], v[80:83]
    ds_read_b64_tr_b16 a[166:167], v209 offset:53248
    v_add_f32_e64 v200, v200, v179
    v_mfma_f32_16x16x32_bf16 a[196:199], v[226:229], v[246:249], a[196:199]
    v_cvt_pk_bf16_f32 v161, v178, v179
    v_add_f32_e64 v194, v194, v198
    v_mfma_f32_16x16x32_bf16 v[68:71], a[128:131], v[16:19], v[132:135]
    v_exp_f32_e64 v180, v112
    v_mfma_f32_16x16x32_bf16 v[68:71], a[132:135], v[20:23], v[68:71]
    ds_read_b64_tr_b16 a[168:169], v210 offset:49152
    v_add_f32_e64 v200, v200, v180
    v_mfma_f32_16x16x32_bf16 v[68:71], a[136:139], v[24:27], v[68:71]
    v_exp_f32_e64 v181, v113
    v_mfma_f32_16x16x32_bf16 v[68:71], a[140:143], v[28:31], v[68:71]
    ds_read_b64_tr_b16 a[170:171], v210 offset:53248
    v_add_f32_e64 v200, v200, v181
    v_mfma_f32_16x16x32_bf16 a[200:203], v[226:229], v[184:187], a[200:203]
    v_cvt_pk_bf16_f32 v162, v180, v181
    v_add_f32_e64 v195, v195, v199
    v_mfma_f32_16x16x32_bf16 v[84:87], a[144:147], v[16:19], v[132:135]
    v_exp_f32_e64 v182, v114
    v_mfma_f32_16x16x32_bf16 v[84:87], a[148:151], v[20:23], v[84:87]
    ds_read_b64_tr_b16 a[172:173], v211 offset:49152
    v_add_f32_e64 v200, v200, v182
    v_mfma_f32_16x16x32_bf16 v[84:87], a[152:155], v[24:27], v[84:87]
    v_exp_f32_e64 v183, v115
    v_mfma_f32_16x16x32_bf16 v[84:87], a[156:159], v[28:31], v[84:87]
    ds_read_b64_tr_b16 a[174:175], v211 offset:53248
    v_add_f32_e64 v200, v200, v183
    v_mfma_f32_16x16x32_bf16 a[204:207], v[226:229], v[188:191], a[204:207]
    v_cvt_pk_bf16_f32 v163, v182, v183
    v_mfma_f32_16x16x32_bf16 v[72:75], a[128:131], v[32:35], v[136:139]
    v_exp_f32_e64 v176, v100
    v_mfma_f32_16x16x32_bf16 v[72:75], a[132:135], v[36:39], v[72:75]
    ds_read_b64_tr_b16 a[176:177], v212 offset:49152
    v_mfma_f32_16x16x32_bf16 v[72:75], a[136:139], v[40:43], v[72:75]
    v_exp_f32_e64 v177, v101
    v_mfma_f32_16x16x32_bf16 v[72:75], a[140:143], v[44:47], v[72:75]
    ds_read_b64_tr_b16 a[178:179], v212 offset:53248
    v_add_f32_e64 v201, v176, v177
    v_mfma_f32_16x16x32_bf16 a[208:211], v[230:233], v[242:245], a[208:211]
    v_cvt_pk_bf16_f32 v164, v176, v177
    v_mfma_f32_16x16x32_bf16 v[88:91], a[144:147], v[32:35], v[136:139]
    v_exp_f32_e64 v178, v102
    v_mfma_f32_16x16x32_bf16 v[88:91], a[148:151], v[36:39], v[88:91]
    ds_read_b64_tr_b16 a[180:181], v213 offset:49152
    v_add_f32_e64 v201, v201, v178
    v_mfma_f32_16x16x32_bf16 v[88:91], a[152:155], v[40:43], v[88:91]
    v_exp_f32_e64 v179, v103
    v_mfma_f32_16x16x32_bf16 v[88:91], a[156:159], v[44:47], v[88:91]
    ds_read_b64_tr_b16 a[182:183], v213 offset:53248
    v_add_f32_e64 v201, v201, v179
    v_mfma_f32_16x16x32_bf16 a[212:215], v[230:233], v[246:249], a[212:215]
    v_cvt_pk_bf16_f32 v165, v178, v179
    v_mfma_f32_16x16x32_bf16 v[76:79], a[128:131], v[48:51], v[140:143]
    v_exp_f32_e64 v180, v116
    v_mfma_f32_16x16x32_bf16 v[76:79], a[132:135], v[52:55], v[76:79]
    ds_read_b64_tr_b16 a[184:185], v214 offset:49152
    v_add_f32_e64 v201, v201, v180
    v_mfma_f32_16x16x32_bf16 v[76:79], a[136:139], v[56:59], v[76:79]
    v_exp_f32_e64 v181, v117
    v_mfma_f32_16x16x32_bf16 v[76:79], a[140:143], v[60:63], v[76:79]
    ds_read_b64_tr_b16 a[186:187], v214 offset:53248
    v_add_f32_e64 v201, v201, v181
    v_mfma_f32_16x16x32_bf16 a[216:219], v[230:233], v[184:187], a[216:219]
    v_cvt_pk_bf16_f32 v166, v180, v181
    v_mfma_f32_16x16x32_bf16 v[92:95], a[144:147], v[48:51], v[140:143]
    v_exp_f32_e64 v182, v118
    v_mfma_f32_16x16x32_bf16 v[92:95], a[148:151], v[52:55], v[92:95]
    ds_read_b64_tr_b16 a[188:189], v215 offset:49152
    v_add_f32_e64 v201, v201, v182
    v_mfma_f32_16x16x32_bf16 v[92:95], a[152:155], v[56:59], v[92:95]
    s_waitcnt lgkmcnt(3)
    v_exp_f32 v183, v119
    v_mfma_f32_16x16x32_bf16 v[92:95], a[156:159], v[60:63], v[92:95]
    ds_read_b64_tr_b16 a[190:191], v215 offset:53248
    v_add_f32_e64 v201, v201, v183
    v_mfma_f32_16x16x32_bf16 a[220:223], v[230:233], v[188:191], a[220:223]
    v_cvt_pk_bf16_f32 v167, v182, v183
    v_mfma_f32_16x16x32_bf16 a[0:3], a[160:163], v[144:147], a[0:3]
    v_exp_f32_e64 v176, v104
    v_mfma_f32_16x16x32_bf16 a[4:7], a[160:163], v[148:151], a[4:7]
    ds_read_b128 a[128:131], v204 offset:8192
    v_mfma_f32_16x16x32_bf16 a[8:11], a[160:163], v[152:155], a[8:11]
    v_exp_f32_e64 v177, v105
    v_mfma_f32_16x16x32_bf16 a[12:15], a[160:163], v[156:159], a[12:15]
    ds_read_b128 a[132:135], v205 offset:8192
    v_add_f32_e64 v202, v176, v177
    v_mfma_f32_16x16x32_bf16 a[224:227], v[234:237], v[242:245], a[224:227]
    v_cvt_pk_bf16_f32 v168, v176, v177
    v_mfma_f32_16x16x32_bf16 a[16:19], a[164:167], v[144:147], a[16:19]
    v_exp_f32_e64 v178, v106
    v_mfma_f32_16x16x32_bf16 a[20:23], a[164:167], v[148:151], a[20:23]
    ds_read_b128 a[136:139], v206 offset:8192
    v_add_f32_e64 v202, v202, v178
    v_mfma_f32_16x16x32_bf16 a[24:27], a[164:167], v[152:155], a[24:27]
    v_exp_f32_e64 v179, v107
    v_mfma_f32_16x16x32_bf16 a[28:31], a[164:167], v[156:159], a[28:31]
    ds_read_b128 a[140:143], v207 offset:8192
    v_add_f32_e64 v202, v202, v179
    v_mfma_f32_16x16x32_bf16 a[228:231], v[234:237], v[246:249], a[228:231]
    v_cvt_pk_bf16_f32 v169, v178, v179
    v_mfma_f32_16x16x32_bf16 a[32:35], a[168:171], v[144:147], a[32:35]
    v_exp_f32_e64 v180, v120
    v_mfma_f32_16x16x32_bf16 a[36:39], a[168:171], v[148:151], a[36:39]
    ds_read_b128 a[144:147], v204 offset:12288
    v_add_f32_e64 v202, v202, v180
    v_mfma_f32_16x16x32_bf16 a[40:43], a[168:171], v[152:155], a[40:43]
    v_exp_f32_e64 v181, v121
    v_mfma_f32_16x16x32_bf16 a[44:47], a[168:171], v[156:159], a[44:47]
    ds_read_b128 a[148:151], v205 offset:12288
    v_add_f32_e64 v202, v202, v181
    v_mfma_f32_16x16x32_bf16 a[232:235], v[234:237], v[184:187], a[232:235]
    v_cvt_pk_bf16_f32 v170, v180, v181
    v_mfma_f32_16x16x32_bf16 a[48:51], a[172:175], v[144:147], a[48:51]
    v_exp_f32_e64 v182, v122
    v_mfma_f32_16x16x32_bf16 a[52:55], a[172:175], v[148:151], a[52:55]
    ds_read_b128 a[152:155], v206 offset:12288
    v_add_f32_e64 v202, v202, v182
    v_mfma_f32_16x16x32_bf16 a[56:59], a[172:175], v[152:155], a[56:59]
    v_exp_f32_e64 v183, v123
    v_mfma_f32_16x16x32_bf16 a[60:63], a[172:175], v[156:159], a[60:63]
    v_exp_f32_e64 v176, v108
    v_mfma_f32_16x16x32_bf16 a[236:239], v[234:237], v[188:191], a[236:239]
    v_add_f32_e64 v202, v202, v183
    v_cvt_pk_bf16_f32 v171, v182, v183
    v_mfma_f32_16x16x32_bf16 a[64:67], a[176:179], v[144:147], a[64:67]
    v_exp_f32_e64 v177, v109
    v_mfma_f32_16x16x32_bf16 a[68:71], a[176:179], v[148:151], a[68:71]
    ds_read_b128 a[156:159], v207 offset:12288
    v_add_f32_e64 v203, v176, v177
    v_mfma_f32_16x16x32_bf16 a[72:75], a[176:179], v[152:155], a[72:75]
    v_exp_f32_e64 v178, v110
    v_mfma_f32_16x16x32_bf16 a[76:79], a[176:179], v[156:159], a[76:79]
    v_exp_f32_e64 v179, v111
    v_mfma_f32_16x16x32_bf16 a[240:243], v[238:241], v[242:245], a[240:243]
    v_cvt_pk_bf16_f32 v172, v176, v177
    v_add_f32 v203, v203, v178
    v_add_f32 v203, v203, v179
    v_mfma_f32_16x16x32_bf16 a[80:83], a[180:183], v[144:147], a[80:83]
    s_add_u32 m0, s37, 0xe000
    v_exp_f32_e64 v180, v124
    v_mfma_f32_16x16x32_bf16 a[84:87], a[180:183], v[148:151], a[84:87]
    buffer_load_dwordx4 v252, s[8:11], s39 offen lds
    v_cvt_pk_bf16_f32 v173, v178, v179
    v_mfma_f32_16x16x32_bf16 a[88:91], a[180:183], v[152:155], a[88:91]
    v_exp_f32_e64 v181, v125
    v_mfma_f32_16x16x32_bf16 a[92:95], a[180:183], v[156:159], a[92:95]
    s_waitcnt lgkmcnt(8)
    v_exp_f32 v182, v126
    v_mfma_f32_16x16x32_bf16 a[244:247], v[238:241], v[246:249], a[244:247]
    v_add_f32 v203, v203, v180
    v_add_f32 v203, v203, v181
    v_cvt_pk_bf16_f32 v174, v180, v181
    v_mfma_f32_16x16x32_bf16 a[96:99], a[184:187], v[144:147], a[96:99]
    s_add_u32 m0, s37, 0xf000
    v_exp_f32_e64 v183, v127
    v_mfma_f32_16x16x32_bf16 a[100:103], a[184:187], v[148:151], a[100:103]
    buffer_load_dwordx4 v253, s[8:11], s39 offen lds
    v_add_f32 v203, v203, v182
    v_add_f32 v203, v203, v183
    v_mfma_f32_16x16x32_bf16 a[104:107], a[184:187], v[152:155], a[104:107]
    s_add_u32 m0, s38, 0x18000
    v_cvt_pk_bf16_f32 v175, v182, v183
    v_max3_f32 v216, v200, v201, v202
    v_max_f32_e64 v216, v216, v203
    v_mfma_f32_16x16x32_bf16 a[108:111], a[184:187], v[156:159], a[108:111]
    buffer_load_dwordx4 v254, s[12:15], s39 offen lds
    v_cmp_lt_f32 vcc, v224, v216
    s_nop 0
    v_mfma_f32_16x16x32_bf16 a[248:251], v[238:241], v[184:187], a[248:251]
    v_mfma_f32_16x16x32_bf16 a[112:115], a[188:191], v[144:147], a[112:115]
    v_mfma_f32_16x16x32_bf16 a[116:119], a[188:191], v[148:151], a[116:119]
    buffer_load_dwordx4 v255, s[12:15], s39 offen offset:1024 lds
    v_mfma_f32_16x16x32_bf16 a[120:123], a[188:191], v[152:155], a[120:123]
    s_addk_i32 s39, 0x2000
    s_nop 0
    v_mfma_f32_16x16x32_bf16 a[124:127], a[188:191], v[156:159], a[124:127]
    v_mfma_f32_16x16x32_bf16 a[252:255], v[238:241], v[188:191], a[252:255]
    s_cbranch_vccnz RARE_15
BACK_16:
    s_waitcnt vmcnt(16) lgkmcnt(0)
    s_barrier
    s_nop 0
    v_mfma_f32_16x16x32_bf16 v[96:99], a[128:131], v[0:3], v[128:131]
    v_exp_f32_e64 v176, v64
    v_mfma_f32_16x16x32_bf16 v[96:99], a[132:135], v[4:7], v[96:99]
    ds_read_b64_tr_b16 a[160:161], v208 offset:57344
    v_add_f32_e64 v192, v192, v200
    v_mfma_f32_16x16x32_bf16 v[96:99], a[136:139], v[8:11], v[96:99]
    v_exp_f32_e64 v177, v65
    v_mfma_f32_16x16x32_bf16 v[96:99], a[140:143], v[12:15], v[96:99]
    ds_read_b64_tr_b16 a[162:163], v208 offset:61440
    v_add_f32_e64 v196, v176, v177
    v_mfma_f32_16x16x32_bf16 v[112:115], a[144:147], v[0:3], v[128:131]
    v_exp_f32_e64 v178, v66
    v_mfma_f32_16x16x32_bf16 v[112:115], a[148:151], v[4:7], v[112:115]
    ds_read_b64_tr_b16 a[164:165], v209 offset:57344
    v_cvt_pk_bf16_f32 v144, v176, v177
    v_mfma_f32_16x16x32_bf16 v[112:115], a[152:155], v[8:11], v[112:115]
    v_exp_f32_e64 v179, v67
    v_mfma_f32_16x16x32_bf16 v[112:115], a[156:159], v[12:15], v[112:115]
    ds_read_b64_tr_b16 a[166:167], v209 offset:61440
    v_add_f32 v196, v196, v178
    v_add_f32 v196, v196, v179
    v_mfma_f32_16x16x32_bf16 v[100:103], a[128:131], v[16:19], v[132:135]
    v_exp_f32_e64 v180, v80
    v_mfma_f32_16x16x32_bf16 v[100:103], a[132:135], v[20:23], v[100:103]
    ds_read_b64_tr_b16 a[168:169], v210 offset:57344
    v_cvt_pk_bf16_f32 v145, v178, v179
    v_mfma_f32_16x16x32_bf16 v[100:103], a[136:139], v[24:27], v[100:103]
    v_exp_f32_e64 v181, v81
    v_mfma_f32_16x16x32_bf16 v[100:103], a[140:143], v[28:31], v[100:103]
    ds_read_b64_tr_b16 a[170:171], v210 offset:61440
    v_add_f32 v196, v196, v180
    v_add_f32 v196, v196, v181
    v_mfma_f32_16x16x32_bf16 v[116:119], a[144:147], v[16:19], v[132:135]
    v_exp_f32_e64 v182, v82
    v_mfma_f32_16x16x32_bf16 v[116:119], a[148:151], v[20:23], v[116:119]
    ds_read_b64_tr_b16 a[172:173], v211 offset:57344
    v_cvt_pk_bf16_f32 v146, v180, v181
    v_mfma_f32_16x16x32_bf16 v[116:119], a[152:155], v[24:27], v[116:119]
    v_exp_f32_e64 v183, v83
    v_mfma_f32_16x16x32_bf16 v[116:119], a[156:159], v[28:31], v[116:119]
    ds_read_b64_tr_b16 a[174:175], v211 offset:61440
    v_add_f32 v196, v196, v182
    v_add_f32 v196, v196, v183
    v_mfma_f32_16x16x32_bf16 v[104:107], a[128:131], v[32:35], v[136:139]
    v_exp_f32_e64 v176, v68
    v_mfma_f32_16x16x32_bf16 v[104:107], a[132:135], v[36:39], v[104:107]
    ds_read_b64_tr_b16 a[176:177], v212 offset:57344
    v_cvt_pk_bf16_f32 v147, v182, v183
    v_mfma_f32_16x16x32_bf16 v[104:107], a[136:139], v[40:43], v[104:107]
    v_exp_f32_e64 v177, v69
    v_mfma_f32_16x16x32_bf16 v[104:107], a[140:143], v[44:47], v[104:107]
    ds_read_b64_tr_b16 a[178:179], v212 offset:61440
    v_add_f32_e64 v197, v176, v177
    v_mfma_f32_16x16x32_bf16 v[120:123], a[144:147], v[32:35], v[136:139]
    v_exp_f32_e64 v178, v70
    v_mfma_f32_16x16x32_bf16 v[120:123], a[148:151], v[36:39], v[120:123]
    ds_read_b64_tr_b16 a[180:181], v213 offset:57344
    v_cvt_pk_bf16_f32 v148, v176, v177
    v_mfma_f32_16x16x32_bf16 v[120:123], a[152:155], v[40:43], v[120:123]
    v_exp_f32_e64 v179, v71
    v_mfma_f32_16x16x32_bf16 v[120:123], a[156:159], v[44:47], v[120:123]
    ds_read_b64_tr_b16 a[182:183], v213 offset:61440
    v_add_f32 v197, v197, v178
    v_add_f32 v197, v197, v179
    v_mfma_f32_16x16x32_bf16 v[108:111], a[128:131], v[48:51], v[140:143]
    v_exp_f32_e64 v180, v84
    v_mfma_f32_16x16x32_bf16 v[108:111], a[132:135], v[52:55], v[108:111]
    ds_read_b64_tr_b16 a[184:185], v214 offset:57344
    v_cvt_pk_bf16_f32 v149, v178, v179
    v_mfma_f32_16x16x32_bf16 v[108:111], a[136:139], v[56:59], v[108:111]
    v_exp_f32_e64 v181, v85
    v_mfma_f32_16x16x32_bf16 v[108:111], a[140:143], v[60:63], v[108:111]
    ds_read_b64_tr_b16 a[186:187], v214 offset:61440
    v_add_f32 v197, v197, v180
    v_add_f32 v197, v197, v181
    v_mfma_f32_16x16x32_bf16 v[124:127], a[144:147], v[48:51], v[140:143]
    v_exp_f32_e64 v182, v86
    v_mfma_f32_16x16x32_bf16 v[124:127], a[148:151], v[52:55], v[124:127]
    ds_read_b64_tr_b16 a[188:189], v215 offset:57344
    v_cvt_pk_bf16_f32 v150, v180, v181
    v_mfma_f32_16x16x32_bf16 v[124:127], a[152:155], v[56:59], v[124:127]
    s_waitcnt lgkmcnt(3)
    v_exp_f32 v183, v87
    v_mfma_f32_16x16x32_bf16 v[124:127], a[156:159], v[60:63], v[124:127]
    ds_read_b64_tr_b16 a[190:191], v215 offset:61440
    v_add_f32 v197, v197, v182
    v_add_f32 v197, v197, v183
    v_mfma_f32_16x16x32_bf16 a[0:3], a[160:163], v[160:163], a[0:3]
    v_exp_f32_e64 v176, v72
    v_mfma_f32_16x16x32_bf16 a[4:7], a[160:163], v[164:167], a[4:7]
    ds_read_b128 a[128:131], v204 offset:16384
    v_cvt_pk_bf16_f32 v151, v182, v183
    v_mfma_f32_16x16x32_bf16 a[8:11], a[160:163], v[168:171], a[8:11]
    v_exp_f32_e64 v177, v73
    v_mfma_f32_16x16x32_bf16 a[12:15], a[160:163], v[172:175], a[12:15]
    ds_read_b128 a[132:135], v205 offset:16384
    v_add_f32_e64 v198, v176, v177
    v_mfma_f32_16x16x32_bf16 a[16:19], a[164:167], v[160:163], a[16:19]
    v_exp_f32_e64 v178, v74
    v_mfma_f32_16x16x32_bf16 a[20:23], a[164:167], v[164:167], a[20:23]
    ds_read_b128 a[136:139], v206 offset:16384
    v_cvt_pk_bf16_f32 v152, v176, v177
    v_mfma_f32_16x16x32_bf16 a[24:27], a[164:167], v[168:171], a[24:27]
    v_exp_f32_e64 v179, v75
    v_mfma_f32_16x16x32_bf16 a[28:31], a[164:167], v[172:175], a[28:31]
    ds_read_b128 a[140:143], v207 offset:16384
    v_add_f32 v198, v198, v178
    v_add_f32 v198, v198, v179
    v_mfma_f32_16x16x32_bf16 a[32:35], a[168:171], v[160:163], a[32:35]
    v_exp_f32_e64 v180, v88
    v_mfma_f32_16x16x32_bf16 a[36:39], a[168:171], v[164:167], a[36:39]
    ds_read_b128 a[144:147], v204 offset:20480
    v_cvt_pk_bf16_f32 v153, v178, v179
    v_mfma_f32_16x16x32_bf16 a[40:43], a[168:171], v[168:171], a[40:43]
    v_exp_f32_e64 v181, v89
    v_mfma_f32_16x16x32_bf16 a[44:47], a[168:171], v[172:175], a[44:47]
    ds_read_b128 a[148:151], v205 offset:20480
    v_add_f32 v198, v198, v180
    v_add_f32 v198, v198, v181
    v_mfma_f32_16x16x32_bf16 a[48:51], a[172:175], v[160:163], a[48:51]
    v_exp_f32_e64 v182, v90
    v_mfma_f32_16x16x32_bf16 a[52:55], a[172:175], v[164:167], a[52:55]
    ds_read_b128 a[152:155], v206 offset:20480
    v_cvt_pk_bf16_f32 v154, v180, v181
    v_mfma_f32_16x16x32_bf16 a[56:59], a[172:175], v[168:171], a[56:59]
    v_exp_f32_e64 v183, v91
    v_mfma_f32_16x16x32_bf16 a[60:63], a[172:175], v[172:175], a[60:63]
    v_exp_f32_e64 v176, v76
    v_mfma_f32_16x16x32_bf16 a[64:67], a[176:179], v[160:163], a[64:67]
    v_exp_f32_e64 v177, v77
    v_mfma_f32_16x16x32_bf16 a[68:71], a[176:179], v[164:167], a[68:71]
    ds_read_b128 a[156:159], v207 offset:20480
    v_add_f32 v198, v198, v182
    v_add_f32 v198, v198, v183
    v_mfma_f32_16x16x32_bf16 a[72:75], a[176:179], v[168:171], a[72:75]
    v_exp_f32_e64 v178, v78
    v_mfma_f32_16x16x32_bf16 a[76:79], a[176:179], v[172:175], a[76:79]
    v_exp_f32_e64 v179, v79
    v_mfma_f32_16x16x32_bf16 a[80:83], a[180:183], v[160:163], a[80:83]
    s_add_u32 m0, s37, 0x0
    v_exp_f32 v180, v92
    v_mfma_f32_16x16x32_bf16 a[84:87], a[180:183], v[164:167], a[84:87]
    buffer_load_dwordx4 v252, s[8:11], s39 offen lds
    v_cvt_pk_bf16_f32 v155, v182, v183
    v_add_f32_e64 v199, v176, v177
    v_mfma_f32_16x16x32_bf16 a[88:91], a[180:183], v[168:171], a[88:91]
    v_exp_f32_e64 v181, v93
    v_mfma_f32_16x16x32_bf16 a[92:95], a[180:183], v[172:175], a[92:95]
    s_waitcnt lgkmcnt(8)
    v_exp_f32 v182, v94
    v_mfma_f32_16x16x32_bf16 a[96:99], a[184:187], v[160:163], a[96:99]
    s_add_u32 m0, s37, 0x1000
    v_exp_f32_e64 v183, v95
    v_mfma_f32_16x16x32_bf16 a[100:103], a[184:187], v[164:167], a[100:103]
    buffer_load_dwordx4 v253, s[8:11], s39 offen lds
    v_cvt_pk_bf16_f32 v156, v176, v177
    v_add_f32 v199, v199, v178
    v_add_f32 v199, v199, v179
    v_mfma_f32_16x16x32_bf16 a[104:107], a[184:187], v[168:171], a[104:107]
    s_add_u32 m0, s38, 0x1a000
    v_cvt_pk_bf16_f32 v157, v178, v179
    v_add_f32 v199, v199, v180
    v_add_f32 v199, v199, v181
    v_mfma_f32_16x16x32_bf16 a[108:111], a[184:187], v[172:175], a[108:111]
    buffer_load_dwordx4 v254, s[12:15], s39 offen lds
    v_cvt_pk_bf16_f32 v158, v180, v181
    v_add_f32 v199, v199, v182
    v_add_f32 v199, v199, v183
    v_mfma_f32_16x16x32_bf16 a[112:115], a[188:191], v[160:163], a[112:115]
    v_cvt_pk_bf16_f32 v159, v182, v183
    v_max3_f32 v216, v196, v197, v198
    v_max_f32_e64 v216, v216, v199
    v_mfma_f32_16x16x32_bf16 a[116:119], a[188:191], v[164:167], a[116:119]
    buffer_load_dwordx4 v255, s[12:15], s39 offen offset:1024 lds
    v_cmp_lt_f32 vcc, v224, v216
    v_add_f32 v193, v193, v201
    v_mfma_f32_16x16x32_bf16 a[120:123], a[188:191], v[168:171], a[120:123]
    s_addk_i32 s39, 0x2000
    v_add_f32 v194, v194, v202
    v_add_f32_e64 v195, v195, v203
    v_mfma_f32_16x16x32_bf16 a[124:127], a[188:191], v[172:175], a[124:127]
    s_cbranch_vccnz RARE_17
BACK_18:
    s_waitcnt vmcnt(8)
    v_readfirstlane_b32 s44, v225
    s_nop 3
    s_cmp_ge_u32 s44, 256
    s_cbranch_scc0 SPIN_19
SPINBK_20:
    s_nop 0
    s_mov_b32 s18, 0x5c0000
    s_mov_b32 s34, 0x1700000
    s_mov_b32 s25, 0x8000
    s_movk_i32 s26, 0x400
    s_waitcnt lgkmcnt(0)
    s_cmp_lt_u32 s39, 0x82000
    s_cbranch_scc1 K1_LOOP
    s_lshl_b32 s27, s36, 13
    s_lshl_b32 s100, s36, 20
    s_lshl_b32 s44, s99, 12
    s_add_u32 s100, s100, s44
    s_nop 0
    v_mfma_f32_16x16x32_bf16 v[64:67], a[128:131], v[0:3], v[128:131]
    v_exp_f32_e64 v176, v96
    v_mfma_f32_16x16x32_bf16 v[64:67], a[132:135], v[4:7], v[64:67]
    ds_read_b64_tr_b16 a[160:161], v208 offset:0
    v_add_f32_e64 v192, v192, v196
    v_mfma_f32_16x16x32_bf16 v[64:67], a[136:139], v[8:11], v[64:67]
    buffer_load_dwordx4 v[226:229], v251, s[16:19], s20 offen offset:0 sc1
    v_exp_f32_e64 v177, v97
    v_mfma_f32_16x16x32_bf16 v[64:67], a[140:143], v[12:15], v[64:67]
    ds_read_b64_tr_b16 a[162:163], v208 offset:4096
    v_add_f32_e64 v200, v176, v177
    v_mfma_f32_16x16x32_bf16 v[80:83], a[144:147], v[0:3], v[128:131]
    v_exp_f32_e64 v178, v98
    v_mfma_f32_16x16x32_bf16 v[80:83], a[148:151], v[4:7], v[80:83]
    ds_read_b64_tr_b16 a[164:165], v209 offset:0
    v_cvt_pk_bf16_f32 v160, v176, v177
    v_mfma_f32_16x16x32_bf16 v[80:83], a[152:155], v[8:11], v[80:83]
    buffer_load_dwordx4 v[230:233], v251, s[16:19], s20 offen offset:1024 sc1
    v_exp_f32_e64 v179, v99
    v_mfma_f32_16x16x32_bf16 v[80:83], a[156:159], v[12:15], v[80:83]
    ds_read_b64_tr_b16 a[166:167], v209 offset:4096
    v_add_f32 v200, v200, v178
    v_add_f32 v200, v200, v179
    v_mfma_f32_16x16x32_bf16 v[68:71], a[128:131], v[16:19], v[132:135]
    v_exp_f32_e64 v180, v112
    v_mfma_f32_16x16x32_bf16 v[68:71], a[132:135], v[20:23], v[68:71]
    ds_read_b64_tr_b16 a[168:169], v210 offset:0
    v_cvt_pk_bf16_f32 v161, v178, v179
    v_mfma_f32_16x16x32_bf16 v[68:71], a[136:139], v[24:27], v[68:71]
    buffer_load_dwordx4 v[234:237], v251, s[16:19], s20 offen offset:2048 sc1
    v_exp_f32_e64 v181, v113
    v_mfma_f32_16x16x32_bf16 v[68:71], a[140:143], v[28:31], v[68:71]
    ds_read_b64_tr_b16 a[170:171], v210 offset:4096
    v_add_f32 v200, v200, v180
    v_add_f32 v200, v200, v181
    v_mfma_f32_16x16x32_bf16 v[84:87], a[144:147], v[16:19], v[132:135]
    v_exp_f32_e64 v182, v114
    v_mfma_f32_16x16x32_bf16 v[84:87], a[148:151], v[20:23], v[84:87]
    ds_read_b64_tr_b16 a[172:173], v211 offset:0
    v_cvt_pk_bf16_f32 v162, v180, v181
    v_mfma_f32_16x16x32_bf16 v[84:87], a[152:155], v[24:27], v[84:87]
    buffer_load_dwordx4 v[238:241], v251, s[16:19], s20 offen offset:3072 sc1
    v_exp_f32_e64 v183, v115
    v_mfma_f32_16x16x32_bf16 v[84:87], a[156:159], v[28:31], v[84:87]
    ds_read_b64_tr_b16 a[174:175], v211 offset:4096
    v_add_f32 v200, v200, v182
    v_add_f32 v200, v200, v183
    v_mfma_f32_16x16x32_bf16 v[72:75], a[128:131], v[32:35], v[136:139]
    v_exp_f32_e64 v176, v100
    v_mfma_f32_16x16x32_bf16 v[72:75], a[132:135], v[36:39], v[72:75]
    ds_read_b64_tr_b16 a[176:177], v212 offset:0
    v_cvt_pk_bf16_f32 v163, v182, v183
    v_mfma_f32_16x16x32_bf16 v[72:75], a[136:139], v[40:43], v[72:75]
    buffer_load_dwordx4 v[242:245], v251, s[32:35], s21 offen sc1
    v_exp_f32_e64 v177, v101
    v_mfma_f32_16x16x32_bf16 v[72:75], a[140:143], v[44:47], v[72:75]
    ds_read_b64_tr_b16 a[178:179], v212 offset:4096
    v_add_f32_e64 v201, v176, v177
    v_mfma_f32_16x16x32_bf16 v[88:91], a[144:147], v[32:35], v[136:139]
    v_exp_f32_e64 v178, v102
    v_mfma_f32_16x16x32_bf16 v[88:91], a[148:151], v[36:39], v[88:91]
    ds_read_b64_tr_b16 a[180:181], v213 offset:0
    v_cvt_pk_bf16_f32 v164, v176, v177
    v_mfma_f32_16x16x32_bf16 v[88:91], a[152:155], v[40:43], v[88:91]
    buffer_load_dwordx4 v[246:249], v251, s[32:35], s22 offen sc1
    v_exp_f32_e64 v179, v103
    v_mfma_f32_16x16x32_bf16 v[88:91], a[156:159], v[44:47], v[88:91]
    ds_read_b64_tr_b16 a[182:183], v213 offset:4096
    v_add_f32 v201, v201, v178
    v_add_f32 v201, v201, v179
    v_mfma_f32_16x16x32_bf16 v[76:79], a[128:131], v[48:51], v[140:143]
    v_exp_f32_e64 v180, v116
    v_mfma_f32_16x16x32_bf16 v[76:79], a[132:135], v[52:55], v[76:79]
    ds_read_b64_tr_b16 a[184:185], v214 offset:0
    v_cvt_pk_bf16_f32 v165, v178, v179
    v_mfma_f32_16x16x32_bf16 v[76:79], a[136:139], v[56:59], v[76:79]
    buffer_load_dwordx4 v[184:187], v251, s[32:35], s23 offen sc1
    v_exp_f32_e64 v181, v117
    v_mfma_f32_16x16x32_bf16 v[76:79], a[140:143], v[60:63], v[76:79]
    ds_read_b64_tr_b16 a[186:187], v214 offset:4096
    v_add_f32 v201, v201, v180
    v_add_f32 v201, v201, v181
    v_mfma_f32_16x16x32_bf16 v[92:95], a[144:147], v[48:51], v[140:143]
    v_exp_f32_e64 v182, v118
    v_mfma_f32_16x16x32_bf16 v[92:95], a[148:151], v[52:55], v[92:95]
    ds_read_b64_tr_b16 a[188:189], v215 offset:0
    v_cvt_pk_bf16_f32 v166, v180, v181
    v_mfma_f32_16x16x32_bf16 v[92:95], a[152:155], v[56:59], v[92:95]
    s_waitcnt lgkmcnt(3)
    s_nop 0
    buffer_load_dwordx4 v[188:191], v251, s[32:35], s24 offen sc1
    v_exp_f32_e64 v183, v119
    v_mfma_f32_16x16x32_bf16 v[92:95], a[156:159], v[60:63], v[92:95]
    ds_read_b64_tr_b16 a[190:191], v215 offset:4096
    v_add_f32 v201, v201, v182
    v_add_f32 v201, v201, v183
    v_mfma_f32_16x16x32_bf16 a[0:3], a[160:163], v[144:147], a[0:3]
    v_exp_f32_e64 v176, v104
    v_mfma_f32_16x16x32_bf16 a[4:7], a[160:163], v[148:151], a[4:7]
    ds_read_b128 a[128:131], v204 offset:24576
    v_cvt_pk_bf16_f32 v167, v182, v183
    v_mfma_f32_16x16x32_bf16 a[8:11], a[160:163], v[152:155], a[8:11]
    s_add_u32 s20, s20, s25
    v_exp_f32 v177, v105
    v_mfma_f32_16x16x32_bf16 a[12:15], a[160:163], v[156:159], a[12:15]
    s_add_u32 s21, s21, s26
    s_nop 0
    ds_read_b128 a[132:135], v205 offset:24576
    v_add_f32_e64 v202, v176, v177
    v_mfma_f32_16x16x32_bf16 a[16:19], a[164:167], v[144:147], a[16:19]
    s_add_u32 s22, s22, s26
    v_exp_f32 v178, v106
    v_mfma_f32_16x16x32_bf16 a[20:23], a[164:167], v[148:151], a[20:23]
    s_add_u32 s23, s23, s26
    s_nop 0
    ds_read_b128 a[136:139], v206 offset:24576
    v_cvt_pk_bf16_f32 v168, v176, v177
    v_mfma_f32_16x16x32_bf16 a[24:27], a[164:167], v[152:155], a[24:27]
    s_add_u32 s24, s24, s26
    v_exp_f32 v179, v107
    v_mfma_f32_16x16x32_bf16 a[28:31], a[164:167], v[156:159], a[28:31]
    ds_read_b128 a[140:143], v207 offset:24576
    v_add_f32 v202, v202, v178
    v_add_f32 v202, v202, v179
    v_mfma_f32_16x16x32_bf16 a[32:35], a[168:171], v[144:147], a[32:35]
    v_exp_f32_e64 v180, v120
    v_mfma_f32_16x16x32_bf16 a[36:39], a[168:171], v[148:151], a[36:39]
    ds_read_b128 a[144:147], v204 offset:28672
    v_cvt_pk_bf16_f32 v169, v178, v179
    v_mfma_f32_16x16x32_bf16 a[40:43], a[168:171], v[152:155], a[40:43]
    v_exp_f32_e64 v181, v121
    v_mfma_f32_16x16x32_bf16 a[44:47], a[168:171], v[156:159], a[44:47]
    ds_read_b128 a[148:151], v205 offset:28672
    v_add_f32 v202, v202, v180
    v_add_f32 v202, v202, v181
    v_mfma_f32_16x16x32_bf16 a[48:51], a[172:175], v[144:147], a[48:51]
    v_exp_f32_e64 v182, v122
    v_mfma_f32_16x16x32_bf16 a[52:55], a[172:175], v[148:151], a[52:55]
    ds_read_b128 a[152:155], v206 offset:28672
    v_cvt_pk_bf16_f32 v170, v180, v181
    v_mfma_f32_16x16x32_bf16 a[56:59], a[172:175], v[152:155], a[56:59]
    v_exp_f32_e64 v183, v123
    v_mfma_f32_16x16x32_bf16 a[60:63], a[172:175], v[156:159], a[60:63]
    v_exp_f32_e64 v176, v108
    v_mfma_f32_16x16x32_bf16 a[64:67], a[176:179], v[144:147], a[64:67]
    v_exp_f32_e64 v177, v109
    v_mfma_f32_16x16x32_bf16 a[68:71], a[176:179], v[148:151], a[68:71]
    ds_read_b128 a[156:159], v207 offset:28672
    v_add_f32 v202, v202, v182
    v_add_f32 v202, v202, v183
    v_mfma_f32_16x16x32_bf16 a[72:75], a[176:179], v[152:155], a[72:75]
    v_exp_f32_e64 v178, v110
    v_mfma_f32_16x16x32_bf16 a[76:79], a[176:179], v[156:159], a[76:79]
    v_exp_f32_e64 v179, v111
    v_mfma_f32_16x16x32_bf16 a[80:83], a[180:183], v[144:147], a[80:83]
    s_add_u32 m0, s38, 0x2000
    s_add_u32 s45, s100, 0x80000
    v_exp_f32_e64 v180, v124
    v_mfma_f32_16x16x32_bf16 a[84:87], a[180:183], v[148:151], a[84:87]
    buffer_load_dwordx4 v251, s[16:19], s45 offen sc1 lds
    v_cvt_pk_bf16_f32 v171, v182, v183
    v_add_f32_e64 v203, v176, v177
    v_mfma_f32_16x16x32_bf16 a[88:91], a[180:183], v[152:155], a[88:91]
    v_exp_f32_e64 v181, v125
    v_mfma_f32_16x16x32_bf16 a[92:95], a[180:183], v[156:159], a[92:95]
    s_waitcnt lgkmcnt(8)
    v_exp_f32 v182, v126
    v_mfma_f32_16x16x32_bf16 a[96:99], a[184:187], v[144:147], a[96:99]
    s_add_u32 m0, s38, 0x2400
    s_add_u32 s45, s100, 0x80400
    v_exp_f32_e64 v183, v127
    v_mfma_f32_16x16x32_bf16 a[100:103], a[184:187], v[148:151], a[100:103]
    buffer_load_dwordx4 v251, s[16:19], s45 offen sc1 lds
    v_cvt_pk_bf16_f32 v172, v176, v177
    v_add_f32 v203, v203, v178
    v_add_f32 v203, v203, v179
    v_mfma_f32_16x16x32_bf16 a[104:107], a[184:187], v[152:155], a[104:107]
    s_add_u32 m0, s38, 0x1c000
    v_cvt_pk_bf16_f32 v173, v178, v179
    v_add_f32 v203, v203, v180
    v_add_f32 v203, v203, v181
    v_mfma_f32_16x16x32_bf16 a[108:111], a[184:187], v[156:159], a[108:111]
    buffer_load_dwordx4 v254, s[12:15], s39 offen lds
    v_cvt_pk_bf16_f32 v174, v180, v181
    v_add_f32 v203, v203, v182
    v_add_f32 v203, v203, v183
    v_mfma_f32_16x16x32_bf16 a[112:115], a[188:191], v[144:147], a[112:115]
    v_cvt_pk_bf16_f32 v175, v182, v183
    v_max3_f32 v216, v200, v201, v202
    v_max_f32_e64 v216, v216, v203
    v_mfma_f32_16x16x32_bf16 a[116:119], a[188:191], v[148:151], a[116:119]
    buffer_load_dwordx4 v255, s[12:15], s39 offen offset:1024 lds
    v_cmp_lt_f32 vcc, v224, v216
    v_add_f32 v193, v193, v197
    v_mfma_f32_16x16x32_bf16 a[120:123], a[188:191], v[152:155], a[120:123]
    s_addk_i32 s39, 0x2000
    v_add_f32 v194, v194, v198
    v_add_f32_e64 v195, v195, v199
    v_mfma_f32_16x16x32_bf16 a[124:127], a[188:191], v[156:159], a[124:127]
    s_cbranch_vccnz RARE_21
BACK_22:
    s_waitcnt vmcnt(16) lgkmcnt(0)
    s_barrier
    s_nop 0
    v_mfma_f32_16x16x32_bf16 v[96:99], a[128:131], v[0:3], v[128:131]
    v_exp_f32_e64 v176, v64
    v_mfma_f32_16x16x32_bf16 v[96:99], a[132:135], v[4:7], v[96:99]
    ds_read_b64_tr_b16 a[160:161], v208 offset:8192
    v_add_f32_e64 v192, v192, v200
    v_mfma_f32_16x16x32_bf16 v[96:99], a[136:139], v[8:11], v[96:99]
    v_exp_f32_e64 v177, v65
    v_mfma_f32_16x16x32_bf16 v[96:99], a[140:143], v[12:15], v[96:99]
    ds_read_b64_tr_b16 a[162:163], v208 offset:12288
    v_add_f32_e64 v196, v176, v177
    v_mfma_f32_16x16x32_bf16 v[112:115], a[144:147], v[0:3], v[128:131]
    v_exp_f32_e64 v178, v66
    v_mfma_f32_16x16x32_bf16 v[112:115], a[148:151], v[4:7], v[112:115]
    ds_read_b64_tr_b16 a[164:165], v209 offset:8192
    v_cvt_pk_bf16_f32 v144, v176, v177
    v_mfma_f32_16x16x32_bf16 v[112:115], a[152:155], v[8:11], v[112:115]
    v_exp_f32_e64 v179, v67
    v_mfma_f32_16x16x32_bf16 v[112:115], a[156:159], v[12:15], v[112:115]
    ds_read_b64_tr_b16 a[166:167], v209 offset:12288
    v_add_f32 v196, v196, v178
    v_add_f32 v196, v196, v179
    v_mfma_f32_16x16x32_bf16 v[100:103], a[128:131], v[16:19], v[132:135]
    v_exp_f32_e64 v180, v80
    v_mfma_f32_16x16x32_bf16 v[100:103], a[132:135], v[20:23], v[100:103]
    ds_read_b64_tr_b16 a[168:169], v210 offset:8192
    v_cvt_pk_bf16_f32 v145, v178, v179
    v_mfma_f32_16x16x32_bf16 v[100:103], a[136:139], v[24:27], v[100:103]
    v_exp_f32_e64 v181, v81
    v_mfma_f32_16x16x32_bf16 v[100:103], a[140:143], v[28:31], v[100:103]
    ds_read_b64_tr_b16 a[170:171], v210 offset:12288
    v_add_f32 v196, v196, v180
    v_add_f32 v196, v196, v181
    v_mfma_f32_16x16x32_bf16 v[116:119], a[144:147], v[16:19], v[132:135]
    v_exp_f32_e64 v182, v82
    v_mfma_f32_16x16x32_bf16 v[116:119], a[148:151], v[20:23], v[116:119]
    ds_read_b64_tr_b16 a[172:173], v211 offset:8192
    v_cvt_pk_bf16_f32 v146, v180, v181
    v_mfma_f32_16x16x32_bf16 v[116:119], a[152:155], v[24:27], v[116:119]
    v_exp_f32_e64 v183, v83
    v_mfma_f32_16x16x32_bf16 v[116:119], a[156:159], v[28:31], v[116:119]
    ds_read_b64_tr_b16 a[174:175], v211 offset:12288
    v_add_f32 v196, v196, v182
    v_add_f32 v196, v196, v183
    v_mfma_f32_16x16x32_bf16 v[104:107], a[128:131], v[32:35], v[136:139]
    v_exp_f32_e64 v176, v68
    v_mfma_f32_16x16x32_bf16 v[104:107], a[132:135], v[36:39], v[104:107]
    ds_read_b64_tr_b16 a[176:177], v212 offset:8192
    v_cvt_pk_bf16_f32 v147, v182, v183
    v_mfma_f32_16x16x32_bf16 v[104:107], a[136:139], v[40:43], v[104:107]
    v_exp_f32_e64 v177, v69
    v_mfma_f32_16x16x32_bf16 v[104:107], a[140:143], v[44:47], v[104:107]
    ds_read_b64_tr_b16 a[178:179], v212 offset:12288
    v_add_f32_e64 v197, v176, v177
    v_mfma_f32_16x16x32_bf16 v[120:123], a[144:147], v[32:35], v[136:139]
    v_exp_f32_e64 v178, v70
    v_mfma_f32_16x16x32_bf16 v[120:123], a[148:151], v[36:39], v[120:123]
    ds_read_b64_tr_b16 a[180:181], v213 offset:8192
    v_cvt_pk_bf16_f32 v148, v176, v177
    v_mfma_f32_16x16x32_bf16 v[120:123], a[152:155], v[40:43], v[120:123]
    v_exp_f32_e64 v179, v71
    v_mfma_f32_16x16x32_bf16 v[120:123], a[156:159], v[44:47], v[120:123]
    ds_read_b64_tr_b16 a[182:183], v213 offset:12288
    v_add_f32 v197, v197, v178
    v_add_f32 v197, v197, v179
    v_mfma_f32_16x16x32_bf16 v[108:111], a[128:131], v[48:51], v[140:143]
    v_exp_f32_e64 v180, v84
    v_mfma_f32_16x16x32_bf16 v[108:111], a[132:135], v[52:55], v[108:111]
    ds_read_b64_tr_b16 a[184:185], v214 offset:8192
    v_cvt_pk_bf16_f32 v149, v178, v179
    v_mfma_f32_16x16x32_bf16 v[108:111], a[136:139], v[56:59], v[108:111]
    v_exp_f32_e64 v181, v85
    v_mfma_f32_16x16x32_bf16 v[108:111], a[140:143], v[60:63], v[108:111]
    ds_read_b64_tr_b16 a[186:187], v214 offset:12288
    v_add_f32 v197, v197, v180
    v_add_f32 v197, v197, v181
    v_mfma_f32_16x16x32_bf16 v[124:127], a[144:147], v[48:51], v[140:143]
    v_exp_f32_e64 v182, v86
    v_mfma_f32_16x16x32_bf16 v[124:127], a[148:151], v[52:55], v[124:127]
    ds_read_b64_tr_b16 a[188:189], v215 offset:8192
    v_cvt_pk_bf16_f32 v150, v180, v181
    v_mfma_f32_16x16x32_bf16 v[124:127], a[152:155], v[56:59], v[124:127]
    s_waitcnt lgkmcnt(3)
    v_exp_f32 v183, v87
    v_mfma_f32_16x16x32_bf16 v[124:127], a[156:159], v[60:63], v[124:127]
    ds_read_b64_tr_b16 a[190:191], v215 offset:12288
    v_add_f32 v197, v197, v182
    v_add_f32 v197, v197, v183
    v_mfma_f32_16x16x32_bf16 a[0:3], a[160:163], v[160:163], a[0:3]
    v_exp_f32_e64 v176, v72
    v_mfma_f32_16x16x32_bf16 a[4:7], a[160:163], v[164:167], a[4:7]
    ds_read_b128 a[128:131], v204 offset:32768
    v_cvt_pk_bf16_f32 v151, v182, v183
    v_mfma_f32_16x16x32_bf16 a[8:11], a[160:163], v[168:171], a[8:11]
    v_exp_f32_e64 v177, v73
    v_mfma_f32_16x16x32_bf16 a[12:15], a[160:163], v[172:175], a[12:15]
    ds_read_b128 a[132:135], v205 offset:32768
    v_add_f32_e64 v198, v176, v177
    v_mfma_f32_16x16x32_bf16 a[16:19], a[164:167], v[160:163], a[16:19]
    v_exp_f32_e64 v178, v74
    v_mfma_f32_16x16x32_bf16 a[20:23], a[164:167], v[164:167], a[20:23]
    ds_read_b128 a[136:139], v206 offset:32768
    v_cvt_pk_bf16_f32 v152, v176, v177
    v_mfma_f32_16x16x32_bf16 a[24:27], a[164:167], v[168:171], a[24:27]
    v_exp_f32_e64 v179, v75
    v_mfma_f32_16x16x32_bf16 a[28:31], a[164:167], v[172:175], a[28:31]
    ds_read_b128 a[140:143], v207 offset:32768
    v_add_f32 v198, v198, v178
    v_add_f32 v198, v198, v179
    v_mfma_f32_16x16x32_bf16 a[32:35], a[168:171], v[160:163], a[32:35]
    v_exp_f32_e64 v180, v88
    v_mfma_f32_16x16x32_bf16 a[36:39], a[168:171], v[164:167], a[36:39]
    ds_read_b128 a[144:147], v204 offset:36864
    v_cvt_pk_bf16_f32 v153, v178, v179
    v_mfma_f32_16x16x32_bf16 a[40:43], a[168:171], v[168:171], a[40:43]
    v_exp_f32_e64 v181, v89
    v_mfma_f32_16x16x32_bf16 a[44:47], a[168:171], v[172:175], a[44:47]
    ds_read_b128 a[148:151], v205 offset:36864
    v_add_f32 v198, v198, v180
    v_add_f32 v198, v198, v181
    v_mfma_f32_16x16x32_bf16 a[48:51], a[172:175], v[160:163], a[48:51]
    v_exp_f32_e64 v182, v90
    v_mfma_f32_16x16x32_bf16 a[52:55], a[172:175], v[164:167], a[52:55]
    ds_read_b128 a[152:155], v206 offset:36864
    v_cvt_pk_bf16_f32 v154, v180, v181
    v_mfma_f32_16x16x32_bf16 a[56:59], a[172:175], v[168:171], a[56:59]
    v_exp_f32_e64 v183, v91
    v_mfma_f32_16x16x32_bf16 a[60:63], a[172:175], v[172:175], a[60:63]
    v_exp_f32_e64 v176, v76
    v_mfma_f32_16x16x32_bf16 a[64:67], a[176:179], v[160:163], a[64:67]
    v_exp_f32_e64 v177, v77
    v_mfma_f32_16x16x32_bf16 a[68:71], a[176:179], v[164:167], a[68:71]
    ds_read_b128 a[156:159], v207 offset:36864
    v_add_f32 v198, v198, v182
    v_add_f32 v198, v198, v183
    v_mfma_f32_16x16x32_bf16 a[72:75], a[176:179], v[168:171], a[72:75]
    v_exp_f32_e64 v178, v78
    v_mfma_f32_16x16x32_bf16 a[76:79], a[176:179], v[172:175], a[76:79]
    v_exp_f32_e64 v179, v79
    v_mfma_f32_16x16x32_bf16 a[80:83], a[180:183], v[160:163], a[80:83]
    s_add_u32 m0, s38, 0x4000
    s_add_u32 s45, s100, 0x80800
    v_exp_f32_e64 v180, v92
    v_mfma_f32_16x16x32_bf16 a[84:87], a[180:183], v[164:167], a[84:87]
    buffer_load_dwordx4 v251, s[16:19], s45 offen sc1 lds
    v_cvt_pk_bf16_f32 v155, v182, v183
    v_add_f32_e64 v199, v176, v177
    v_mfma_f32_16x16x32_bf16 a[88:91], a[180:183], v[168:171], a[88:91]
    v_exp_f32_e64 v181, v93
    v_mfma_f32_16x16x32_bf16 a[92:95], a[180:183], v[172:175], a[92:95]
    s_waitcnt lgkmcnt(8)
    v_exp_f32 v182, v94
    v_mfma_f32_16x16x32_bf16 a[96:99], a[184:187], v[160:163], a[96:99]
    s_add_u32 m0, s38, 0x4400
    s_add_u32 s45, s100, 0x80c00
    v_exp_f32_e64 v183, v95
    v_mfma_f32_16x16x32_bf16 a[100:103], a[184:187], v[164:167], a[100:103]
    buffer_load_dwordx4 v251, s[16:19], s45 offen sc1 lds
    v_cvt_pk_bf16_f32 v156, v176, v177
    v_add_f32 v199, v199, v178
    v_add_f32 v199, v199, v179
    v_mfma_f32_16x16x32_bf16 a[104:107], a[184:187], v[168:171], a[104:107]
    s_add_u32 m0, s38, 0x1e000
    v_cvt_pk_bf16_f32 v157, v178, v179
    v_add_f32 v199, v199, v180
    v_add_f32 v199, v199, v181
    v_mfma_f32_16x16x32_bf16 a[108:111], a[184:187], v[172:175], a[108:111]
    buffer_load_dwordx4 v254, s[12:15], s39 offen lds
    v_cvt_pk_bf16_f32 v158, v180, v181
    v_add_f32 v199, v199, v182
    v_add_f32 v199, v199, v183
    v_mfma_f32_16x16x32_bf16 a[112:115], a[188:191], v[160:163], a[112:115]
    v_cvt_pk_bf16_f32 v159, v182, v183
    v_max3_f32 v216, v196, v197, v198
    v_max_f32_e64 v216, v216, v199
    v_mfma_f32_16x16x32_bf16 a[116:119], a[188:191], v[164:167], a[116:119]
    buffer_load_dwordx4 v255, s[12:15], s39 offen offset:1024 lds
    v_cmp_lt_f32 vcc, v224, v216
    v_add_f32 v193, v193, v201
    v_mfma_f32_16x16x32_bf16 a[120:123], a[188:191], v[168:171], a[120:123]
    s_addk_i32 s39, 0x2000
    v_add_f32 v194, v194, v202
    v_add_f32_e64 v195, v195, v203
    v_mfma_f32_16x16x32_bf16 a[124:127], a[188:191], v[172:175], a[124:127]
    s_cbranch_vccnz RARE_23
BACK_24:
    s_waitcnt lgkmcnt(0)
    v_mfma_f32_16x16x32_bf16 v[64:67], a[128:131], v[0:3], v[128:131]
    s_waitcnt vmcnt(8)
    v_exp_f32 v176, v96
    v_mfma_f32_16x16x32_bf16 v[64:67], a[132:135], v[4:7], v[64:67]
    ds_read_b64_tr_b16 a[160:161], v208 offset:16384
    v_add_f32_e64 v192, v192, v196
    v_mfma_f32_16x16x32_bf16 v[64:67], a[136:139], v[8:11], v[64:67]
    v_exp_f32_e64 v177, v97
    v_mfma_f32_16x16x32_bf16 v[64:67], a[140:143], v[12:15], v[64:67]
    ds_read_b64_tr_b16 a[162:163], v208 offset:20480
    v_add_f32_e64 v200, v176, v177
    v_mfma_f32_16x16x32_bf16 a[192:195], v[226:229], v[242:245], a[192:195]
    v_cvt_pk_bf16_f32 v160, v176, v177
    v_add_f32_e64 v193, v193, v197
    v_mfma_f32_16x16x32_bf16 v[80:83], a[144:147], v[0:3], v[128:131]
    v_exp_f32_e64 v178, v98
    v_mfma_f32_16x16x32_bf16 v[80:83], a[148:151], v[4:7], v[80:83]
    ds_read_b64_tr_b16 a[164:165], v209 offset:16384
    v_add_f32_e64 v200, v200, v178
    v_mfma_f32_16x16x32_bf16 v[80:83], a[152:155], v[8:11], v[80:83]
    v_exp_f32_e64 v179, v99
    v_mfma_f32_16x16x32_bf16 v[80:83], a[156:159], v[12:15], v[80:83]
    ds_read_b64_tr_b16 a[166:167], v209 offset:20480
    v_add_f32_e64 v200, v200, v179
    v_mfma_f32_16x16x32_bf16 a[196:199], v[226:229], v[246:249], a[196:199]
    v_cvt_pk_bf16_f32 v161, v178, v179
    v_add_f32_e64 v194, v194, v198
    v_mfma_f32_16x16x32_bf16 v[68:71], a[128:131], v[16:19], v[132:135]
    v_exp_f32_e64 v180, v112
    v_mfma_f32_16x16x32_bf16 v[68:71], a[132:135], v[20:23], v[68:71]
    ds_read_b64_tr_b16 a[168:169], v210 offset:16384
    v_add_f32_e64 v200, v200, v180
    v_mfma_f32_16x16x32_bf16 v[68:71], a[136:139], v[24:27], v[68:71]
    v_exp_f32_e64 v181, v113
    v_mfma_f32_16x16x32_bf16 v[68:71], a[140:143], v[28:31], v[68:71]
    ds_read_b64_tr_b16 a[170:171], v210 offset:20480
    v_add_f32_e64 v200, v200, v181
    v_mfma_f32_16x16x32_bf16 a[200:203], v[226:229], v[184:187], a[200:203]
    v_cvt_pk_bf16_f32 v162, v180, v181
    v_add_f32_e64 v195, v195, v199
    v_mfma_f32_16x16x32_bf16 v[84:87], a[144:147], v[16:19], v[132:135]
    v_exp_f32_e64 v182, v114
    v_mfma_f32_16x16x32_bf16 v[84:87], a[148:151], v[20:23], v[84:87]
    ds_read_b64_tr_b16 a[172:173], v211 offset:16384
    v_add_f32_e64 v200, v200, v182
    v_mfma_f32_16x16x32_bf16 v[84:87], a[152:155], v[24:27], v[84:87]
    v_exp_f32_e64 v183, v115
    v_mfma_f32_16x16x32_bf16 v[84:87], a[156:159], v[28:31], v[84:87]
    ds_read_b64_tr_b16 a[174:175], v211 offset:20480
    v_add_f32_e64 v200, v200, v183
    v_mfma_f32_16x16x32_bf16 a[204:207], v[226:229], v[188:191], a[204:207]
    v_cvt_pk_bf16_f32 v163, v182, v183
    v_mfma_f32_16x16x32_bf16 v[72:75], a[128:131], v[32:35], v[136:139]
    v_exp_f32_e64 v176, v100
    v_mfma_f32_16x16x32_bf16 v[72:75], a[132:135], v[36:39], v[72:75]
    ds_read_b64_tr_b16 a[176:177], v212 offset:16384
    v_mfma_f32_16x16x32_bf16 v[72:75], a[136:139], v[40:43], v[72:75]
    v_exp_f32_e64 v177, v101
    v_mfma_f32_16x16x32_bf16 v[72:75], a[140:143], v[44:47], v[72:75]
    ds_read_b64_tr_b16 a[178:179], v212 offset:20480
    v_add_f32_e64 v201, v176, v177
    v_mfma_f32_16x16x32_bf16 a[208:211], v[230:233], v[242:245], a[208:211]
    v_cvt_pk_bf16_f32 v164, v176, v177
    v_mfma_f32_16x16x32_bf16 v[88:91], a[144:147], v[32:35], v[136:139]
    v_exp_f32_e64 v178, v102
    v_mfma_f32_16x16x32_bf16 v[88:91], a[148:151], v[36:39], v[88:91]
    ds_read_b64_tr_b16 a[180:181], v213 offset:16384
    v_add_f32_e64 v201, v201, v178
    v_mfma_f32_16x16x32_bf16 v[88:91], a[152:155], v[40:43], v[88:91]
    v_exp_f32_e64 v179, v103
    v_mfma_f32_16x16x32_bf16 v[88:91], a[156:159], v[44:47], v[88:91]
    ds_read_b64_tr_b16 a[182:183], v213 offset:20480
    v_add_f32_e64 v201, v201, v179
    v_mfma_f32_16x16x32_bf16 a[212:215], v[230:233], v[246:249], a[212:215]
    v_cvt_pk_bf16_f32 v165, v178, v179
    v_mfma_f32_16x16x32_bf16 v[76:79], a[128:131], v[48:51], v[140:143]
    v_exp_f32_e64 v180, v116
    v_mfma_f32_16x16x32_bf16 v[76:79], a[132:135], v[52:55], v[76:79]
    ds_read_b64_tr_b16 a[184:185], v214 offset:16384
    v_add_f32_e64 v201, v201, v180
    v_mfma_f32_16x16x32_bf16 v[76:79], a[136:139], v[56:59], v[76:79]
    v_exp_f32_e64 v181, v117
    v_mfma_f32_16x16x32_bf16 v[76:79], a[140:143], v[60:63], v[76:79]
    ds_read_b64_tr_b16 a[186:187], v214 offset:20480
    v_add_f32_e64 v201, v201, v181
    v_mfma_f32_16x16x32_bf16 a[216:219], v[230:233], v[184:187], a[216:219]
    v_cvt_pk_bf16_f32 v166, v180, v181
    v_mfma_f32_16x16x32_bf16 v[92:95], a[144:147], v[48:51], v[140:143]
    v_exp_f32_e64 v182, v118
    v_mfma_f32_16x16x32_bf16 v[92:95], a[148:151], v[52:55], v[92:95]
    ds_read_b64_tr_b16 a[188:189], v215 offset:16384
    v_add_f32_e64 v201, v201, v182
    v_mfma_f32_16x16x32_bf16 v[92:95], a[152:155], v[56:59], v[92:95]
    s_waitcnt lgkmcnt(3)
    v_exp_f32 v183, v119
    v_mfma_f32_16x16x32_bf16 v[92:95], a[156:159], v[60:63], v[92:95]
    ds_read_b64_tr_b16 a[190:191], v215 offset:20480
    v_add_f32_e64 v201, v201, v183
    v_mfma_f32_16x16x32_bf16 a[220:223], v[230:233], v[188:191], a[220:223]
    v_cvt_pk_bf16_f32 v167, v182, v183
    v_mfma_f32_16x16x32_bf16 a[0:3], a[160:163], v[144:147], a[0:3]
    v_exp_f32_e64 v176, v104
    v_mfma_f32_16x16x32_bf16 a[4:7], a[160:163], v[148:151], a[4:7]
    ds_read_b128 a[128:131], v204 offset:40960
    v_mfma_f32_16x16x32_bf16 a[8:11], a[160:163], v[152:155], a[8:11]
    v_exp_f32_e64 v177, v105
    v_mfma_f32_16x16x32_bf16 a[12:15], a[160:163], v[156:159], a[12:15]
    ds_read_b128 a[132:135], v205 offset:40960
    v_add_f32_e64 v202, v176, v177
    v_mfma_f32_16x16x32_bf16 a[224:227], v[234:237], v[242:245], a[224:227]
    v_cvt_pk_bf16_f32 v168, v176, v177
    v_mfma_f32_16x16x32_bf16 a[16:19], a[164:167], v[144:147], a[16:19]
    v_exp_f32_e64 v178, v106
    v_mfma_f32_16x16x32_bf16 a[20:23], a[164:167], v[148:151], a[20:23]
    ds_read_b128 a[136:139], v206 offset:40960
    v_add_f32_e64 v202, v202, v178
    v_mfma_f32_16x16x32_bf16 a[24:27], a[164:167], v[152:155], a[24:27]
    v_exp_f32_e64 v179, v107
    v_mfma_f32_16x16x32_bf16 a[28:31], a[164:167], v[156:159], a[28:31]
    ds_read_b128 a[140:143], v207 offset:40960
    v_add_f32_e64 v202, v202, v179
    v_mfma_f32_16x16x32_bf16 a[228:231], v[234:237], v[246:249], a[228:231]
    v_cvt_pk_bf16_f32 v169, v178, v179
    v_mfma_f32_16x16x32_bf16 a[32:35], a[168:171], v[144:147], a[32:35]
    v_exp_f32_e64 v180, v120
    v_mfma_f32_16x16x32_bf16 a[36:39], a[168:171], v[148:151], a[36:39]
    ds_read_b128 a[144:147], v204 offset:45056
    v_add_f32_e64 v202, v202, v180
    v_mfma_f32_16x16x32_bf16 a[40:43], a[168:171], v[152:155], a[40:43]
    v_exp_f32_e64 v181, v121
    v_mfma_f32_16x16x32_bf16 a[44:47], a[168:171], v[156:159], a[44:47]
    ds_read_b128 a[148:151], v205 offset:45056
    v_add_f32_e64 v202, v202, v181
    v_mfma_f32_16x16x32_bf16 a[232:235], v[234:237], v[184:187], a[232:235]
    v_cvt_pk_bf16_f32 v170, v180, v181
    v_mfma_f32_16x16x32_bf16 a[48:51], a[172:175], v[144:147], a[48:51]
    v_exp_f32_e64 v182, v122
    v_mfma_f32_16x16x32_bf16 a[52:55], a[172:175], v[148:151], a[52:55]
    ds_read_b128 a[152:155], v206 offset:45056
    v_add_f32_e64 v202, v202, v182
    v_mfma_f32_16x16x32_bf16 a[56:59], a[172:175], v[152:155], a[56:59]
    v_exp_f32_e64 v183, v123
    v_mfma_f32_16x16x32_bf16 a[60:63], a[172:175], v[156:159], a[60:63]
    v_exp_f32_e64 v176, v108
    v_mfma_f32_16x16x32_bf16 a[236:239], v[234:237], v[188:191], a[236:239]
    v_add_f32_e64 v202, v202, v183
    v_cvt_pk_bf16_f32 v171, v182, v183
    v_mfma_f32_16x16x32_bf16 a[64:67], a[176:179], v[144:147], a[64:67]
    v_exp_f32_e64 v177, v109
    v_mfma_f32_16x16x32_bf16 a[68:71], a[176:179], v[148:151], a[68:71]
    ds_read_b128 a[156:159], v207 offset:45056
    v_add_f32_e64 v203, v176, v177
    v_mfma_f32_16x16x32_bf16 a[72:75], a[176:179], v[152:155], a[72:75]
    v_exp_f32_e64 v178, v110
    v_mfma_f32_16x16x32_bf16 a[76:79], a[176:179], v[156:159], a[76:79]
    v_exp_f32_e64 v179, v111
    v_mfma_f32_16x16x32_bf16 a[240:243], v[238:241], v[242:245], a[240:243]
    v_cvt_pk_bf16_f32 v172, v176, v177
    v_add_f32 v203, v203, v178
    v_add_f32 v203, v203, v179
    v_mfma_f32_16x16x32_bf16 a[80:83], a[180:183], v[144:147], a[80:83]
    s_add_u32 m0, s38, 0x6000
    s_add_u32 s45, s100, 0x88000
    v_exp_f32_e64 v180, v124
    v_mfma_f32_16x16x32_bf16 a[84:87], a[180:183], v[148:151], a[84:87]
    buffer_load_dwordx4 v251, s[16:19], s45 offen sc1 lds
    v_cvt_pk_bf16_f32 v173, v178, v179
    v_mfma_f32_16x16x32_bf16 a[88:91], a[180:183], v[152:155], a[88:91]
    v_exp_f32_e64 v181, v125
    v_mfma_f32_16x16x32_bf16 a[92:95], a[180:183], v[156:159], a[92:95]
    s_waitcnt lgkmcnt(8)
    v_exp_f32 v182, v126
    v_mfma_f32_16x16x32_bf16 a[244:247], v[238:241], v[246:249], a[244:247]
    v_add_f32 v203, v203, v180
    v_add_f32 v203, v203, v181
    v_cvt_pk_bf16_f32 v174, v180, v181
    v_mfma_f32_16x16x32_bf16 a[96:99], a[184:187], v[144:147], a[96:99]
    s_add_u32 m0, s38, 0x6400
    s_add_u32 s45, s100, 0x88400
    v_exp_f32_e64 v183, v127
    v_mfma_f32_16x16x32_bf16 a[100:103], a[184:187], v[148:151], a[100:103]
    buffer_load_dwordx4 v251, s[16:19], s45 offen sc1 lds
    v_add_f32 v203, v203, v182
    v_add_f32 v203, v203, v183
    v_mfma_f32_16x16x32_bf16 a[104:107], a[184:187], v[152:155], a[104:107]
    s_add_u32 m0, s27, 0x20000
    s_add_u32 s45, s100, 0x98000
    v_cvt_pk_bf16_f32 v175, v182, v183
    v_max3_f32 v216, v200, v201, v202
    v_max_f32_e64 v216, v216, v203
    v_mfma_f32_16x16x32_bf16 a[108:111], a[184:187], v[156:159], a[108:111]
    buffer_load_dwordx4 v251, s[16:19], s45 offen sc1 lds
    v_cmp_lt_f32 vcc, v224, v216
    s_nop 0
    v_mfma_f32_16x16x32_bf16 a[248:251], v[238:241], v[184:187], a[248:251]
    v_mfma_f32_16x16x32_bf16 a[112:115], a[188:191], v[144:147], a[112:115]
    s_add_u32 m0, s27, 0x20400
    s_add_u32 s45, s100, 0x98400
    v_mfma_f32_16x16x32_bf16 a[116:119], a[188:191], v[148:151], a[116:119]
    buffer_load_dwordx4 v251, s[16:19], s45 offen sc1 lds
    v_mfma_f32_16x16x32_bf16 a[120:123], a[188:191], v[152:155], a[120:123]
    v_mfma_f32_16x16x32_bf16 a[124:127], a[188:191], v[156:159], a[124:127]
    v_mfma_f32_16x16x32_bf16 a[252:255], v[238:241], v[188:191], a[252:255]
    s_cbranch_vccnz RARE_25
BACK_26:
    s_waitcnt vmcnt(16) lgkmcnt(0)
    s_barrier
    s_nop 0
    v_mfma_f32_16x16x32_bf16 v[96:99], a[128:131], v[0:3], v[128:131]
    v_exp_f32_e64 v176, v64
    v_mfma_f32_16x16x32_bf16 v[96:99], a[132:135], v[4:7], v[96:99]
    ds_read_b64_tr_b16 a[160:161], v208 offset:24576
    v_add_f32_e64 v192, v192, v200
    v_mfma_f32_16x16x32_bf16 v[96:99], a[136:139], v[8:11], v[96:99]
    v_exp_f32_e64 v177, v65
    v_mfma_f32_16x16x32_bf16 v[96:99], a[140:143], v[12:15], v[96:99]
    ds_read_b64_tr_b16 a[162:163], v208 offset:28672
    v_add_f32_e64 v196, v176, v177
    v_mfma_f32_16x16x32_bf16 v[112:115], a[144:147], v[0:3], v[128:131]
    v_exp_f32_e64 v178, v66
    v_mfma_f32_16x16x32_bf16 v[112:115], a[148:151], v[4:7], v[112:115]
    ds_read_b64_tr_b16 a[164:165], v209 offset:24576
    v_cvt_pk_bf16_f32 v144, v176, v177
    v_mfma_f32_16x16x32_bf16 v[112:115], a[152:155], v[8:11], v[112:115]
    v_exp_f32_e64 v179, v67
    v_mfma_f32_16x16x32_bf16 v[112:115], a[156:159], v[12:15], v[112:115]
    ds_read_b64_tr_b16 a[166:167], v209 offset:28672
    v_add_f32 v196, v196, v178
    v_add_f32 v196, v196, v179
    v_mfma_f32_16x16x32_bf16 v[100:103], a[128:131], v[16:19], v[132:135]
    v_exp_f32_e64 v180, v80
    v_mfma_f32_16x16x32_bf16 v[100:103], a[132:135], v[20:23], v[100:103]
    ds_read_b64_tr_b16 a[168:169], v210 offset:24576
    v_cvt_pk_bf16_f32 v145, v178, v179
    v_mfma_f32_16x16x32_bf16 v[100:103], a[136:139], v[24:27], v[100:103]
    v_exp_f32_e64 v181, v81
    v_mfma_f32_16x16x32_bf16 v[100:103], a[140:143], v[28:31], v[100:103]
    ds_read_b64_tr_b16 a[170:171], v210 offset:28672
    v_add_f32 v196, v196, v180
    v_add_f32 v196, v196, v181
    v_mfma_f32_16x16x32_bf16 v[116:119], a[144:147], v[16:19], v[132:135]
    v_exp_f32_e64 v182, v82
    v_mfma_f32_16x16x32_bf16 v[116:119], a[148:151], v[20:23], v[116:119]
    ds_read_b64_tr_b16 a[172:173], v211 offset:24576
    v_cvt_pk_bf16_f32 v146, v180, v181
    v_mfma_f32_16x16x32_bf16 v[116:119], a[152:155], v[24:27], v[116:119]
    v_exp_f32_e64 v183, v83
    v_mfma_f32_16x16x32_bf16 v[116:119], a[156:159], v[28:31], v[116:119]
    ds_read_b64_tr_b16 a[174:175], v211 offset:28672
    v_add_f32 v196, v196, v182
    v_add_f32 v196, v196, v183
    v_mfma_f32_16x16x32_bf16 v[104:107], a[128:131], v[32:35], v[136:139]
    v_exp_f32_e64 v176, v68
    v_mfma_f32_16x16x32_bf16 v[104:107], a[132:135], v[36:39], v[104:107]
    ds_read_b64_tr_b16 a[176:177], v212 offset:24576
    v_cvt_pk_bf16_f32 v147, v182, v183
    v_mfma_f32_16x16x32_bf16 v[104:107], a[136:139], v[40:43], v[104:107]
    v_exp_f32_e64 v177, v69
    v_mfma_f32_16x16x32_bf16 v[104:107], a[140:143], v[44:47], v[104:107]
    ds_read_b64_tr_b16 a[178:179], v212 offset:28672
    v_add_f32_e64 v197, v176, v177
    v_mfma_f32_16x16x32_bf16 v[120:123], a[144:147], v[32:35], v[136:139]
    v_exp_f32_e64 v178, v70
    v_mfma_f32_16x16x32_bf16 v[120:123], a[148:151], v[36:39], v[120:123]
    ds_read_b64_tr_b16 a[180:181], v213 offset:24576
    v_cvt_pk_bf16_f32 v148, v176, v177
    v_mfma_f32_16x16x32_bf16 v[120:123], a[152:155], v[40:43], v[120:123]
    v_exp_f32_e64 v179, v71
    v_mfma_f32_16x16x32_bf16 v[120:123], a[156:159], v[44:47], v[120:123]
    ds_read_b64_tr_b16 a[182:183], v213 offset:28672
    v_add_f32 v197, v197, v178
    v_add_f32 v197, v197, v179
    v_mfma_f32_16x16x32_bf16 v[108:111], a[128:131], v[48:51], v[140:143]
    v_exp_f32_e64 v180, v84
    v_mfma_f32_16x16x32_bf16 v[108:111], a[132:135], v[52:55], v[108:111]
    ds_read_b64_tr_b16 a[184:185], v214 offset:24576
    v_cvt_pk_bf16_f32 v149, v178, v179
    v_mfma_f32_16x16x32_bf16 v[108:111], a[136:139], v[56:59], v[108:111]
    v_exp_f32_e64 v181, v85
    v_mfma_f32_16x16x32_bf16 v[108:111], a[140:143], v[60:63], v[108:111]
    ds_read_b64_tr_b16 a[186:187], v214 offset:28672
    v_add_f32 v197, v197, v180
    v_add_f32 v197, v197, v181
    v_mfma_f32_16x16x32_bf16 v[124:127], a[144:147], v[48:51], v[140:143]
    v_exp_f32_e64 v182, v86
    v_mfma_f32_16x16x32_bf16 v[124:127], a[148:151], v[52:55], v[124:127]
    ds_read_b64_tr_b16 a[188:189], v215 offset:24576
    v_cvt_pk_bf16_f32 v150, v180, v181
    v_mfma_f32_16x16x32_bf16 v[124:127], a[152:155], v[56:59], v[124:127]
    s_waitcnt lgkmcnt(3)
    v_exp_f32 v183, v87
    v_mfma_f32_16x16x32_bf16 v[124:127], a[156:159], v[60:63], v[124:127]
    ds_read_b64_tr_b16 a[190:191], v215 offset:28672
    v_add_f32 v197, v197, v182
    v_add_f32 v197, v197, v183
    v_mfma_f32_16x16x32_bf16 a[0:3], a[160:163], v[160:163], a[0:3]
    v_exp_f32_e64 v176, v72
    v_mfma_f32_16x16x32_bf16 a[4:7], a[160:163], v[164:167], a[4:7]
    ds_read_b128 a[128:131], v204 offset:49152
    v_cvt_pk_bf16_f32 v151, v182, v183
    v_mfma_f32_16x16x32_bf16 a[8:11], a[160:163], v[168:171], a[8:11]
    v_exp_f32_e64 v177, v73
    v_mfma_f32_16x16x32_bf16 a[12:15], a[160:163], v[172:175], a[12:15]
    ds_read_b128 a[132:135], v205 offset:49152
    v_add_f32_e64 v198, v176, v177
    v_mfma_f32_16x16x32_bf16 a[16:19], a[164:167], v[160:163], a[16:19]
    v_exp_f32_e64 v178, v74
    v_mfma_f32_16x16x32_bf16 a[20:23], a[164:167], v[164:167], a[20:23]
    ds_read_b128 a[136:139], v206 offset:49152
    v_cvt_pk_bf16_f32 v152, v176, v177
    v_mfma_f32_16x16x32_bf16 a[24:27], a[164:167], v[168:171], a[24:27]
    v_exp_f32_e64 v179, v75
    v_mfma_f32_16x16x32_bf16 a[28:31], a[164:167], v[172:175], a[28:31]
    ds_read_b128 a[140:143], v207 offset:49152
    v_add_f32 v198, v198, v178
    v_add_f32 v198, v198, v179
    v_mfma_f32_16x16x32_bf16 a[32:35], a[168:171], v[160:163], a[32:35]
    v_exp_f32_e64 v180, v88
    v_mfma_f32_16x16x32_bf16 a[36:39], a[168:171], v[164:167], a[36:39]
    ds_read_b128 a[144:147], v204 offset:53248
    v_cvt_pk_bf16_f32 v153, v178, v179
    v_mfma_f32_16x16x32_bf16 a[40:43], a[168:171], v[168:171], a[40:43]
    v_exp_f32_e64 v181, v89
    v_mfma_f32_16x16x32_bf16 a[44:47], a[168:171], v[172:175], a[44:47]
    ds_read_b128 a[148:151], v205 offset:53248
    v_add_f32 v198, v198, v180
    v_add_f32 v198, v198, v181
    v_mfma_f32_16x16x32_bf16 a[48:51], a[172:175], v[160:163], a[48:51]
    v_exp_f32_e64 v182, v90
    v_mfma_f32_16x16x32_bf16 a[52:55], a[172:175], v[164:167], a[52:55]
    ds_read_b128 a[152:155], v206 offset:53248
    v_cvt_pk_bf16_f32 v154, v180, v181
    v_mfma_f32_16x16x32_bf16 a[56:59], a[172:175], v[168:171], a[56:59]
    v_exp_f32_e64 v183, v91
    v_mfma_f32_16x16x32_bf16 a[60:63], a[172:175], v[172:175], a[60:63]
    v_exp_f32_e64 v176, v76
    v_mfma_f32_16x16x32_bf16 a[64:67], a[176:179], v[160:163], a[64:67]
    v_exp_f32_e64 v177, v77
    v_mfma_f32_16x16x32_bf16 a[68:71], a[176:179], v[164:167], a[68:71]
    ds_read_b128 a[156:159], v207 offset:53248
    v_add_f32 v198, v198, v182
    v_add_f32 v198, v198, v183
    v_mfma_f32_16x16x32_bf16 a[72:75], a[176:179], v[168:171], a[72:75]
    v_exp_f32_e64 v178, v78
    v_mfma_f32_16x16x32_bf16 a[76:79], a[176:179], v[172:175], a[76:79]
    v_exp_f32_e64 v179, v79
    v_mfma_f32_16x16x32_bf16 a[80:83], a[180:183], v[160:163], a[80:83]
    s_add_u32 m0, s38, 0x8000
    s_add_u32 s45, s100, 0x88800
    v_exp_f32_e64 v180, v92
    v_mfma_f32_16x16x32_bf16 a[84:87], a[180:183], v[164:167], a[84:87]
    buffer_load_dwordx4 v251, s[16:19], s45 offen sc1 lds
    v_cvt_pk_bf16_f32 v155, v182, v183
    v_add_f32_e64 v199, v176, v177
    v_mfma_f32_16x16x32_bf16 a[88:91], a[180:183], v[168:171], a[88:91]
    v_exp_f32_e64 v181, v93
    v_mfma_f32_16x16x32_bf16 a[92:95], a[180:183], v[172:175], a[92:95]
    s_waitcnt lgkmcnt(8)
    v_exp_f32 v182, v94
    v_mfma_f32_16x16x32_bf16 a[96:99], a[184:187], v[160:163], a[96:99]
    s_add_u32 m0, s38, 0x8400
    s_add_u32 s45, s100, 0x88c00
    v_exp_f32_e64 v183, v95
    v_mfma_f32_16x16x32_bf16 a[100:103], a[184:187], v[164:167], a[100:103]
    buffer_load_dwordx4 v251, s[16:19], s45 offen sc1 lds
    v_cvt_pk_bf16_f32 v156, v176, v177
    v_add_f32 v199, v199, v178
    v_add_f32 v199, v199, v179
    v_mfma_f32_16x16x32_bf16 a[104:107], a[184:187], v[168:171], a[104:107]
    s_add_u32 m0, s27, 0x20800
    s_add_u32 s45, s100, 0x98800
    v_cvt_pk_bf16_f32 v157, v178, v179
    v_add_f32 v199, v199, v180
    v_add_f32 v199, v199, v181
    v_mfma_f32_16x16x32_bf16 a[108:111], a[184:187], v[172:175], a[108:111]
    buffer_load_dwordx4 v251, s[16:19], s45 offen sc1 lds
    v_cvt_pk_bf16_f32 v158, v180, v181
    v_add_f32 v199, v199, v182
    v_add_f32 v199, v199, v183
    v_mfma_f32_16x16x32_bf16 a[112:115], a[188:191], v[160:163], a[112:115]
    s_add_u32 m0, s27, 0x20c00
    s_add_u32 s45, s100, 0x98c00
    v_cvt_pk_bf16_f32 v159, v182, v183
    v_max3_f32 v216, v196, v197, v198
    v_max_f32_e64 v216, v216, v199
    v_mfma_f32_16x16x32_bf16 a[116:119], a[188:191], v[164:167], a[116:119]
    buffer_load_dwordx4 v251, s[16:19], s45 offen sc1 lds
    v_cmp_lt_f32 vcc, v224, v216
    v_add_f32 v193, v193, v201
    v_mfma_f32_16x16x32_bf16 a[120:123], a[188:191], v[168:171], a[120:123]
    v_add_f32 v194, v194, v202
    v_add_f32 v195, v195, v203
    v_mfma_f32_16x16x32_bf16 a[124:127], a[188:191], v[172:175], a[124:127]
    s_cbranch_vccnz RARE_27
BACK_28:
    s_waitcnt lgkmcnt(0)
    v_mfma_f32_16x16x32_bf16 v[64:67], a[128:131], v[0:3], v[128:131]
    v_exp_f32_e64 v176, v96
    v_mfma_f32_16x16x32_bf16 v[64:67], a[132:135], v[4:7], v[64:67]
    ds_read_b64_tr_b16 a[160:161], v208 offset:32768
    v_add_f32_e64 v192, v192, v196
    v_mfma_f32_16x16x32_bf16 v[64:67], a[136:139], v[8:11], v[64:67]
    buffer_load_dwordx4 v[226:229], v251, s[16:19], s20 offen offset:0 sc1
    v_exp_f32_e64 v177, v97
    v_mfma_f32_16x16x32_bf16 v[64:67], a[140:143], v[12:15], v[64:67]
    ds_read_b64_tr_b16 a[162:163], v208 offset:36864
    v_add_f32_e64 v200, v176, v177
    v_mfma_f32_16x16x32_bf16 v[80:83], a[144:147], v[0:3], v[128:131]
    v_exp_f32_e64 v178, v98
    v_mfma_f32_16x16x32_bf16 v[80:83], a[148:151], v[4:7], v[80:83]
    ds_read_b64_tr_b16 a[164:165], v209 offset:32768
    v_cvt_pk_bf16_f32 v160, v176, v177
    v_mfma_f32_16x16x32_bf16 v[80:83], a[152:155], v[8:11], v[80:83]
    buffer_load_dwordx4 v[230:233], v251, s[16:19], s20 offen offset:1024 sc1
    v_exp_f32_e64 v179, v99
    v_mfma_f32_16x16x32_bf16 v[80:83], a[156:159], v[12:15], v[80:83]
    ds_read_b64_tr_b16 a[166:167], v209 offset:36864
    v_add_f32 v200, v200, v178
    v_add_f32 v200, v200, v179
    v_mfma_f32_16x16x32_bf16 v[68:71], a[128:131], v[16:19], v[132:135]
    v_exp_f32_e64 v180, v112
    v_mfma_f32_16x16x32_bf16 v[68:71], a[132:135], v[20:23], v[68:71]
    ds_read_b64_tr_b16 a[168:169], v210 offset:32768
    v_cvt_pk_bf16_f32 v161, v178, v179
    v_mfma_f32_16x16x32_bf16 v[68:71], a[136:139], v[24:27], v[68:71]
    buffer_load_dwordx4 v[234:237], v251, s[16:19], s20 offen offset:2048 sc1
    v_exp_f32_e64 v181, v113
    v_mfma_f32_16x16x32_bf16 v[68:71], a[140:143], v[28:31], v[68:71]
    ds_read_b64_tr_b16 a[170:171], v210 offset:36864
    v_add_f32 v200, v200, v180
    v_add_f32 v200, v200, v181
    v_mfma_f32_16x16x32_bf16 v[84:87], a[144:147], v[16:19], v[132:135]
    v_exp_f32_e64 v182, v114
    v_mfma_f32_16x16x32_bf16 v[84:87], a[148:151], v[20:23], v[84:87]
    ds_read_b64_tr_b16 a[172:173], v211 offset:32768
    v_cvt_pk_bf16_f32 v162, v180, v181
    v_mfma_f32_16x16x32_bf16 v[84:87], a[152:155], v[24:27], v[84:87]
    buffer_load_dwordx4 v[238:241], v251, s[16:19], s20 offen offset:3072 sc1
    v_exp_f32_e64 v183, v115
    v_mfma_f32_16x16x32_bf16 v[84:87], a[156:159], v[28:31], v[84:87]
    ds_read_b64_tr_b16 a[174:175], v211 offset:36864
    v_add_f32 v200, v200, v182
    v_add_f32 v200, v200, v183
    v_mfma_f32_16x16x32_bf16 v[72:75], a[128:131], v[32:35], v[136:139]
    v_exp_f32_e64 v176, v100
    v_mfma_f32_16x16x32_bf16 v[72:75], a[132:135], v[36:39], v[72:75]
    ds_read_b64_tr_b16 a[176:177], v212 offset:32768
    v_cvt_pk_bf16_f32 v163, v182, v183
    v_mfma_f32_16x16x32_bf16 v[72:75], a[136:139], v[40:43], v[72:75]
    buffer_load_dwordx4 v[242:245], v251, s[32:35], s21 offen sc1
    v_exp_f32_e64 v177, v101
    v_mfma_f32_16x16x32_bf16 v[72:75], a[140:143], v[44:47], v[72:75]
    ds_read_b64_tr_b16 a[178:179], v212 offset:36864
    v_add_f32_e64 v201, v176, v177
    v_mfma_f32_16x16x32_bf16 v[88:91], a[144:147], v[32:35], v[136:139]
    v_exp_f32_e64 v178, v102
    v_mfma_f32_16x16x32_bf16 v[88:91], a[148:151], v[36:39], v[88:91]
    ds_read_b64_tr_b16 a[180:181], v213 offset:32768
    v_cvt_pk_bf16_f32 v164, v176, v177
    v_mfma_f32_16x16x32_bf16 v[88:91], a[152:155], v[40:43], v[88:91]
    buffer_load_dwordx4 v[246:249], v251, s[32:35], s22 offen sc1
    v_exp_f32_e64 v179, v103
    v_mfma_f32_16x16x32_bf16 v[88:91], a[156:159], v[44:47], v[88:91]
    ds_read_b64_tr_b16 a[182:183], v213 offset:36864
    v_add_f32 v201, v201, v178
    v_add_f32 v201, v201, v179
    v_mfma_f32_16x16x32_bf16 v[76:79], a[128:131], v[48:51], v[140:143]
    v_exp_f32_e64 v180, v116
    v_mfma_f32_16x16x32_bf16 v[76:79], a[132:135], v[52:55], v[76:79]
    ds_read_b64_tr_b16 a[184:185], v214 offset:32768
    v_cvt_pk_bf16_f32 v165, v178, v179
    v_mfma_f32_16x16x32_bf16 v[76:79], a[136:139], v[56:59], v[76:79]
    buffer_load_dwordx4 v[184:187], v251, s[32:35], s23 offen sc1
    v_exp_f32_e64 v181, v117
    v_mfma_f32_16x16x32_bf16 v[76:79], a[140:143], v[60:63], v[76:79]
    ds_read_b64_tr_b16 a[186:187], v214 offset:36864
    v_add_f32 v201, v201, v180
    v_add_f32 v201, v201, v181
    v_mfma_f32_16x16x32_bf16 v[92:95], a[144:147], v[48:51], v[140:143]
    v_exp_f32_e64 v182, v118
    v_mfma_f32_16x16x32_bf16 v[92:95], a[148:151], v[52:55], v[92:95]
    ds_read_b64_tr_b16 a[188:189], v215 offset:32768
    v_cvt_pk_bf16_f32 v166, v180, v181
    v_mfma_f32_16x16x32_bf16 v[92:95], a[152:155], v[56:59], v[92:95]
    s_waitcnt lgkmcnt(3)
    s_nop 0
    buffer_load_dwordx4 v[188:191], v251, s[32:35], s24 offen sc1
    v_exp_f32_e64 v183, v119
    v_mfma_f32_16x16x32_bf16 v[92:95], a[156:159], v[60:63], v[92:95]
    ds_read_b64_tr_b16 a[190:191], v215 offset:36864
    v_add_f32 v201, v201, v182
    v_add_f32 v201, v201, v183
    v_mfma_f32_16x16x32_bf16 a[0:3], a[160:163], v[144:147], a[0:3]
    v_exp_f32_e64 v176, v104
    v_mfma_f32_16x16x32_bf16 a[4:7], a[160:163], v[148:151], a[4:7]
    ds_read_b128 a[128:131], v204 offset:57344
    v_cvt_pk_bf16_f32 v167, v182, v183
    v_mfma_f32_16x16x32_bf16 a[8:11], a[160:163], v[152:155], a[8:11]
    s_add_u32 s20, s20, s25
    v_exp_f32 v177, v105
    v_mfma_f32_16x16x32_bf16 a[12:15], a[160:163], v[156:159], a[12:15]
    s_add_u32 s21, s21, s26
    s_nop 0
    ds_read_b128 a[132:135], v205 offset:57344
    v_add_f32_e64 v202, v176, v177
    v_mfma_f32_16x16x32_bf16 a[16:19], a[164:167], v[144:147], a[16:19]
    s_add_u32 s22, s22, s26
    v_exp_f32 v178, v106
    v_mfma_f32_16x16x32_bf16 a[20:23], a[164:167], v[148:151], a[20:23]
    s_add_u32 s23, s23, s26
    s_nop 0
    ds_read_b128 a[136:139], v206 offset:57344
    v_cvt_pk_bf16_f32 v168, v176, v177
    v_mfma_f32_16x16x32_bf16 a[24:27], a[164:167], v[152:155], a[24:27]
    s_add_u32 s24, s24, s26
    v_exp_f32 v179, v107
    v_mfma_f32_16x16x32_bf16 a[28:31], a[164:167], v[156:159], a[28:31]
    ds_read_b128 a[140:143], v207 offset:57344
    v_add_f32 v202, v202, v178
    v_add_f32 v202, v202, v179
    v_mfma_f32_16x16x32_bf16 a[32:35], a[168:171], v[144:147], a[32:35]
    v_exp_f32_e64 v180, v120
    v_mfma_f32_16x16x32_bf16 a[36:39], a[168:171], v[148:151], a[36:39]
    ds_read_b128 a[144:147], v204 offset:61440
    v_cvt_pk_bf16_f32 v169, v178, v179
    v_mfma_f32_16x16x32_bf16 a[40:43], a[168:171], v[152:155], a[40:43]
    v_exp_f32_e64 v181, v121
    v_mfma_f32_16x16x32_bf16 a[44:47], a[168:171], v[156:159], a[44:47]
    ds_read_b128 a[148:151], v205 offset:61440
    v_add_f32 v202, v202, v180
    v_add_f32 v202, v202, v181
    v_mfma_f32_16x16x32_bf16 a[48:51], a[172:175], v[144:147], a[48:51]
    v_exp_f32_e64 v182, v122
    v_mfma_f32_16x16x32_bf16 a[52:55], a[172:175], v[148:151], a[52:55]
    ds_read_b128 a[152:155], v206 offset:61440
    v_cvt_pk_bf16_f32 v170, v180, v181
    v_mfma_f32_16x16x32_bf16 a[56:59], a[172:175], v[152:155], a[56:59]
    v_exp_f32_e64 v183, v123
    v_mfma_f32_16x16x32_bf16 a[60:63], a[172:175], v[156:159], a[60:63]
    v_exp_f32_e64 v176, v108
    v_mfma_f32_16x16x32_bf16 a[64:67], a[176:179], v[144:147], a[64:67]
    v_exp_f32_e64 v177, v109
    v_mfma_f32_16x16x32_bf16 a[68:71], a[176:179], v[148:151], a[68:71]
    ds_read_b128 a[156:159], v207 offset:61440
    v_add_f32 v202, v202, v182
    v_add_f32 v202, v202, v183
    v_mfma_f32_16x16x32_bf16 a[72:75], a[176:179], v[152:155], a[72:75]
    v_exp_f32_e64 v178, v110
    v_mfma_f32_16x16x32_bf16 a[76:79], a[176:179], v[156:159], a[76:79]
    v_exp_f32_e64 v179, v111
    v_mfma_f32_16x16x32_bf16 a[80:83], a[180:183], v[144:147], a[80:83]
    s_add_u32 m0, s38, 0xa000
    s_add_u32 s45, s100, 0x90000
    v_exp_f32_e64 v180, v124
    v_mfma_f32_16x16x32_bf16 a[84:87], a[180:183], v[148:151], a[84:87]
    buffer_load_dwordx4 v251, s[16:19], s45 offen sc1 lds
    v_cvt_pk_bf16_f32 v171, v182, v183
    v_add_f32_e64 v203, v176, v177
    v_mfma_f32_16x16x32_bf16 a[88:91], a[180:183], v[152:155], a[88:91]
    v_exp_f32_e64 v181, v125
    v_mfma_f32_16x16x32_bf16 a[92:95], a[180:183], v[156:159], a[92:95]
    s_waitcnt lgkmcnt(8)
    v_exp_f32 v182, v126
    v_mfma_f32_16x16x32_bf16 a[96:99], a[184:187], v[144:147], a[96:99]
    s_add_u32 m0, s38, 0xa400
    s_add_u32 s45, s100, 0x90400
    v_exp_f32_e64 v183, v127
    v_mfma_f32_16x16x32_bf16 a[100:103], a[184:187], v[148:151], a[100:103]
    buffer_load_dwordx4 v251, s[16:19], s45 offen sc1 lds
    v_cvt_pk_bf16_f32 v172, v176, v177
    v_add_f32 v203, v203, v178
    v_add_f32 v203, v203, v179
    v_mfma_f32_16x16x32_bf16 a[104:107], a[184:187], v[152:155], a[104:107]
    s_add_u32 m0, s27, 0x21000
    s_add_u32 s45, s100, 0xa0000
    v_cvt_pk_bf16_f32 v173, v178, v179
    v_add_f32 v203, v203, v180
    v_add_f32 v203, v203, v181
    v_mfma_f32_16x16x32_bf16 a[108:111], a[184:187], v[156:159], a[108:111]
    buffer_load_dwordx4 v251, s[16:19], s45 offen sc1 lds
    v_cvt_pk_bf16_f32 v174, v180, v181
    v_add_f32 v203, v203, v182
    v_add_f32 v203, v203, v183
    v_mfma_f32_16x16x32_bf16 a[112:115], a[188:191], v[144:147], a[112:115]
    s_add_u32 m0, s27, 0x21400
    s_add_u32 s45, s100, 0xa0400
    v_cvt_pk_bf16_f32 v175, v182, v183
    v_max3_f32 v216, v200, v201, v202
    v_max_f32_e64 v216, v216, v203
    v_mfma_f32_16x16x32_bf16 a[116:119], a[188:191], v[148:151], a[116:119]
    buffer_load_dwordx4 v251, s[16:19], s45 offen sc1 lds
    v_cmp_lt_f32 vcc, v224, v216
    v_add_f32 v193, v193, v197
    v_mfma_f32_16x16x32_bf16 a[120:123], a[188:191], v[152:155], a[120:123]
    v_add_f32 v194, v194, v198
    v_add_f32 v195, v195, v199
    v_mfma_f32_16x16x32_bf16 a[124:127], a[188:191], v[156:159], a[124:127]
    s_cbranch_vccnz RARE_29
BACK_30:
    s_waitcnt vmcnt(12) lgkmcnt(0)
    s_barrier
    s_nop 0
    v_mfma_f32_16x16x32_bf16 v[96:99], a[128:131], v[0:3], v[128:131]
    v_exp_f32_e64 v176, v64
    v_mfma_f32_16x16x32_bf16 v[96:99], a[132:135], v[4:7], v[96:99]
    ds_read_b64_tr_b16 a[160:161], v208 offset:40960
    v_add_f32_e64 v192, v192, v200
    v_mfma_f32_16x16x32_bf16 v[96:99], a[136:139], v[8:11], v[96:99]
    v_exp_f32_e64 v177, v65
    v_mfma_f32_16x16x32_bf16 v[96:99], a[140:143], v[12:15], v[96:99]
    ds_read_b64_tr_b16 a[162:163], v208 offset:45056
    v_add_f32_e64 v196, v176, v177
    v_mfma_f32_16x16x32_bf16 v[112:115], a[144:147], v[0:3], v[128:131]
    v_exp_f32_e64 v178, v66
    v_mfma_f32_16x16x32_bf16 v[112:115], a[148:151], v[4:7], v[112:115]
    ds_read_b64_tr_b16 a[164:165], v209 offset:40960
    v_cvt_pk_bf16_f32 v144, v176, v177
    v_mfma_f32_16x16x32_bf16 v[112:115], a[152:155], v[8:11], v[112:115]
    v_exp_f32_e64 v179, v67
    v_mfma_f32_16x16x32_bf16 v[112:115], a[156:159], v[12:15], v[112:115]
    ds_read_b64_tr_b16 a[166:167], v209 offset:45056
    v_add_f32 v196, v196, v178
    v_add_f32 v196, v196, v179
    v_mfma_f32_16x16x32_bf16 v[100:103], a[128:131], v[16:19], v[132:135]
    v_exp_f32_e64 v180, v80
    v_mfma_f32_16x16x32_bf16 v[100:103], a[132:135], v[20:23], v[100:103]
    ds_read_b64_tr_b16 a[168:169], v210 offset:40960
    v_cvt_pk_bf16_f32 v145, v178, v179
    v_mfma_f32_16x16x32_bf16 v[100:103], a[136:139], v[24:27], v[100:103]
    v_exp_f32_e64 v181, v81
    v_mfma_f32_16x16x32_bf16 v[100:103], a[140:143], v[28:31], v[100:103]
    ds_read_b64_tr_b16 a[170:171], v210 offset:45056
    v_add_f32 v196, v196, v180
    v_add_f32 v196, v196, v181
    v_mfma_f32_16x16x32_bf16 v[116:119], a[144:147], v[16:19], v[132:135]
    v_exp_f32_e64 v182, v82
    v_mfma_f32_16x16x32_bf16 v[116:119], a[148:151], v[20:23], v[116:119]
    ds_read_b64_tr_b16 a[172:173], v211 offset:40960
    v_cvt_pk_bf16_f32 v146, v180, v181
    v_mfma_f32_16x16x32_bf16 v[116:119], a[152:155], v[24:27], v[116:119]
    v_exp_f32_e64 v183, v83
    v_mfma_f32_16x16x32_bf16 v[116:119], a[156:159], v[28:31], v[116:119]
    ds_read_b64_tr_b16 a[174:175], v211 offset:45056
    v_add_f32 v196, v196, v182
    v_add_f32 v196, v196, v183
    v_mfma_f32_16x16x32_bf16 v[104:107], a[128:131], v[32:35], v[136:139]
    v_exp_f32_e64 v176, v68
    v_mfma_f32_16x16x32_bf16 v[104:107], a[132:135], v[36:39], v[104:107]
    ds_read_b64_tr_b16 a[176:177], v212 offset:40960
    v_cvt_pk_bf16_f32 v147, v182, v183
    v_mfma_f32_16x16x32_bf16 v[104:107], a[136:139], v[40:43], v[104:107]
    v_exp_f32_e64 v177, v69
    v_mfma_f32_16x16x32_bf16 v[104:107], a[140:143], v[44:47], v[104:107]
    ds_read_b64_tr_b16 a[178:179], v212 offset:45056
    v_add_f32_e64 v197, v176, v177
    v_mfma_f32_16x16x32_bf16 v[120:123], a[144:147], v[32:35], v[136:139]
    v_exp_f32_e64 v178, v70
    v_mfma_f32_16x16x32_bf16 v[120:123], a[148:151], v[36:39], v[120:123]
    ds_read_b64_tr_b16 a[180:181], v213 offset:40960
    v_cvt_pk_bf16_f32 v148, v176, v177
    v_mfma_f32_16x16x32_bf16 v[120:123], a[152:155], v[40:43], v[120:123]
    v_exp_f32_e64 v179, v71
    v_mfma_f32_16x16x32_bf16 v[120:123], a[156:159], v[44:47], v[120:123]
    ds_read_b64_tr_b16 a[182:183], v213 offset:45056
    v_add_f32 v197, v197, v178
    v_add_f32 v197, v197, v179
    v_mfma_f32_16x16x32_bf16 v[108:111], a[128:131], v[48:51], v[140:143]
    v_exp_f32_e64 v180, v84
    v_mfma_f32_16x16x32_bf16 v[108:111], a[132:135], v[52:55], v[108:111]
    ds_read_b64_tr_b16 a[184:185], v214 offset:40960
    v_cvt_pk_bf16_f32 v149, v178, v179
    v_mfma_f32_16x16x32_bf16 v[108:111], a[136:139], v[56:59], v[108:111]
    v_exp_f32_e64 v181, v85
    v_mfma_f32_16x16x32_bf16 v[108:111], a[140:143], v[60:63], v[108:111]
    ds_read_b64_tr_b16 a[186:187], v214 offset:45056
    v_add_f32 v197, v197, v180
    v_add_f32 v197, v197, v181
    v_mfma_f32_16x16x32_bf16 v[124:127], a[144:147], v[48:51], v[140:143]
    v_exp_f32_e64 v182, v86
    v_mfma_f32_16x16x32_bf16 v[124:127], a[148:151], v[52:55], v[124:127]
    ds_read_b64_tr_b16 a[188:189], v215 offset:40960
    v_cvt_pk_bf16_f32 v150, v180, v181
    v_mfma_f32_16x16x32_bf16 v[124:127], a[152:155], v[56:59], v[124:127]
    s_waitcnt lgkmcnt(3)
    v_exp_f32 v183, v87
    v_mfma_f32_16x16x32_bf16 v[124:127], a[156:159], v[60:63], v[124:127]
    ds_read_b64_tr_b16 a[190:191], v215 offset:45056
    v_add_f32 v197, v197, v182
    v_add_f32 v197, v197, v183
    v_mfma_f32_16x16x32_bf16 a[0:3], a[160:163], v[160:163], a[0:3]
    s_add_u32 s101, s100, 0x0
    v_exp_f32 v176, v72
    v_mfma_f32_16x16x32_bf16 a[4:7], a[160:163], v[164:167], a[4:7]
    buffer_load_dwordx4 v[0:3], v251, s[16:19], s101 offen offset:0 sc1
    v_cvt_pk_bf16_f32 v151, v182, v183
    v_mfma_f32_16x16x32_bf16 a[8:11], a[160:163], v[168:171], a[8:11]
    v_exp_f32_e64 v177, v73
    v_mfma_f32_16x16x32_bf16 a[12:15], a[160:163], v[172:175], a[12:15]
    buffer_load_dwordx4 v[4:7], v251, s[16:19], s101 offen offset:1024 sc1
    v_add_f32_e64 v198, v176, v177
    v_mfma_f32_16x16x32_bf16 a[16:19], a[164:167], v[160:163], a[16:19]
    v_exp_f32_e64 v178, v74
    v_mfma_f32_16x16x32_bf16 a[20:23], a[164:167], v[164:167], a[20:23]
    buffer_load_dwordx4 v[8:11], v251, s[16:19], s101 offen offset:2048 sc1
    v_cvt_pk_bf16_f32 v152, v176, v177
    v_mfma_f32_16x16x32_bf16 a[24:27], a[164:167], v[168:171], a[24:27]
    v_exp_f32_e64 v179, v75
    v_mfma_f32_16x16x32_bf16 a[28:31], a[164:167], v[172:175], a[28:31]
    buffer_load_dwordx4 v[12:15], v251, s[16:19], s101 offen offset:3072 sc1
    v_add_f32 v198, v198, v178
    v_add_f32 v198, v198, v179
    v_mfma_f32_16x16x32_bf16 a[32:35], a[168:171], v[160:163], a[32:35]
    s_add_u32 s101, s100, 0x8000
    v_exp_f32_e64 v180, v88
    v_mfma_f32_16x16x32_bf16 a[36:39], a[168:171], v[164:167], a[36:39]
    buffer_load_dwordx4 v[16:19], v251, s[16:19], s101 offen offset:0 sc1
    v_cvt_pk_bf16_f32 v153, v178, v179
    v_mfma_f32_16x16x32_bf16 a[40:43], a[168:171], v[168:171], a[40:43]
    v_exp_f32_e64 v181, v89
    v_mfma_f32_16x16x32_bf16 a[44:47], a[168:171], v[172:175], a[44:47]
    buffer_load_dwordx4 v[20:23], v251, s[16:19], s101 offen offset:1024 sc1
    v_add_f32 v198, v198, v180
    v_add_f32 v198, v198, v181
    v_mfma_f32_16x16x32_bf16 a[48:51], a[172:175], v[160:163], a[48:51]
    v_exp_f32_e64 v182, v90
    v_mfma_f32_16x16x32_bf16 a[52:55], a[172:175], v[164:167], a[52:55]
    buffer_load_dwordx4 v[24:27], v251, s[16:19], s101 offen offset:2048 sc1
    v_cvt_pk_bf16_f32 v154, v180, v181
    v_mfma_f32_16x16x32_bf16 a[56:59], a[172:175], v[168:171], a[56:59]
    v_exp_f32_e64 v183, v91
    v_mfma_f32_16x16x32_bf16 a[60:63], a[172:175], v[172:175], a[60:63]
    v_exp_f32_e64 v176, v76
    v_mfma_f32_16x16x32_bf16 a[64:67], a[176:179], v[160:163], a[64:67]
    v_exp_f32_e64 v177, v77
    v_mfma_f32_16x16x32_bf16 a[68:71], a[176:179], v[164:167], a[68:71]
    buffer_load_dwordx4 v[28:31], v251, s[16:19], s101 offen offset:3072 sc1
    v_add_f32 v198, v198, v182
    v_add_f32 v198, v198, v183
    v_mfma_f32_16x16x32_bf16 a[72:75], a[176:179], v[168:171], a[72:75]
    v_exp_f32_e64 v178, v78
    v_mfma_f32_16x16x32_bf16 a[76:79], a[176:179], v[172:175], a[76:79]
    v_exp_f32_e64 v179, v79
    v_mfma_f32_16x16x32_bf16 a[80:83], a[180:183], v[160:163], a[80:83]
    s_add_u32 m0, s38, 0xc000
    s_add_u32 s45, s100, 0x90800
    v_exp_f32_e64 v180, v92
    v_mfma_f32_16x16x32_bf16 a[84:87], a[180:183], v[164:167], a[84:87]
    buffer_load_dwordx4 v251, s[16:19], s45 offen sc1 lds
    v_cvt_pk_bf16_f32 v155, v182, v183
    v_add_f32_e64 v199, v176, v177
    v_mfma_f32_16x16x32_bf16 a[88:91], a[180:183], v[168:171], a[88:91]
    v_exp_f32_e64 v181, v93
    v_mfma_f32_16x16x32_bf16 a[92:95], a[180:183], v[172:175], a[92:95]
    s_waitcnt lgkmcnt(8)
    v_exp_f32 v182, v94
    v_mfma_f32_16x16x32_bf16 a[96:99], a[184:187], v[160:163], a[96:99]
    s_add_u32 m0, s38, 0xc400
    s_add_u32 s45, s100, 0x90c00
    v_exp_f32_e64 v183, v95
    v_mfma_f32_16x16x32_bf16 a[100:103], a[184:187], v[164:167], a[100:103]
    buffer_load_dwordx4 v251, s[16:19], s45 offen sc1 lds
    v_cvt_pk_bf16_f32 v156, v176, v177
    v_add_f32 v199, v199, v178
    v_add_f32 v199, v199, v179
    v_mfma_f32_16x16x32_bf16 a[104:107], a[184:187], v[168:171], a[104:107]
    s_add_u32 m0, s27, 0x21800
    s_add_u32 s45, s100, 0xa0800
    v_cvt_pk_bf16_f32 v157, v178, v179
    v_add_f32 v199, v199, v180
    v_add_f32 v199, v199, v181
    v_mfma_f32_16x16x32_bf16 a[108:111], a[184:187], v[172:175], a[108:111]
    buffer_load_dwordx4 v251, s[16:19], s45 offen sc1 lds
    v_cvt_pk_bf16_f32 v158, v180, v181
    v_add_f32 v199, v199, v182
    v_add_f32 v199, v199, v183
    v_mfma_f32_16x16x32_bf16 a[112:115], a[188:191], v[160:163], a[112:115]
    s_add_u32 m0, s27, 0x21c00
    s_add_u32 s45, s100, 0xa0c00
    v_cvt_pk_bf16_f32 v159, v182, v183
    v_max3_f32 v216, v196, v197, v198
    v_max_f32_e64 v216, v216, v199
    v_mfma_f32_16x16x32_bf16 a[116:119], a[188:191], v[164:167], a[116:119]
    buffer_load_dwordx4 v251, s[16:19], s45 offen sc1 lds
    v_cmp_lt_f32 vcc, v224, v216
    v_add_f32 v193, v193, v201
    v_mfma_f32_16x16x32_bf16 a[120:123], a[188:191], v[168:171], a[120:123]
    v_add_f32 v194, v194, v202
    v_add_f32 v195, v195, v203
    v_mfma_f32_16x16x32_bf16 a[124:127], a[188:191], v[172:175], a[124:127]
    s_cbranch_vccnz RARE_31
BACK_32:
    s_waitcnt lgkmcnt(0)
    s_waitcnt vmcnt(16)
    v_exp_f32 v176, v96
    s_add_u32 s101, s100, 0x10000
    ds_read_b64_tr_b16 a[160:161], v208 offset:49152
    v_add_f32_e64 v192, v192, v196
    buffer_load_dwordx4 v[32:35], v251, s[16:19], s101 offen offset:0 sc1
    v_exp_f32_e64 v177, v97
    ds_read_b64_tr_b16 a[162:163], v208 offset:53248
    v_add_f32_e64 v200, v176, v177
    v_mfma_f32_16x16x32_bf16 a[192:195], v[226:229], v[242:245], a[192:195]
    v_cvt_pk_bf16_f32 v160, v176, v177
    v_add_f32 v193, v193, v197
    v_exp_f32 v178, v98
    ds_read_b64_tr_b16 a[164:165], v209 offset:49152
    v_add_f32_e64 v200, v200, v178
    buffer_load_dwordx4 v[36:39], v251, s[16:19], s101 offen offset:1024 sc1
    v_exp_f32_e64 v179, v99
    ds_read_b64_tr_b16 a[166:167], v209 offset:53248
    v_add_f32_e64 v200, v200, v179
    v_mfma_f32_16x16x32_bf16 a[196:199], v[226:229], v[246:249], a[196:199]
    v_cvt_pk_bf16_f32 v161, v178, v179
    v_add_f32 v194, v194, v198
    v_exp_f32 v180, v112
    ds_read_b64_tr_b16 a[168:169], v210 offset:49152
    v_add_f32_e64 v200, v200, v180
    buffer_load_dwordx4 v[40:43], v251, s[16:19], s101 offen offset:2048 sc1
    v_exp_f32_e64 v181, v113
    ds_read_b64_tr_b16 a[170:171], v210 offset:53248
    v_add_f32_e64 v200, v200, v181
    v_mfma_f32_16x16x32_bf16 a[200:203], v[226:229], v[184:187], a[200:203]
    v_cvt_pk_bf16_f32 v162, v180, v181
    v_add_f32 v195, v195, v199
    v_exp_f32 v182, v114
    ds_read_b64_tr_b16 a[172:173], v211 offset:49152
    v_add_f32_e64 v200, v200, v182
    buffer_load_dwordx4 v[44:47], v251, s[16:19], s101 offen offset:3072 sc1
    v_exp_f32_e64 v183, v115
    ds_read_b64_tr_b16 a[174:175], v211 offset:53248
    v_add_f32_e64 v200, v200, v183
    v_mfma_f32_16x16x32_bf16 a[204:207], v[226:229], v[188:191], a[204:207]
    v_cvt_pk_bf16_f32 v163, v182, v183
    v_exp_f32_e64 v176, v100
    s_add_u32 s101, s100, 0x18000
    ds_read_b64_tr_b16 a[176:177], v212 offset:49152
    buffer_load_dwordx4 v[48:51], v251, s[16:19], s101 offen offset:0 sc1
    v_exp_f32_e64 v177, v101
    ds_read_b64_tr_b16 a[178:179], v212 offset:53248
    v_add_f32_e64 v201, v176, v177
    v_mfma_f32_16x16x32_bf16 a[208:211], v[230:233], v[242:245], a[208:211]
    v_cvt_pk_bf16_f32 v164, v176, v177
    v_exp_f32_e64 v178, v102
    ds_read_b64_tr_b16 a[180:181], v213 offset:49152
    v_add_f32_e64 v201, v201, v178
    buffer_load_dwordx4 v[52:55], v251, s[16:19], s101 offen offset:1024 sc1
    v_exp_f32_e64 v179, v103
    ds_read_b64_tr_b16 a[182:183], v213 offset:53248
    v_add_f32_e64 v201, v201, v179
    v_mfma_f32_16x16x32_bf16 a[212:215], v[230:233], v[246:249], a[212:215]
    v_cvt_pk_bf16_f32 v165, v178, v179
    v_exp_f32_e64 v180, v116
    ds_read_b64_tr_b16 a[184:185], v214 offset:49152
    v_add_f32_e64 v201, v201, v180
    buffer_load_dwordx4 v[56:59], v251, s[16:19], s101 offen offset:2048 sc1
    v_exp_f32_e64 v181, v117
    ds_read_b64_tr_b16 a[186:187], v214 offset:53248
    v_add_f32_e64 v201, v201, v181
    v_mfma_f32_16x16x32_bf16 a[216:219], v[230:233], v[184:187], a[216:219]
    v_cvt_pk_bf16_f32 v166, v180, v181
    v_exp_f32_e64 v182, v118
    ds_read_b64_tr_b16 a[188:189], v215 offset:49152
    v_add_f32 v201, v201, v182
    s_waitcnt lgkmcnt(3)
    buffer_load_dwordx4 v[60:63], v251, s[16:19], s101 offen offset:3072 sc1
    v_exp_f32_e64 v183, v119
    ds_read_b64_tr_b16 a[190:191], v215 offset:53248
    v_add_f32_e64 v201, v201, v183
    v_mfma_f32_16x16x32_bf16 a[220:223], v[230:233], v[188:191], a[220:223]
    v_cvt_pk_bf16_f32 v167, v182, v183
    v_mfma_f32_16x16x32_bf16 a[0:3], a[160:163], v[144:147], a[0:3]
    v_exp_f32_e64 v176, v104
    v_mfma_f32_16x16x32_bf16 a[4:7], a[160:163], v[148:151], a[4:7]
    v_mfma_f32_16x16x32_bf16 a[8:11], a[160:163], v[152:155], a[8:11]
    v_exp_f32_e64 v177, v105
    v_mfma_f32_16x16x32_bf16 a[12:15], a[160:163], v[156:159], a[12:15]
    ds_read_b64_tr_b16 a[160:161], v208 offset:57344
    v_add_f32_e64 v202, v176, v177
    v_mfma_f32_16x16x32_bf16 a[224:227], v[234:237], v[242:245], a[224:227]
    ds_read_b64_tr_b16 a[162:163], v208 offset:61440
    v_cvt_pk_bf16_f32 v168, v176, v177
    v_mfma_f32_16x16x32_bf16 a[16:19], a[164:167], v[144:147], a[16:19]
    v_exp_f32_e64 v178, v106
    v_mfma_f32_16x16x32_bf16 a[20:23], a[164:167], v[148:151], a[20:23]
    v_add_f32_e64 v202, v202, v178
    v_mfma_f32_16x16x32_bf16 a[24:27], a[164:167], v[152:155], a[24:27]
    v_exp_f32_e64 v179, v107
    v_mfma_f32_16x16x32_bf16 a[28:31], a[164:167], v[156:159], a[28:31]
    ds_read_b64_tr_b16 a[164:165], v209 offset:57344
    v_add_f32_e64 v202, v202, v179
    v_mfma_f32_16x16x32_bf16 a[228:231], v[234:237], v[246:249], a[228:231]
    ds_read_b64_tr_b16 a[166:167], v209 offset:61440
    v_cvt_pk_bf16_f32 v169, v178, v179
    v_mfma_f32_16x16x32_bf16 a[32:35], a[168:171], v[144:147], a[32:35]
    v_exp_f32_e64 v180, v120
    v_mfma_f32_16x16x32_bf16 a[36:39], a[168:171], v[148:151], a[36:39]
    v_add_f32_e64 v202, v202, v180
    v_mfma_f32_16x16x32_bf16 a[40:43], a[168:171], v[152:155], a[40:43]
    v_exp_f32_e64 v181, v121
    v_mfma_f32_16x16x32_bf16 a[44:47], a[168:171], v[156:159], a[44:47]
    ds_read_b64_tr_b16 a[168:169], v210 offset:57344
    v_add_f32_e64 v202, v202, v181
    v_mfma_f32_16x16x32_bf16 a[232:235], v[234:237], v[184:187], a[232:235]
    ds_read_b64_tr_b16 a[170:171], v210 offset:61440
    v_cvt_pk_bf16_f32 v170, v180, v181
    v_mfma_f32_16x16x32_bf16 a[48:51], a[172:175], v[144:147], a[48:51]
    v_exp_f32_e64 v182, v122
    v_mfma_f32_16x16x32_bf16 a[52:55], a[172:175], v[148:151], a[52:55]
    v_add_f32_e64 v202, v202, v182
    v_mfma_f32_16x16x32_bf16 a[56:59], a[172:175], v[152:155], a[56:59]
    v_exp_f32_e64 v183, v123
    v_mfma_f32_16x16x32_bf16 a[60:63], a[172:175], v[156:159], a[60:63]
    ds_read_b64_tr_b16 a[172:173], v211 offset:57344
    v_exp_f32_e64 v176, v108
    v_mfma_f32_16x16x32_bf16 a[236:239], v[234:237], v[188:191], a[236:239]
    ds_read_b64_tr_b16 a[174:175], v211 offset:61440
    v_add_f32_e64 v202, v202, v183
    v_mfma_f32_16x16x32_bf16 a[64:67], a[176:179], v[144:147], a[64:67]
    v_exp_f32_e64 v177, v109
    v_mfma_f32_16x16x32_bf16 a[68:71], a[176:179], v[148:151], a[68:71]
    v_cvt_pk_bf16_f32 v171, v182, v183
    v_add_f32_e64 v203, v176, v177
    v_cvt_pk_bf16_f32 v172, v176, v177
    v_mfma_f32_16x16x32_bf16 a[72:75], a[176:179], v[152:155], a[72:75]
    v_exp_f32_e64 v178, v110
    v_mfma_f32_16x16x32_bf16 a[76:79], a[176:179], v[156:159], a[76:79]
    ds_read_b64_tr_b16 a[176:177], v212 offset:57344
    v_exp_f32_e64 v179, v111
    v_mfma_f32_16x16x32_bf16 a[240:243], v[238:241], v[242:245], a[240:243]
    ds_read_b64_tr_b16 a[178:179], v212 offset:61440
    v_add_f32 v203, v203, v178
    v_add_f32 v203, v203, v179
    v_mfma_f32_16x16x32_bf16 a[80:83], a[180:183], v[144:147], a[80:83]
    v_exp_f32_e64 v180, v124
    v_mfma_f32_16x16x32_bf16 a[84:87], a[180:183], v[148:151], a[84:87]
    v_cvt_pk_bf16_f32 v173, v178, v179
    v_add_f32_e64 v203, v203, v180
    v_mfma_f32_16x16x32_bf16 a[88:91], a[180:183], v[152:155], a[88:91]
    v_exp_f32_e64 v181, v125
    v_mfma_f32_16x16x32_bf16 a[92:95], a[180:183], v[156:159], a[92:95]
    s_waitcnt lgkmcnt(8)
    s_nop 0
    ds_read_b64_tr_b16 a[180:181], v213 offset:57344
    v_exp_f32_e64 v182, v126
    v_mfma_f32_16x16x32_bf16 a[244:247], v[238:241], v[246:249], a[244:247]
    ds_read_b64_tr_b16 a[182:183], v213 offset:61440
    v_add_f32_e64 v203, v203, v181
    v_cvt_pk_bf16_f32 v174, v180, v181
    v_mfma_f32_16x16x32_bf16 a[96:99], a[184:187], v[144:147], a[96:99]
    v_exp_f32_e64 v183, v127
    v_mfma_f32_16x16x32_bf16 a[100:103], a[184:187], v[148:151], a[100:103]
    v_add_f32 v203, v203, v182
    v_add_f32 v203, v203, v183
    v_cvt_pk_bf16_f32 v175, v182, v183
    v_mfma_f32_16x16x32_bf16 a[104:107], a[184:187], v[152:155], a[104:107]
    v_max3_f32 v216, v200, v201, v202
    v_max_f32 v216, v216, v203
    v_cmp_lt_f32 vcc, v224, v216
    v_mfma_f32_16x16x32_bf16 a[108:111], a[184:187], v[156:159], a[108:111]
    ds_read_b64_tr_b16 a[184:185], v214 offset:57344
    v_mfma_f32_16x16x32_bf16 a[248:251], v[238:241], v[184:187], a[248:251]
    ds_read_b64_tr_b16 a[186:187], v214 offset:61440
    v_mfma_f32_16x16x32_bf16 a[112:115], a[188:191], v[144:147], a[112:115]
    v_mfma_f32_16x16x32_bf16 a[116:119], a[188:191], v[148:151], a[116:119]
    v_mfma_f32_16x16x32_bf16 a[120:123], a[188:191], v[152:155], a[120:123]
    v_mfma_f32_16x16x32_bf16 a[124:127], a[188:191], v[156:159], a[124:127]
    ds_read_b64_tr_b16 a[188:189], v215 offset:57344
    v_mfma_f32_16x16x32_bf16 a[252:255], v[238:241], v[188:191], a[252:255]
    ds_read_b64_tr_b16 a[190:191], v215 offset:61440
    s_cbranch_vccnz RARE_33
BACK_34:
    s_waitcnt vmcnt(28) lgkmcnt(0)
    s_barrier
    s_lshl_b32 s44, s43, 4
    s_lshl_b32 s45, s36, 2
    s_add_u32 s44, s44, s45
    s_mul_i32 s44, s44, 184
    s_lshl_b32 s45, s42, 2
    s_add_u32 s44, s44, s45
    s_lshl_b32 s44, s44, 10
    s_nop 0
    v_mfma_f32_16x16x32_bf16 a[0:3], a[160:163], v[160:163], a[0:3]
    v_add_f32 v192, v192, v200
    v_add_f32 v193, v193, v201
    v_add_f32 v194, v194, v202
    v_add_f32 v195, v195, v203
    v_mfma_f32_16x16x32_bf16 a[16:19], a[164:167], v[160:163], a[16:19]
    v_mov_b32 v216, v192
    v_mov_b32 v217, v193
    v_mov_b32 v218, v194
    v_mov_b32 v219, v195
    v_mfma_f32_16x16x32_bf16 a[32:35], a[168:171], v[160:163], a[32:35]
    v_permlane32_swap_b32 v192, v216
    v_permlane32_swap_b32 v193, v217
    v_permlane32_swap_b32 v194, v218
    v_permlane32_swap_b32 v195, v219
    v_mfma_f32_16x16x32_bf16 a[48:51], a[172:175], v[160:163], a[48:51]
    v_add_f32 v192, v192, v216
    v_add_f32 v193, v193, v217
    v_add_f32 v194, v194, v218
    v_add_f32 v195, v195, v219
    v_mfma_f32_16x16x32_bf16 a[64:67], a[176:179], v[160:163], a[64:67]
    v_mov_b32 v216, v192
    v_mov_b32 v217, v193
    v_mov_b32 v218, v194
    v_mov_b32 v219, v195
    v_mfma_f32_16x16x32_bf16 a[80:83], a[180:183], v[160:163], a[80:83]
    v_permlane16_swap_b32 v192, v216
    v_permlane16_swap_b32 v193, v217
    v_permlane16_swap_b32 v194, v218
    v_permlane16_swap_b32 v195, v219
    v_mfma_f32_16x16x32_bf16 a[96:99], a[184:187], v[160:163], a[96:99]
    v_add_f32 v192, v192, v216
    v_add_f32 v193, v193, v217
    v_add_f32 v194, v194, v218
    v_add_f32 v195, v195, v219
    v_mfma_f32_16x16x32_bf16 a[112:115], a[188:191], v[160:163], a[112:115]
    v_rcp_f32 v196, v192
    v_rcp_f32 v197, v193
    v_rcp_f32 v198, v194
    v_rcp_f32 v199, v195
    v_mfma_f32_16x16x32_bf16 a[4:7], a[160:163], v[164:167], a[4:7]
    v_mfma_f32_16x16x32_bf16 a[20:23], a[164:167], v[164:167], a[20:23]
    v_mfma_f32_16x16x32_bf16 a[36:39], a[168:171], v[164:167], a[36:39]
    v_mfma_f32_16x16x32_bf16 a[52:55], a[172:175], v[164:167], a[52:55]
    v_mfma_f32_16x16x32_bf16 a[68:71], a[176:179], v[164:167], a[68:71]
    v_mfma_f32_16x16x32_bf16 a[84:87], a[180:183], v[164:167], a[84:87]
    v_mfma_f32_16x16x32_bf16 a[100:103], a[184:187], v[164:167], a[100:103]
    v_mfma_f32_16x16x32_bf16 a[116:119], a[188:191], v[164:167], a[116:119]
    v_mfma_f32_16x16x32_bf16 a[8:11], a[160:163], v[168:171], a[8:11]
    v_accvgpr_read_b32 v64, a0
    v_accvgpr_read_b32 v65, a1
    v_accvgpr_read_b32 v66, a2
    v_accvgpr_read_b32 v67, a3
    v_accvgpr_read_b32 v68, a16
    v_accvgpr_read_b32 v69, a17
    v_accvgpr_read_b32 v70, a18
    v_accvgpr_read_b32 v71, a19
    v_mul_f32 v64, v64, v196
    v_mul_f32 v65, v65, v196
    v_mul_f32_e64 v66, v66, v196
    v_mfma_f32_16x16x32_bf16 a[24:27], a[164:167], v[168:171], a[24:27]
    v_mul_f32 v67, v67, v196
    v_mul_f32 v68, v68, v196
    v_mul_f32 v69, v69, v196
    v_mul_f32 v70, v70, v196
    v_mul_f32_e64 v71, v71, v196
    v_cvt_pk_bf16_f32 v72, v64, v65
    v_cvt_pk_bf16_f32 v73, v66, v67
    v_cvt_pk_bf16_f32 v74, v68, v69
    v_cvt_pk_bf16_f32 v75, v70, v71
    s_add_u32 s45, s44, 0x0
    s_nop 0
    buffer_store_dwordx4 v[72:75], v251, s[28:31], s45 offen sc1
    v_mfma_f32_16x16x32_bf16 a[40:43], a[168:171], v[168:171], a[40:43]
    v_accvgpr_read_b32 v76, a32
    v_accvgpr_read_b32 v77, a33
    v_accvgpr_read_b32 v78, a34
    v_accvgpr_read_b32 v79, a35
    v_accvgpr_read_b32 v80, a48
    v_accvgpr_read_b32 v81, a49
    v_accvgpr_read_b32 v82, a50
    v_accvgpr_read_b32 v83, a51
    v_mul_f32 v76, v76, v196
    v_mul_f32 v77, v77, v196
    v_mul_f32_e64 v78, v78, v196
    v_mfma_f32_16x16x32_bf16 a[56:59], a[172:175], v[168:171], a[56:59]
    v_mul_f32 v79, v79, v196
    v_mul_f32 v80, v80, v196
    v_mul_f32 v81, v81, v196
    v_mul_f32 v82, v82, v196
    v_mul_f32_e64 v83, v83, v196
    v_cvt_pk_bf16_f32 v84, v76, v77
    v_cvt_pk_bf16_f32 v85, v78, v79
    v_cvt_pk_bf16_f32 v86, v80, v81
    v_cvt_pk_bf16_f32 v87, v82, v83
    s_add_u32 s45, s44, 0x400
    buffer_store_dwordx4 v[84:87], v251, s[28:31], s45 offen sc1
    v_mfma_f32_16x16x32_bf16 a[72:75], a[176:179], v[168:171], a[72:75]
    v_accvgpr_read_b32 v88, a64
    v_accvgpr_read_b32 v89, a65
    v_accvgpr_read_b32 v90, a66
    v_accvgpr_read_b32 v91, a67
    v_accvgpr_read_b32 v92, a80
    v_accvgpr_read_b32 v93, a81
    v_accvgpr_read_b32 v94, a82
    v_accvgpr_read_b32 v95, a83
    v_mul_f32 v88, v88, v196
    v_mul_f32 v89, v89, v196
    v_mul_f32_e64 v90, v90, v196
    v_mfma_f32_16x16x32_bf16 a[88:91], a[180:183], v[168:171], a[88:91]
    v_mul_f32 v91, v91, v196
    v_mul_f32 v92, v92, v196
    v_mul_f32 v93, v93, v196
    v_mul_f32 v94, v94, v196
    v_mul_f32_e64 v95, v95, v196
    v_cvt_pk_bf16_f32 v96, v88, v89
    v_cvt_pk_bf16_f32 v97, v90, v91
    v_cvt_pk_bf16_f32 v98, v92, v93
    v_cvt_pk_bf16_f32 v99, v94, v95
    s_add_u32 s45, s44, 0x800
    buffer_store_dwordx4 v[96:99], v251, s[28:31], s45 offen sc1
    v_mfma_f32_16x16x32_bf16 a[104:107], a[184:187], v[168:171], a[104:107]
    v_accvgpr_read_b32 v100, a96
    v_accvgpr_read_b32 v101, a97
    v_accvgpr_read_b32 v102, a98
    v_accvgpr_read_b32 v103, a99
    v_accvgpr_read_b32 v104, a112
    v_accvgpr_read_b32 v105, a113
    v_accvgpr_read_b32 v106, a114
    v_accvgpr_read_b32 v107, a115
    v_mul_f32 v100, v100, v196
    v_mul_f32 v101, v101, v196
    v_mul_f32_e64 v102, v102, v196
    v_mfma_f32_16x16x32_bf16 a[120:123], a[188:191], v[168:171], a[120:123]
    v_mul_f32 v103, v103, v196
    v_mul_f32 v104, v104, v196
    v_mul_f32 v105, v105, v196
    v_mul_f32 v106, v106, v196
    v_mul_f32_e64 v107, v107, v196
    v_cvt_pk_bf16_f32 v108, v100, v101
    v_cvt_pk_bf16_f32 v109, v102, v103
    v_cvt_pk_bf16_f32 v110, v104, v105
    v_cvt_pk_bf16_f32 v111, v106, v107
    s_add_u32 s45, s44, 0xc00
    buffer_store_dwordx4 v[108:111], v251, s[28:31], s45 offen sc1
    v_mfma_f32_16x16x32_bf16 a[12:15], a[160:163], v[172:175], a[12:15]
    v_accvgpr_read_b32 v112, a4
    v_accvgpr_read_b32 v113, a5
    v_accvgpr_read_b32 v114, a6
    v_accvgpr_read_b32 v115, a7
    v_accvgpr_read_b32 v116, a20
    v_accvgpr_read_b32 v117, a21
    v_accvgpr_read_b32 v118, a22
    v_accvgpr_read_b32 v119, a23
    v_mul_f32 v112, v112, v197
    v_mul_f32 v113, v113, v197
    v_mul_f32_e64 v114, v114, v197
    v_mfma_f32_16x16x32_bf16 a[28:31], a[164:167], v[172:175], a[28:31]
    v_mul_f32 v115, v115, v197
    v_mul_f32 v116, v116, v197
    v_mul_f32 v117, v117, v197
    v_mul_f32 v118, v118, v197
    v_mul_f32_e64 v119, v119, v197
    v_cvt_pk_bf16_f32 v120, v112, v113
    v_cvt_pk_bf16_f32 v121, v114, v115
    v_cvt_pk_bf16_f32 v122, v116, v117
    v_cvt_pk_bf16_f32 v123, v118, v119
    s_add_u32 s45, s44, 0x2e000
    buffer_store_dwordx4 v[120:123], v251, s[28:31], s45 offen sc1
    v_mfma_f32_16x16x32_bf16 a[44:47], a[168:171], v[172:175], a[44:47]
    v_accvgpr_read_b32 v124, a36
    v_accvgpr_read_b32 v125, a37
    v_accvgpr_read_b32 v126, a38
    v_accvgpr_read_b32 v127, a39
    v_accvgpr_read_b32 v128, a52
    v_accvgpr_read_b32 v129, a53
    v_accvgpr_read_b32 v130, a54
    v_accvgpr_read_b32 v131, a55
    v_mul_f32 v124, v124, v197
    v_mul_f32 v125, v125, v197
    v_mul_f32_e64 v126, v126, v197
    v_mfma_f32_16x16x32_bf16 a[60:63], a[172:175], v[172:175], a[60:63]
    v_mul_f32 v127, v127, v197
    v_mul_f32 v128, v128, v197
    v_mul_f32 v129, v129, v197
    v_mul_f32 v130, v130, v197
    v_mul_f32_e64 v131, v131, v197
    v_cvt_pk_bf16_f32 v132, v124, v125
    v_cvt_pk_bf16_f32 v133, v126, v127
    v_cvt_pk_bf16_f32 v134, v128, v129
    v_cvt_pk_bf16_f32 v135, v130, v131
    s_add_u32 s45, s44, 0x2e400
    buffer_store_dwordx4 v[132:135], v251, s[28:31], s45 offen sc1
    v_mfma_f32_16x16x32_bf16 a[76:79], a[176:179], v[172:175], a[76:79]
    v_accvgpr_read_b32 v136, a68
    v_accvgpr_read_b32 v137, a69
    v_accvgpr_read_b32 v138, a70
    v_accvgpr_read_b32 v139, a71
    v_accvgpr_read_b32 v140, a84
    v_accvgpr_read_b32 v141, a85
    v_accvgpr_read_b32 v142, a86
    v_accvgpr_read_b32 v143, a87
    v_mul_f32 v136, v136, v197
    v_mul_f32 v137, v137, v197
    v_mul_f32_e64 v138, v138, v197
    v_mfma_f32_16x16x32_bf16 a[92:95], a[180:183], v[172:175], a[92:95]
    v_mul_f32 v139, v139, v197
    v_mul_f32 v140, v140, v197
    v_mul_f32 v141, v141, v197
    v_mul_f32 v142, v142, v197
    v_mul_f32_e64 v143, v143, v197
    v_cvt_pk_bf16_f32 v144, v136, v137
    v_cvt_pk_bf16_f32 v145, v138, v139
    v_cvt_pk_bf16_f32 v146, v140, v141
    v_cvt_pk_bf16_f32 v147, v142, v143
    s_add_u32 s45, s44, 0x2e800
    buffer_store_dwordx4 v[144:147], v251, s[28:31], s45 offen sc1
    v_mfma_f32_16x16x32_bf16 a[108:111], a[184:187], v[172:175], a[108:111]
    v_accvgpr_read_b32 v148, a100
    v_accvgpr_read_b32 v149, a101
    v_accvgpr_read_b32 v150, a102
    v_accvgpr_read_b32 v151, a103
    v_accvgpr_read_b32 v152, a116
    v_accvgpr_read_b32 v153, a117
    v_accvgpr_read_b32 v154, a118
    v_accvgpr_read_b32 v155, a119
    v_mul_f32 v148, v148, v197
    v_mul_f32 v149, v149, v197
    v_mul_f32_e64 v150, v150, v197
    v_mfma_f32_16x16x32_bf16 a[124:127], a[188:191], v[172:175], a[124:127]
    v_mul_f32 v151, v151, v197
    v_mul_f32 v152, v152, v197
    v_mul_f32 v153, v153, v197
    v_mul_f32 v154, v154, v197
    v_mul_f32_e64 v155, v155, v197
    v_cvt_pk_bf16_f32 v156, v148, v149
    v_cvt_pk_bf16_f32 v157, v150, v151
    v_cvt_pk_bf16_f32 v158, v152, v153
    v_cvt_pk_bf16_f32 v159, v154, v155
    s_add_u32 s45, s44, 0x2ec00
    buffer_store_dwordx4 v[156:159], v251, s[28:31], s45 offen sc1
    s_nop 0
    s_nop 0
    v_accvgpr_read_b32 v64, a8
    v_accvgpr_read_b32 v65, a9
    v_accvgpr_read_b32 v66, a10
    v_accvgpr_read_b32 v67, a11
    v_accvgpr_read_b32 v68, a24
    v_accvgpr_read_b32 v69, a25
    v_accvgpr_read_b32 v70, a26
    v_accvgpr_read_b32 v71, a27
    v_mul_f32 v64, v64, v198
    v_mul_f32 v65, v65, v198
    v_mul_f32 v66, v66, v198
    v_mul_f32 v67, v67, v198
    v_mul_f32 v68, v68, v198
    v_mul_f32 v69, v69, v198
    v_mul_f32 v70, v70, v198
    v_mul_f32 v71, v71, v198
    v_cvt_pk_bf16_f32 v72, v64, v65
    v_cvt_pk_bf16_f32 v73, v66, v67
    v_cvt_pk_bf16_f32 v74, v68, v69
    v_cvt_pk_bf16_f32 v75, v70, v71
    s_add_u32 s45, s44, 0x5c000
    buffer_store_dwordx4 v[72:75], v251, s[28:31], s45 offen sc1
    v_accvgpr_read_b32 v76, a40
    v_accvgpr_read_b32 v77, a41
    v_accvgpr_read_b32 v78, a42
    v_accvgpr_read_b32 v79, a43
    v_accvgpr_read_b32 v80, a56
    v_accvgpr_read_b32 v81, a57
    v_accvgpr_read_b32 v82, a58
    v_accvgpr_read_b32 v83, a59
    v_mul_f32 v76, v76, v198
    v_mul_f32 v77, v77, v198
    v_mul_f32 v78, v78, v198
    v_mul_f32 v79, v79, v198
    v_mul_f32 v80, v80, v198
    v_mul_f32 v81, v81, v198
    v_mul_f32 v82, v82, v198
    v_mul_f32 v83, v83, v198
    v_cvt_pk_bf16_f32 v84, v76, v77
    v_cvt_pk_bf16_f32 v85, v78, v79
    v_cvt_pk_bf16_f32 v86, v80, v81
    v_cvt_pk_bf16_f32 v87, v82, v83
    s_add_u32 s45, s44, 0x5c400
    buffer_store_dwordx4 v[84:87], v251, s[28:31], s45 offen sc1
    v_accvgpr_read_b32 v88, a72
    v_accvgpr_read_b32 v89, a73
    v_accvgpr_read_b32 v90, a74
    v_accvgpr_read_b32 v91, a75
    v_accvgpr_read_b32 v92, a88
    v_accvgpr_read_b32 v93, a89
    v_accvgpr_read_b32 v94, a90
    v_accvgpr_read_b32 v95, a91
    v_mul_f32 v88, v88, v198
    v_mul_f32 v89, v89, v198
    v_mul_f32 v90, v90, v198
    v_mul_f32 v91, v91, v198
    v_mul_f32 v92, v92, v198
    v_mul_f32 v93, v93, v198
    v_mul_f32 v94, v94, v198
    v_mul_f32 v95, v95, v198
    v_cvt_pk_bf16_f32 v96, v88, v89
    v_cvt_pk_bf16_f32 v97, v90, v91
    v_cvt_pk_bf16_f32 v98, v92, v93
    v_cvt_pk_bf16_f32 v99, v94, v95
    s_add_u32 s45, s44, 0x5c800
    buffer_store_dwordx4 v[96:99], v251, s[28:31], s45 offen sc1
    v_accvgpr_read_b32 v100, a104
    v_accvgpr_read_b32 v101, a105
    v_accvgpr_read_b32 v102, a106
    v_accvgpr_read_b32 v103, a107
    v_accvgpr_read_b32 v104, a120
    v_accvgpr_read_b32 v105, a121
    v_accvgpr_read_b32 v106, a122
    v_accvgpr_read_b32 v107, a123
    v_mul_f32 v100, v100, v198
    v_mul_f32 v101, v101, v198
    v_mul_f32 v102, v102, v198
    v_mul_f32 v103, v103, v198
    v_mul_f32 v104, v104, v198
    v_mul_f32 v105, v105, v198
    v_mul_f32 v106, v106, v198
    v_mul_f32 v107, v107, v198
    v_cvt_pk_bf16_f32 v108, v100, v101
    v_cvt_pk_bf16_f32 v109, v102, v103
    v_cvt_pk_bf16_f32 v110, v104, v105
    v_cvt_pk_bf16_f32 v111, v106, v107
    s_add_u32 s45, s44, 0x5cc00
    buffer_store_dwordx4 v[108:111], v251, s[28:31], s45 offen sc1
    v_accvgpr_read_b32 v112, a12
    v_accvgpr_read_b32 v113, a13
    v_accvgpr_read_b32 v114, a14
    v_accvgpr_read_b32 v115, a15
    v_accvgpr_read_b32 v116, a28
    v_accvgpr_read_b32 v117, a29
    v_accvgpr_read_b32 v118, a30
    v_accvgpr_read_b32 v119, a31
    v_mul_f32 v112, v112, v199
    v_mul_f32 v113, v113, v199
    v_mul_f32 v114, v114, v199
    v_mul_f32 v115, v115, v199
    v_mul_f32 v116, v116, v199
    v_mul_f32 v117, v117, v199
    v_mul_f32 v118, v118, v199
    v_mul_f32 v119, v119, v199
    v_cvt_pk_bf16_f32 v120, v112, v113
    v_cvt_pk_bf16_f32 v121, v114, v115
    v_cvt_pk_bf16_f32 v122, v116, v117
    v_cvt_pk_bf16_f32 v123, v118, v119
    s_add_u32 s45, s44, 0x8a000
    buffer_store_dwordx4 v[120:123], v251, s[28:31], s45 offen sc1
    v_accvgpr_read_b32 v124, a44
    v_accvgpr_read_b32 v125, a45
    v_accvgpr_read_b32 v126, a46
    v_accvgpr_read_b32 v127, a47
    v_accvgpr_read_b32 v128, a60
    v_accvgpr_read_b32 v129, a61
    v_accvgpr_read_b32 v130, a62
    v_accvgpr_read_b32 v131, a63
    v_mul_f32 v124, v124, v199
    v_mul_f32 v125, v125, v199
    v_mul_f32 v126, v126, v199
    v_mul_f32 v127, v127, v199
    v_mul_f32 v128, v128, v199
    v_mul_f32 v129, v129, v199
    v_mul_f32 v130, v130, v199
    v_mul_f32 v131, v131, v199
    v_cvt_pk_bf16_f32 v132, v124, v125
    v_cvt_pk_bf16_f32 v133, v126, v127
    v_cvt_pk_bf16_f32 v134, v128, v129
    v_cvt_pk_bf16_f32 v135, v130, v131
    s_add_u32 s45, s44, 0x8a400
    buffer_store_dwordx4 v[132:135], v251, s[28:31], s45 offen sc1
    v_accvgpr_read_b32 v136, a76
    v_accvgpr_read_b32 v137, a77
    v_accvgpr_read_b32 v138, a78
    v_accvgpr_read_b32 v139, a79
    v_accvgpr_read_b32 v140, a92
    v_accvgpr_read_b32 v141, a93
    v_accvgpr_read_b32 v142, a94
    v_accvgpr_read_b32 v143, a95
    v_mul_f32 v136, v136, v199
    v_mul_f32 v137, v137, v199
    v_mul_f32 v138, v138, v199
    v_mul_f32 v139, v139, v199
    v_mul_f32 v140, v140, v199
    v_mul_f32 v141, v141, v199
    v_mul_f32 v142, v142, v199
    v_mul_f32 v143, v143, v199
    v_cvt_pk_bf16_f32 v144, v136, v137
    v_cvt_pk_bf16_f32 v145, v138, v139
    v_cvt_pk_bf16_f32 v146, v140, v141
    v_cvt_pk_bf16_f32 v147, v142, v143
    s_add_u32 s45, s44, 0x8a800
    buffer_store_dwordx4 v[144:147], v251, s[28:31], s45 offen sc1
    v_accvgpr_read_b32 v148, a108
    v_accvgpr_read_b32 v149, a109
    v_accvgpr_read_b32 v150, a110
    v_accvgpr_read_b32 v151, a111
    v_accvgpr_read_b32 v152, a124
    v_accvgpr_read_b32 v153, a125
    v_accvgpr_read_b32 v154, a126
    v_accvgpr_read_b32 v155, a127
    v_mul_f32 v148, v148, v199
    v_mul_f32 v149, v149, v199
    v_mul_f32 v150, v150, v199
    v_mul_f32 v151, v151, v199
    v_mul_f32 v152, v152, v199
    v_mul_f32 v153, v153, v199
    v_mul_f32 v154, v154, v199
    v_mul_f32 v155, v155, v199
    v_cvt_pk_bf16_f32 v156, v148, v149
    v_cvt_pk_bf16_f32 v157, v150, v151
    v_cvt_pk_bf16_f32 v158, v152, v153
    v_cvt_pk_bf16_f32 v159, v154, v155
    s_add_u32 s45, s44, 0x8ac00
    buffer_store_dwordx4 v[156:159], v251, s[28:31], s45 offen sc1
    s_add_u32 s32, s52, 0x2800000
    s_addc_u32 s33, s53, 0
    s_nop 0
    s_mov_b32 s34, 0x2000
    s_mov_b32 s35, 0x20000
    s_load_dwordx2 s[4:5], s[0:1], 0
    s_load_dwordx2 s[6:7], s[0:1], 64
    s_mov_b32 s16, s92
    s_mov_b32 s17, s93
    s_mov_b32 s18, 0x5c0000
    s_mov_b32 s19, 0x20000
    s_lshl_b32 s44, s99, 12
    v_add_u32 v137, s44, v251
    s_lshl_b32 s46, s36, 15
    s_lshl_b32 s51, s36, 20
    s_mul_i32 s44, s98, 0xb8000
    v_add_u32_e64 v129, s44, v251
    v_add_u32 v130, 0x2e000, v129
    v_add_u32 v131, 0x2e000, v130
    v_add_u32 v132, 0x2e000, v131
    v_add_u32 v138, s38, v251
    s_lshl_b32 s44, s36, 13
    s_add_u32 s44, s44, 0x20000
    v_add_u32 v139, s44, v251
    s_lshl_b32 s44, s36, 14
    s_add_u32 s50, s44, 0x10000
    v_add_u32_e64 v136, s50, v251
    s_add_u32 s47, s51, 0x20000
    buffer_load_dwordx4 a[128:131], v137, s[16:19], s47 offen offset:0 sc1
    buffer_load_dwordx4 a[132:135], v137, s[16:19], s47 offen offset:1024 sc1
    buffer_load_dwordx4 a[136:139], v137, s[16:19], s47 offen offset:2048 sc1
    buffer_load_dwordx4 a[140:143], v137, s[16:19], s47 offen offset:3072 sc1
    s_add_u32 s47, s51, 0x28000
    buffer_load_dwordx4 a[144:147], v137, s[16:19], s47 offen offset:0 sc1
    buffer_load_dwordx4 a[148:151], v137, s[16:19], s47 offen offset:1024 sc1
    buffer_load_dwordx4 a[152:155], v137, s[16:19], s47 offen offset:2048 sc1
    buffer_load_dwordx4 a[156:159], v137, s[16:19], s47 offen offset:3072 sc1
    s_add_u32 s47, s51, 0x30000
    buffer_load_dwordx4 a[0:3], v137, s[16:19], s47 offen offset:0 sc1
    buffer_load_dwordx4 a[4:7], v137, s[16:19], s47 offen offset:1024 sc1
    buffer_load_dwordx4 a[8:11], v137, s[16:19], s47 offen offset:2048 sc1
    buffer_load_dwordx4 a[12:15], v137, s[16:19], s47 offen offset:3072 sc1
    s_add_u32 s47, s51, 0x38000
    buffer_load_dwordx4 a[16:19], v137, s[16:19], s47 offen offset:0 sc1
    buffer_load_dwordx4 a[20:23], v137, s[16:19], s47 offen offset:1024 sc1
    buffer_load_dwordx4 a[24:27], v137, s[16:19], s47 offen offset:2048 sc1
    buffer_load_dwordx4 a[28:31], v137, s[16:19], s47 offen offset:3072 sc1
    s_add_u32 s47, s51, 0x40000
    buffer_load_dwordx4 a[32:35], v137, s[16:19], s47 offen offset:0 sc1
    buffer_load_dwordx4 a[36:39], v137, s[16:19], s47 offen offset:1024 sc1
    buffer_load_dwordx4 a[40:43], v137, s[16:19], s47 offen offset:2048 sc1
    buffer_load_dwordx4 a[44:47], v137, s[16:19], s47 offen offset:3072 sc1
    s_add_u32 s47, s51, 0x48000
    buffer_load_dwordx4 a[48:51], v137, s[16:19], s47 offen offset:0 sc1
    buffer_load_dwordx4 a[52:55], v137, s[16:19], s47 offen offset:1024 sc1
    buffer_load_dwordx4 a[56:59], v137, s[16:19], s47 offen offset:2048 sc1
    buffer_load_dwordx4 a[60:63], v137, s[16:19], s47 offen offset:3072 sc1
    s_barrier
    s_lshl_b32 s44, s36, 14
    s_add_u32 s44, s44, 0x10000
    v_add_u32_e64 v143, s44, v251
    ds_write_b128 v143, a[192:195] offset:0
    ds_write_b128 v143, a[208:211] offset:1024
    ds_write_b128 v143, a[224:227] offset:2048
    ds_write_b128 v143, a[240:243] offset:3072
    ds_write_b128 v143, a[196:199] offset:4096
    ds_write_b128 v143, a[212:215] offset:5120
    ds_write_b128 v143, a[228:231] offset:6144
    ds_write_b128 v143, a[244:247] offset:7168
    ds_write_b128 v143, a[200:203] offset:8192
    ds_write_b128 v143, a[216:219] offset:9216
    ds_write_b128 v143, a[232:235] offset:10240
    ds_write_b128 v143, a[248:251] offset:11264
    ds_write_b128 v143, a[204:207] offset:12288
    ds_write_b128 v143, a[220:223] offset:13312
    ds_write_b128 v143, a[236:239] offset:14336
    ds_write_b128 v143, a[252:255] offset:15360
    s_waitcnt vmcnt(24) lgkmcnt(0)
    s_barrier
    s_cmp_lg_u32 s36, 0
    s_cbranch_scc1 K1_NOSIG2
    s_lshl_b32 s44, s43, 2
    s_lshr_b32 s45, s42, 3
    s_add_u32 s44, s44, s45
    s_lshl_b32 s44, s44, 8
    s_mov_b64 s[48:49], exec
    s_mov_b64 exec, 1
    v_mov_b32_e64 v140, 1
    buffer_atomic_add v140, off, s[32:35], s44 sc1
    s_mov_b64 exec, s[48:49]
K1_NOSIG2:
    s_nop 0
    s_add_u32 s47, s51, 0x50000
    buffer_load_dwordx4 a[64:67], v137, s[16:19], s47 offen offset:0 sc1
    buffer_load_dwordx4 a[68:71], v137, s[16:19], s47 offen offset:1024 sc1
    buffer_load_dwordx4 a[72:75], v137, s[16:19], s47 offen offset:2048 sc1
    buffer_load_dwordx4 a[76:79], v137, s[16:19], s47 offen offset:3072 sc1
    s_add_u32 s47, s51, 0x58000
    buffer_load_dwordx4 a[80:83], v137, s[16:19], s47 offen offset:0 sc1
    buffer_load_dwordx4 a[84:87], v137, s[16:19], s47 offen offset:1024 sc1
    buffer_load_dwordx4 a[88:91], v137, s[16:19], s47 offen offset:2048 sc1
    buffer_load_dwordx4 a[92:95], v137, s[16:19], s47 offen offset:3072 sc1
    s_add_u32 s47, s51, 0x60000
    buffer_load_dwordx4 a[96:99], v137, s[16:19], s47 offen offset:0 sc1
    buffer_load_dwordx4 a[100:103], v137, s[16:19], s47 offen offset:1024 sc1
    buffer_load_dwordx4 a[104:107], v137, s[16:19], s47 offen offset:2048 sc1
    buffer_load_dwordx4 a[108:111], v137, s[16:19], s47 offen offset:3072 sc1
    s_add_u32 s47, s51, 0x68000
    buffer_load_dwordx4 a[112:115], v137, s[16:19], s47 offen offset:0 sc1
    buffer_load_dwordx4 a[116:119], v137, s[16:19], s47 offen offset:1024 sc1
    buffer_load_dwordx4 a[120:123], v137, s[16:19], s47 offen offset:2048 sc1
    buffer_load_dwordx4 a[124:127], v137, s[16:19], s47 offen offset:3072 sc1
    s_add_u32 s47, s51, 0x70000
    buffer_load_dwordx4 a[160:163], v137, s[16:19], s47 offen offset:0 sc1
    buffer_load_dwordx4 a[164:167], v137, s[16:19], s47 offen offset:1024 sc1
    buffer_load_dwordx4 a[168:171], v137, s[16:19], s47 offen offset:2048 sc1
    buffer_load_dwordx4 a[172:175], v137, s[16:19], s47 offen offset:3072 sc1
    s_add_u32 s47, s51, 0x78000
    buffer_load_dwordx4 a[176:179], v137, s[16:19], s47 offen offset:0 sc1
    buffer_load_dwordx4 a[180:183], v137, s[16:19], s47 offen offset:1024 sc1
    buffer_load_dwordx4 a[184:187], v137, s[16:19], s47 offen offset:2048 sc1
    buffer_load_dwordx4 a[188:191], v137, s[16:19], s47 offen offset:3072 sc1
    s_lshl_b32 s44, s36, 12
    s_nop 0
    s_add_u32 s44, s44, 0x10000
    v_add_u32_e64 v143, s44, v251
    ds_read_b128 v[168:171], v143 offset:0
    ds_read_b128 v[172:175], v143 offset:1024
    ds_read_b128 v[176:179], v143 offset:2048
    ds_read_b128 v[180:183], v143 offset:3072
    ds_read_b128 v[184:187], v143 offset:16384
    ds_read_b128 v[188:191], v143 offset:17408
    ds_read_b128 v[192:195], v143 offset:18432
    ds_read_b128 v[196:199], v143 offset:19456
    ds_read_b128 v[200:203], v143 offset:32768
    ds_read_b128 v[204:207], v143 offset:33792
    ds_read_b128 v[208:211], v143 offset:34816
    ds_read_b128 v[212:215], v143 offset:35840
    ds_read_b128 v[216:219], v143 offset:49152
    ds_read_b128 v[220:223], v143 offset:50176
    ds_read_b128 v[224:227], v143 offset:51200
    ds_read_b128 v[228:231], v143 offset:52224
    v_and_b32 v140, 15, v250
    v_lshrrev_b32 v141, 4, v250
    s_lshl_b32 s44, s98, 6
    s_lshl_b32 s45, s36, 4
    s_add_u32 s44, s44, s45
    v_add_u32 v140, s44, v140
    v_lshlrev_b32_e64 v140, 10, v140
    v_lshl_add_u32 v140, v141, 4, v140
    s_lshl_b32 s44, s99, 7
    v_add_u32_e64 v142, s44, v140
    s_waitcnt lgkmcnt(0)
    s_mov_b32 s20, s4
    s_mov_b32 s21, s5
    s_mov_b32 s22, 0x200000
    s_mov_b32 s23, 0x20000
    s_mov_b32 s24, s6
    s_mov_b32 s25, s7
    s_mov_b32 s26, 0x200000
    s_mov_b32 s27, 0x20000
    buffer_load_dwordx4 v[144:147], v142, s[20:23], 0 offen
    buffer_load_dwordx4 v[148:151], v142, s[20:23], 0 offen offset:64
    v_pk_add_f32 v[168:169], v[168:169], v[184:185]
    v_pk_add_f32 v[200:201], v[200:201], v[216:217]
    v_pk_add_f32 v[170:171], v[170:171], v[186:187]
    v_pk_add_f32 v[202:203], v[202:203], v[218:219]
    v_pk_add_f32 v[172:173], v[172:173], v[188:189]
    v_pk_add_f32 v[204:205], v[204:205], v[220:221]
    v_pk_add_f32 v[174:175], v[174:175], v[190:191]
    v_pk_add_f32 v[206:207], v[206:207], v[222:223]
    v_pk_add_f32 v[176:177], v[176:177], v[192:193]
    v_pk_add_f32 v[208:209], v[208:209], v[224:225]
    v_pk_add_f32 v[178:179], v[178:179], v[194:195]
    v_pk_add_f32 v[210:211], v[210:211], v[226:227]
    v_pk_add_f32 v[180:181], v[180:181], v[196:197]
    v_pk_add_f32 v[212:213], v[212:213], v[228:229]
    v_pk_add_f32 v[182:183], v[182:183], v[198:199]
    v_pk_add_f32 v[214:215], v[214:215], v[230:231]
    v_pk_add_f32 v[168:169], v[168:169], v[200:201]
    v_pk_add_f32 v[170:171], v[170:171], v[202:203]
    v_pk_add_f32 v[172:173], v[172:173], v[204:205]
    v_pk_add_f32 v[174:175], v[174:175], v[206:207]
    v_pk_add_f32 v[176:177], v[176:177], v[208:209]
    v_pk_add_f32 v[178:179], v[178:179], v[210:211]
    v_pk_add_f32 v[180:181], v[180:181], v[212:213]
    v_pk_add_f32 v[182:183], v[182:183], v[214:215]
    v_mul_f32 v184, 0xbfb8aa3b, v168
    v_mul_f32 v185, 0xbfb8aa3b, v169
    v_mul_f32 v186, 0xbfb8aa3b, v170
    v_mul_f32 v187, 0xbfb8aa3b, v171
    v_mul_f32 v188, 0xbfb8aa3b, v172
    v_mul_f32 v189, 0xbfb8aa3b, v173
    v_mul_f32 v190, 0xbfb8aa3b, v174
    v_mul_f32 v191, 0xbfb8aa3b, v175
    v_mul_f32 v192, 0xbfb8aa3b, v176
    v_mul_f32 v193, 0xbfb8aa3b, v177
    v_mul_f32 v194, 0xbfb8aa3b, v178
    v_mul_f32 v195, 0xbfb8aa3b, v179
    v_mul_f32 v196, 0xbfb8aa3b, v180
    v_mul_f32 v197, 0xbfb8aa3b, v181
    v_mul_f32 v198, 0xbfb8aa3b, v182
    v_mul_f32 v199, 0xbfb8aa3b, v183
    v_exp_f32 v184, v184
    v_exp_f32 v185, v185
    v_exp_f32 v186, v186
    v_exp_f32 v187, v187
    v_exp_f32 v188, v188
    v_exp_f32 v189, v189
    v_exp_f32 v190, v190
    v_exp_f32 v191, v191
    v_exp_f32 v192, v192
    v_exp_f32 v193, v193
    v_exp_f32 v194, v194
    v_exp_f32 v195, v195
    v_exp_f32 v196, v196
    v_exp_f32 v197, v197
    v_exp_f32 v198, v198
    v_exp_f32 v199, v199
    s_nop 0
    v_add_f32 v184, 1.0, v184
    v_add_f32 v185, 1.0, v185
    v_add_f32 v186, 1.0, v186
    v_add_f32 v187, 1.0, v187
    v_add_f32 v188, 1.0, v188
    v_add_f32 v189, 1.0, v189
    v_add_f32 v190, 1.0, v190
    v_add_f32 v191, 1.0, v191
    v_add_f32 v192, 1.0, v192
    v_add_f32 v193, 1.0, v193
    v_add_f32 v194, 1.0, v194
    v_add_f32 v195, 1.0, v195
    v_add_f32 v196, 1.0, v196
    v_add_f32 v197, 1.0, v197
    v_add_f32 v198, 1.0, v198
    v_add_f32 v199, 1.0, v199
    v_rcp_f32 v184, v184
    v_rcp_f32 v185, v185
    v_rcp_f32 v186, v186
    v_rcp_f32 v187, v187
    v_rcp_f32 v188, v188
    v_rcp_f32 v189, v189
    v_rcp_f32 v190, v190
    v_rcp_f32 v191, v191
    v_rcp_f32 v192, v192
    v_rcp_f32 v193, v193
    v_rcp_f32 v194, v194
    v_rcp_f32 v195, v195
    v_rcp_f32 v196, v196
    v_rcp_f32 v197, v197
    v_rcp_f32 v198, v198
    v_rcp_f32 v199, v199
    s_nop 0
    v_mul_f32 v152, v168, v184
    v_mul_f32 v153, v169, v185
    v_mul_f32 v154, v170, v186
    v_mul_f32 v155, v171, v187
    v_mul_f32 v156, v172, v188
    v_mul_f32 v157, v173, v189
    v_mul_f32 v158, v174, v190
    v_mul_f32 v159, v175, v191
    v_mul_f32 v160, v176, v192
    v_mul_f32 v161, v177, v193
    v_mul_f32 v162, v178, v194
    v_mul_f32 v163, v179, v195
    v_mul_f32 v164, v180, v196
    v_mul_f32 v165, v181, v197
    v_mul_f32 v166, v182, v198
    v_mul_f32 v167, v183, v199
    v_mov_b32 v64, 0
    v_mov_b32 v65, 0
    v_mov_b32 v66, 0
    v_mov_b32 v67, 0
    v_mov_b32 v68, 0
    v_mov_b32 v69, 0
    v_mov_b32 v70, 0
    v_mov_b32 v71, 0
    v_mov_b32 v72, 0
    v_mov_b32 v73, 0
    v_mov_b32 v74, 0
    v_mov_b32 v75, 0
    v_mov_b32 v76, 0
    v_mov_b32 v77, 0
    v_mov_b32 v78, 0
    v_mov_b32 v79, 0
    v_mov_b32 v80, 0
    v_mov_b32 v81, 0
    v_mov_b32 v82, 0
    v_mov_b32 v83, 0
    v_mov_b32 v84, 0
    v_mov_b32 v85, 0
    v_mov_b32 v86, 0
    v_mov_b32 v87, 0
    v_mov_b32 v88, 0
    v_mov_b32 v89, 0
    v_mov_b32 v90, 0
    v_mov_b32 v91, 0
    v_mov_b32 v92, 0
    v_mov_b32 v93, 0
    v_mov_b32 v94, 0
    v_mov_b32 v95, 0
    v_mov_b32 v96, 0
    v_mov_b32 v97, 0
    v_mov_b32 v98, 0
    v_mov_b32 v99, 0
    v_mov_b32 v100, 0
    v_mov_b32 v101, 0
    v_mov_b32 v102, 0
    v_mov_b32 v103, 0
    v_mov_b32 v104, 0
    v_mov_b32 v105, 0
    v_mov_b32 v106, 0
    v_mov_b32 v107, 0
    v_mov_b32 v108, 0
    v_mov_b32 v109, 0
    v_mov_b32 v110, 0
    v_mov_b32 v111, 0
    v_mov_b32 v112, 0
    v_mov_b32 v113, 0
    v_mov_b32 v114, 0
    v_mov_b32 v115, 0
    v_mov_b32 v116, 0
    v_mov_b32 v117, 0
    v_mov_b32 v118, 0
    v_mov_b32 v119, 0
    v_mov_b32 v120, 0
    v_mov_b32 v121, 0
    v_mov_b32 v122, 0
    v_mov_b32 v123, 0
    v_mov_b32 v124, 0
    v_mov_b32 v125, 0
    v_mov_b32 v126, 0
    v_mov_b32 v127, 0
    s_lshr_b32 s44, s98, 2
    s_lshl_b32 s44, s44, 2
    s_add_u32 s44, s44, s36
    s_lshl_b32 s44, s44, 8
    s_mov_b32 s45, 0x8000
K1_POLL2:
    buffer_load_dword v140, off, s[32:35], s44 sc1
    s_waitcnt vmcnt(0)
    v_readfirstlane_b32 s48, v140
    s_sub_u32 s45, s45, 1
    s_cmp_eq_u32 s45, 0
    s_cbranch_scc1 K1_POLL2D
    s_cmp_ge_u32 s48, 8
    s_cbranch_scc1 K1_POLL2D
    s_sleep 1
    s_branch K1_POLL2
K1_POLL2D:
    s_nop 0
    buffer_load_dwordx4 a[192:195], v129, s[28:31], s46 offen sc1
    buffer_load_dwordx4 a[196:199], v130, s[28:31], s46 offen sc1
    buffer_load_dwordx4 a[200:203], v131, s[28:31], s46 offen sc1
    buffer_load_dwordx4 a[204:207], v132, s[28:31], s46 offen sc1
    s_addk_i32 s46, 0x400
    s_nop 0
    buffer_load_dwordx4 a[208:211], v129, s[28:31], s46 offen sc1
    buffer_load_dwordx4 a[212:215], v130, s[28:31], s46 offen sc1
    buffer_load_dwordx4 a[216:219], v131, s[28:31], s46 offen sc1
    buffer_load_dwordx4 a[220:223], v132, s[28:31], s46 offen sc1
    s_addk_i32 s46, 0x400
    s_nop 0
    buffer_load_dwordx4 a[224:227], v129, s[28:31], s46 offen sc1
    buffer_load_dwordx4 a[228:231], v130, s[28:31], s46 offen sc1
    buffer_load_dwordx4 a[232:235], v131, s[28:31], s46 offen sc1
    buffer_load_dwordx4 a[236:239], v132, s[28:31], s46 offen sc1
    s_addk_i32 s46, 0x400
    s_nop 0
    buffer_load_dwordx4 a[240:243], v129, s[28:31], s46 offen sc1
    buffer_load_dwordx4 a[244:247], v130, s[28:31], s46 offen sc1
    buffer_load_dwordx4 a[248:251], v131, s[28:31], s46 offen sc1
    buffer_load_dwordx4 a[252:255], v132, s[28:31], s46 offen sc1
    s_addk_i32 s46, 0x400
    s_nop 0
    buffer_load_dwordx4 v[168:171], v129, s[28:31], s46 offen sc1
    buffer_load_dwordx4 v[172:175], v130, s[28:31], s46 offen sc1
    buffer_load_dwordx4 v[176:179], v131, s[28:31], s46 offen sc1
    buffer_load_dwordx4 v[180:183], v132, s[28:31], s46 offen sc1
    s_addk_i32 s46, 0x400
    s_nop 0
    buffer_load_dwordx4 v[184:187], v129, s[28:31], s46 offen sc1
    buffer_load_dwordx4 v[188:191], v130, s[28:31], s46 offen sc1
    buffer_load_dwordx4 v[192:195], v131, s[28:31], s46 offen sc1
    buffer_load_dwordx4 v[196:199], v132, s[28:31], s46 offen sc1
    s_addk_i32 s46, 0x400
    s_waitcnt vmcnt(20) lgkmcnt(0)
    v_mfma_f32_16x16x32_bf16 v[64:67], v[0:3], a[192:195], v[64:67]
    v_mfma_f32_16x16x32_bf16 v[68:71], v[0:3], a[196:199], v[68:71]
    v_mfma_f32_16x16x32_bf16 v[72:75], v[0:3], a[200:203], v[72:75]
    v_mfma_f32_16x16x32_bf16 v[76:79], v[0:3], a[204:207], v[76:79]
    ds_read_b128 v[0:3], v138 offset:8192
    v_mfma_f32_16x16x32_bf16 v[80:83], v[4:7], a[192:195], v[80:83]
    v_mfma_f32_16x16x32_bf16 v[84:87], v[4:7], a[196:199], v[84:87]
    v_mfma_f32_16x16x32_bf16 v[88:91], v[4:7], a[200:203], v[88:91]
    v_mfma_f32_16x16x32_bf16 v[92:95], v[4:7], a[204:207], v[92:95]
    ds_read_b128 v[4:7], v138 offset:9216
    v_mfma_f32_16x16x32_bf16 v[96:99], v[8:11], a[192:195], v[96:99]
    v_mfma_f32_16x16x32_bf16 v[100:103], v[8:11], a[196:199], v[100:103]
    v_mfma_f32_16x16x32_bf16 v[104:107], v[8:11], a[200:203], v[104:107]
    v_mfma_f32_16x16x32_bf16 v[108:111], v[8:11], a[204:207], v[108:111]
    ds_read_b128 v[8:11], v138 offset:16384
    v_mfma_f32_16x16x32_bf16 v[112:115], v[12:15], a[192:195], v[112:115]
    v_mfma_f32_16x16x32_bf16 v[116:119], v[12:15], a[196:199], v[116:119]
    v_mfma_f32_16x16x32_bf16 v[120:123], v[12:15], a[200:203], v[120:123]
    v_mfma_f32_16x16x32_bf16 v[124:127], v[12:15], a[204:207], v[124:127]
    ds_read_b128 v[12:15], v138 offset:17408
    buffer_load_dwordx4 a[192:195], v129, s[28:31], s46 offen sc1
    buffer_load_dwordx4 a[196:199], v130, s[28:31], s46 offen sc1
    buffer_load_dwordx4 a[200:203], v131, s[28:31], s46 offen sc1
    buffer_load_dwordx4 a[204:207], v132, s[28:31], s46 offen sc1
    s_addk_i32 s46, 0x400
    s_waitcnt vmcnt(20) lgkmcnt(0)
    v_mfma_f32_16x16x32_bf16 v[64:67], v[16:19], a[208:211], v[64:67]
    v_mfma_f32_16x16x32_bf16 v[68:71], v[16:19], a[212:215], v[68:71]
    v_mfma_f32_16x16x32_bf16 v[72:75], v[16:19], a[216:219], v[72:75]
    v_mfma_f32_16x16x32_bf16 v[76:79], v[16:19], a[220:223], v[76:79]
    ds_read_b128 v[16:19], v138 offset:24576
    v_mfma_f32_16x16x32_bf16 v[80:83], v[20:23], a[208:211], v[80:83]
    v_mfma_f32_16x16x32_bf16 v[84:87], v[20:23], a[212:215], v[84:87]
    v_mfma_f32_16x16x32_bf16 v[88:91], v[20:23], a[216:219], v[88:91]
    v_mfma_f32_16x16x32_bf16 v[92:95], v[20:23], a[220:223], v[92:95]
    ds_read_b128 v[20:23], v138 offset:25600
    v_mfma_f32_16x16x32_bf16 v[96:99], v[24:27], a[208:211], v[96:99]
    v_mfma_f32_16x16x32_bf16 v[100:103], v[24:27], a[212:215], v[100:103]
    v_mfma_f32_16x16x32_bf16 v[104:107], v[24:27], a[216:219], v[104:107]
    v_mfma_f32_16x16x32_bf16 v[108:111], v[24:27], a[220:223], v[108:111]
    ds_read_b128 v[24:27], v138 offset:32768
    v_mfma_f32_16x16x32_bf16 v[112:115], v[28:31], a[208:211], v[112:115]
    v_mfma_f32_16x16x32_bf16 v[116:119], v[28:31], a[212:215], v[116:119]
    v_mfma_f32_16x16x32_bf16 v[120:123], v[28:31], a[216:219], v[120:123]
    v_mfma_f32_16x16x32_bf16 v[124:127], v[28:31], a[220:223], v[124:127]
    ds_read_b128 v[28:31], v138 offset:33792
    buffer_load_dwordx4 a[208:211], v129, s[28:31], s46 offen sc1
    buffer_load_dwordx4 a[212:215], v130, s[28:31], s46 offen sc1
    buffer_load_dwordx4 a[216:219], v131, s[28:31], s46 offen sc1
    buffer_load_dwordx4 a[220:223], v132, s[28:31], s46 offen sc1
    s_addk_i32 s46, 0x400
    s_waitcnt vmcnt(20) lgkmcnt(0)
    v_mfma_f32_16x16x32_bf16 v[64:67], v[32:35], a[224:227], v[64:67]
    v_mfma_f32_16x16x32_bf16 v[68:71], v[32:35], a[228:231], v[68:71]
    v_mfma_f32_16x16x32_bf16 v[72:75], v[32:35], a[232:235], v[72:75]
    v_mfma_f32_16x16x32_bf16 v[76:79], v[32:35], a[236:239], v[76:79]
    ds_read_b128 v[32:35], v138 offset:40960
    v_mfma_f32_16x16x32_bf16 v[80:83], v[36:39], a[224:227], v[80:83]
    v_mfma_f32_16x16x32_bf16 v[84:87], v[36:39], a[228:231], v[84:87]
    v_mfma_f32_16x16x32_bf16 v[88:91], v[36:39], a[232:235], v[88:91]
    v_mfma_f32_16x16x32_bf16 v[92:95], v[36:39], a[236:239], v[92:95]
    ds_read_b128 v[36:39], v138 offset:41984
    v_mfma_f32_16x16x32_bf16 v[96:99], v[40:43], a[224:227], v[96:99]
    v_mfma_f32_16x16x32_bf16 v[100:103], v[40:43], a[228:231], v[100:103]
    v_mfma_f32_16x16x32_bf16 v[104:107], v[40:43], a[232:235], v[104:107]
    v_mfma_f32_16x16x32_bf16 v[108:111], v[40:43], a[236:239], v[108:111]
    ds_read_b128 v[40:43], v138 offset:49152
    v_mfma_f32_16x16x32_bf16 v[112:115], v[44:47], a[224:227], v[112:115]
    v_mfma_f32_16x16x32_bf16 v[116:119], v[44:47], a[228:231], v[116:119]
    v_mfma_f32_16x16x32_bf16 v[120:123], v[44:47], a[232:235], v[120:123]
    v_mfma_f32_16x16x32_bf16 v[124:127], v[44:47], a[236:239], v[124:127]
    ds_read_b128 v[44:47], v138 offset:50176
    buffer_load_dwordx4 a[224:227], v129, s[28:31], s46 offen sc1
    buffer_load_dwordx4 a[228:231], v130, s[28:31], s46 offen sc1
    buffer_load_dwordx4 a[232:235], v131, s[28:31], s46 offen sc1
    buffer_load_dwordx4 a[236:239], v132, s[28:31], s46 offen sc1
    s_addk_i32 s46, 0x400
    s_waitcnt vmcnt(20) lgkmcnt(0)
    v_mfma_f32_16x16x32_bf16 v[64:67], v[48:51], a[240:243], v[64:67]
    v_mfma_f32_16x16x32_bf16 v[68:71], v[48:51], a[244:247], v[68:71]
    v_mfma_f32_16x16x32_bf16 v[72:75], v[48:51], a[248:251], v[72:75]
    v_mfma_f32_16x16x32_bf16 v[76:79], v[48:51], a[252:255], v[76:79]
    ds_read_b128 v[48:51], v139 offset:0
    v_mfma_f32_16x16x32_bf16 v[80:83], v[52:55], a[240:243], v[80:83]
    v_mfma_f32_16x16x32_bf16 v[84:87], v[52:55], a[244:247], v[84:87]
    v_mfma_f32_16x16x32_bf16 v[88:91], v[52:55], a[248:251], v[88:91]
    v_mfma_f32_16x16x32_bf16 v[92:95], v[52:55], a[252:255], v[92:95]
    ds_read_b128 v[52:55], v139 offset:1024
    v_mfma_f32_16x16x32_bf16 v[96:99], v[56:59], a[240:243], v[96:99]
    v_mfma_f32_16x16x32_bf16 v[100:103], v[56:59], a[244:247], v[100:103]
    v_mfma_f32_16x16x32_bf16 v[104:107], v[56:59], a[248:251], v[104:107]
    v_mfma_f32_16x16x32_bf16 v[108:111], v[56:59], a[252:255], v[108:111]
    ds_read_b128 v[56:59], v139 offset:2048
    v_mfma_f32_16x16x32_bf16 v[112:115], v[60:63], a[240:243], v[112:115]
    v_mfma_f32_16x16x32_bf16 v[116:119], v[60:63], a[244:247], v[116:119]
    v_mfma_f32_16x16x32_bf16 v[120:123], v[60:63], a[248:251], v[120:123]
    v_mfma_f32_16x16x32_bf16 v[124:127], v[60:63], a[252:255], v[124:127]
    ds_read_b128 v[60:63], v139 offset:3072
    buffer_load_dwordx4 a[240:243], v129, s[28:31], s46 offen sc1
    buffer_load_dwordx4 a[244:247], v130, s[28:31], s46 offen sc1
    buffer_load_dwordx4 a[248:251], v131, s[28:31], s46 offen sc1
    buffer_load_dwordx4 a[252:255], v132, s[28:31], s46 offen sc1
    s_addk_i32 s46, 0x400
    s_waitcnt vmcnt(20) lgkmcnt(0)
    v_mfma_f32_16x16x32_bf16 v[64:67], a[128:131], v[168:171], v[64:67]
    v_mfma_f32_16x16x32_bf16 v[68:71], a[128:131], v[172:175], v[68:71]
    v_mfma_f32_16x16x32_bf16 v[72:75], a[128:131], v[176:179], v[72:75]
    v_mfma_f32_16x16x32_bf16 v[76:79], a[128:131], v[180:183], v[76:79]
    ds_read_b128 a[128:131], v139 offset:4096
    v_mfma_f32_16x16x32_bf16 v[80:83], a[132:135], v[168:171], v[80:83]
    v_mfma_f32_16x16x32_bf16 v[84:87], a[132:135], v[172:175], v[84:87]
    v_mfma_f32_16x16x32_bf16 v[88:91], a[132:135], v[176:179], v[88:91]
    v_mfma_f32_16x16x32_bf16 v[92:95], a[132:135], v[180:183], v[92:95]
    ds_read_b128 a[132:135], v139 offset:5120
    v_mfma_f32_16x16x32_bf16 v[96:99], a[136:139], v[168:171], v[96:99]
    v_mfma_f32_16x16x32_bf16 v[100:103], a[136:139], v[172:175], v[100:103]
    v_mfma_f32_16x16x32_bf16 v[104:107], a[136:139], v[176:179], v[104:107]
    v_mfma_f32_16x16x32_bf16 v[108:111], a[136:139], v[180:183], v[108:111]
    ds_read_b128 a[136:139], v139 offset:6144
    v_mfma_f32_16x16x32_bf16 v[112:115], a[140:143], v[168:171], v[112:115]
    v_mfma_f32_16x16x32_bf16 v[116:119], a[140:143], v[172:175], v[116:119]
    v_mfma_f32_16x16x32_bf16 v[120:123], a[140:143], v[176:179], v[120:123]
    v_mfma_f32_16x16x32_bf16 v[124:127], a[140:143], v[180:183], v[124:127]
    ds_read_b128 a[140:143], v139 offset:7168
    buffer_load_dwordx4 v[168:171], v129, s[28:31], s46 offen sc1
    buffer_load_dwordx4 v[172:175], v130, s[28:31], s46 offen sc1
    buffer_load_dwordx4 v[176:179], v131, s[28:31], s46 offen sc1
    buffer_load_dwordx4 v[180:183], v132, s[28:31], s46 offen sc1
    s_addk_i32 s46, 0x400
    s_waitcnt vmcnt(20) lgkmcnt(0)
    s_add_u32 s47, s51, 0xa8000
    v_mfma_f32_16x16x32_bf16 v[64:67], a[144:147], v[184:187], v[64:67]
    v_mfma_f32_16x16x32_bf16 v[68:71], a[144:147], v[188:191], v[68:71]
    v_mfma_f32_16x16x32_bf16 v[72:75], a[144:147], v[192:195], v[72:75]
    v_mfma_f32_16x16x32_bf16 v[76:79], a[144:147], v[196:199], v[76:79]
    buffer_load_dwordx4 a[144:147], v137, s[16:19], s47 offen offset:0 sc1
    v_mfma_f32_16x16x32_bf16 v[80:83], a[148:151], v[184:187], v[80:83]
    v_mfma_f32_16x16x32_bf16 v[84:87], a[148:151], v[188:191], v[84:87]
    v_mfma_f32_16x16x32_bf16 v[88:91], a[148:151], v[192:195], v[88:91]
    v_mfma_f32_16x16x32_bf16 v[92:95], a[148:151], v[196:199], v[92:95]
    buffer_load_dwordx4 a[148:151], v137, s[16:19], s47 offen offset:1024 sc1
    v_mfma_f32_16x16x32_bf16 v[96:99], a[152:155], v[184:187], v[96:99]
    v_mfma_f32_16x16x32_bf16 v[100:103], a[152:155], v[188:191], v[100:103]
    v_mfma_f32_16x16x32_bf16 v[104:107], a[152:155], v[192:195], v[104:107]
    v_mfma_f32_16x16x32_bf16 v[108:111], a[152:155], v[196:199], v[108:111]
    buffer_load_dwordx4 a[152:155], v137, s[16:19], s47 offen offset:2048 sc1
    v_mfma_f32_16x16x32_bf16 v[112:115], a[156:159], v[184:187], v[112:115]
    v_mfma_f32_16x16x32_bf16 v[116:119], a[156:159], v[188:191], v[116:119]
    v_mfma_f32_16x16x32_bf16 v[120:123], a[156:159], v[192:195], v[120:123]
    v_mfma_f32_16x16x32_bf16 v[124:127], a[156:159], v[196:199], v[124:127]
    buffer_load_dwordx4 a[156:159], v137, s[16:19], s47 offen offset:3072 sc1
    buffer_load_dwordx4 v[184:187], v129, s[28:31], s46 offen sc1
    buffer_load_dwordx4 v[188:191], v130, s[28:31], s46 offen sc1
    buffer_load_dwordx4 v[192:195], v131, s[28:31], s46 offen sc1
    buffer_load_dwordx4 v[196:199], v132, s[28:31], s46 offen sc1
    s_addk_i32 s46, 0x400
    s_waitcnt vmcnt(24) lgkmcnt(0)
    s_add_u32 s47, s51, 0xb0000
    v_mfma_f32_16x16x32_bf16 v[64:67], a[0:3], a[192:195], v[64:67]
    v_mfma_f32_16x16x32_bf16 v[68:71], a[0:3], a[196:199], v[68:71]
    v_mfma_f32_16x16x32_bf16 v[72:75], a[0:3], a[200:203], v[72:75]
    v_mfma_f32_16x16x32_bf16 v[76:79], a[0:3], a[204:207], v[76:79]
    buffer_load_dwordx4 a[0:3], v137, s[16:19], s47 offen offset:0 sc1
    v_mfma_f32_16x16x32_bf16 v[80:83], a[4:7], a[192:195], v[80:83]
    v_mfma_f32_16x16x32_bf16 v[84:87], a[4:7], a[196:199], v[84:87]
    v_mfma_f32_16x16x32_bf16 v[88:91], a[4:7], a[200:203], v[88:91]
    v_mfma_f32_16x16x32_bf16 v[92:95], a[4:7], a[204:207], v[92:95]
    buffer_load_dwordx4 a[4:7], v137, s[16:19], s47 offen offset:1024 sc1
    v_mfma_f32_16x16x32_bf16 v[96:99], a[8:11], a[192:195], v[96:99]
    v_mfma_f32_16x16x32_bf16 v[100:103], a[8:11], a[196:199], v[100:103]
    v_mfma_f32_16x16x32_bf16 v[104:107], a[8:11], a[200:203], v[104:107]
    v_mfma_f32_16x16x32_bf16 v[108:111], a[8:11], a[204:207], v[108:111]
    buffer_load_dwordx4 a[8:11], v137, s[16:19], s47 offen offset:2048 sc1
    v_mfma_f32_16x16x32_bf16 v[112:115], a[12:15], a[192:195], v[112:115]
    v_mfma_f32_16x16x32_bf16 v[116:119], a[12:15], a[196:199], v[116:119]
    v_mfma_f32_16x16x32_bf16 v[120:123], a[12:15], a[200:203], v[120:123]
    v_mfma_f32_16x16x32_bf16 v[124:127], a[12:15], a[204:207], v[124:127]
    buffer_load_dwordx4 a[12:15], v137, s[16:19], s47 offen offset:3072 sc1
    buffer_load_dwordx4 a[192:195], v129, s[28:31], s46 offen sc1
    buffer_load_dwordx4 a[196:199], v130, s[28:31], s46 offen sc1
    buffer_load_dwordx4 a[200:203], v131, s[28:31], s46 offen sc1
    buffer_load_dwordx4 a[204:207], v132, s[28:31], s46 offen sc1
    s_addk_i32 s46, 0x400
    s_waitcnt vmcnt(28) lgkmcnt(0)
    s_add_u32 s47, s51, 0xb8000
    v_mfma_f32_16x16x32_bf16 v[64:67], a[16:19], a[208:211], v[64:67]
    v_mfma_f32_16x16x32_bf16 v[68:71], a[16:19], a[212:215], v[68:71]
    v_mfma_f32_16x16x32_bf16 v[72:75], a[16:19], a[216:219], v[72:75]
    v_mfma_f32_16x16x32_bf16 v[76:79], a[16:19], a[220:223], v[76:79]
    buffer_load_dwordx4 a[16:19], v137, s[16:19], s47 offen offset:0 sc1
    v_mfma_f32_16x16x32_bf16 v[80:83], a[20:23], a[208:211], v[80:83]
    v_mfma_f32_16x16x32_bf16 v[84:87], a[20:23], a[212:215], v[84:87]
    v_mfma_f32_16x16x32_bf16 v[88:91], a[20:23], a[216:219], v[88:91]
    v_mfma_f32_16x16x32_bf16 v[92:95], a[20:23], a[220:223], v[92:95]
    buffer_load_dwordx4 a[20:23], v137, s[16:19], s47 offen offset:1024 sc1
    v_mfma_f32_16x16x32_bf16 v[96:99], a[24:27], a[208:211], v[96:99]
    v_mfma_f32_16x16x32_bf16 v[100:103], a[24:27], a[212:215], v[100:103]
    v_mfma_f32_16x16x32_bf16 v[104:107], a[24:27], a[216:219], v[104:107]
    v_mfma_f32_16x16x32_bf16 v[108:111], a[24:27], a[220:223], v[108:111]
    buffer_load_dwordx4 a[24:27], v137, s[16:19], s47 offen offset:2048 sc1
    v_mfma_f32_16x16x32_bf16 v[112:115], a[28:31], a[208:211], v[112:115]
    v_mfma_f32_16x16x32_bf16 v[116:119], a[28:31], a[212:215], v[116:119]
    v_mfma_f32_16x16x32_bf16 v[120:123], a[28:31], a[216:219], v[120:123]
    v_mfma_f32_16x16x32_bf16 v[124:127], a[28:31], a[220:223], v[124:127]
    buffer_load_dwordx4 a[28:31], v137, s[16:19], s47 offen offset:3072 sc1
    buffer_load_dwordx4 a[208:211], v129, s[28:31], s46 offen sc1
    buffer_load_dwordx4 a[212:215], v130, s[28:31], s46 offen sc1
    buffer_load_dwordx4 a[216:219], v131, s[28:31], s46 offen sc1
    buffer_load_dwordx4 a[220:223], v132, s[28:31], s46 offen sc1
    s_addk_i32 s46, 0x400
    s_waitcnt vmcnt(32) lgkmcnt(0)
    s_add_u32 s47, s51, 0xc0000
    v_mfma_f32_16x16x32_bf16 v[64:67], a[32:35], a[224:227], v[64:67]
    v_mfma_f32_16x16x32_bf16 v[68:71], a[32:35], a[228:231], v[68:71]
    v_mfma_f32_16x16x32_bf16 v[72:75], a[32:35], a[232:235], v[72:75]
    v_mfma_f32_16x16x32_bf16 v[76:79], a[32:35], a[236:239], v[76:79]
    buffer_load_dwordx4 a[32:35], v137, s[16:19], s47 offen offset:0 sc1
    v_mfma_f32_16x16x32_bf16 v[80:83], a[36:39], a[224:227], v[80:83]
    v_mfma_f32_16x16x32_bf16 v[84:87], a[36:39], a[228:231], v[84:87]
    v_mfma_f32_16x16x32_bf16 v[88:91], a[36:39], a[232:235], v[88:91]
    v_mfma_f32_16x16x32_bf16 v[92:95], a[36:39], a[236:239], v[92:95]
    buffer_load_dwordx4 a[36:39], v137, s[16:19], s47 offen offset:1024 sc1
    v_mfma_f32_16x16x32_bf16 v[96:99], a[40:43], a[224:227], v[96:99]
    v_mfma_f32_16x16x32_bf16 v[100:103], a[40:43], a[228:231], v[100:103]
    v_mfma_f32_16x16x32_bf16 v[104:107], a[40:43], a[232:235], v[104:107]
    v_mfma_f32_16x16x32_bf16 v[108:111], a[40:43], a[236:239], v[108:111]
    buffer_load_dwordx4 a[40:43], v137, s[16:19], s47 offen offset:2048 sc1
    v_mfma_f32_16x16x32_bf16 v[112:115], a[44:47], a[224:227], v[112:115]
    v_mfma_f32_16x16x32_bf16 v[116:119], a[44:47], a[228:231], v[116:119]
    v_mfma_f32_16x16x32_bf16 v[120:123], a[44:47], a[232:235], v[120:123]
    v_mfma_f32_16x16x32_bf16 v[124:127], a[44:47], a[236:239], v[124:127]
    buffer_load_dwordx4 a[44:47], v137, s[16:19], s47 offen offset:3072 sc1
    buffer_load_dwordx4 a[224:227], v129, s[28:31], s46 offen sc1
    buffer_load_dwordx4 a[228:231], v130, s[28:31], s46 offen sc1
    buffer_load_dwordx4 a[232:235], v131, s[28:31], s46 offen sc1
    buffer_load_dwordx4 a[236:239], v132, s[28:31], s46 offen sc1
    s_addk_i32 s46, 0x400
    s_waitcnt vmcnt(36) lgkmcnt(0)
    s_add_u32 s47, s51, 0xc8000
    v_mfma_f32_16x16x32_bf16 v[64:67], a[48:51], a[240:243], v[64:67]
    v_mfma_f32_16x16x32_bf16 v[68:71], a[48:51], a[244:247], v[68:71]
    v_mfma_f32_16x16x32_bf16 v[72:75], a[48:51], a[248:251], v[72:75]
    v_mfma_f32_16x16x32_bf16 v[76:79], a[48:51], a[252:255], v[76:79]
    buffer_load_dwordx4 a[48:51], v137, s[16:19], s47 offen offset:0 sc1
    v_mfma_f32_16x16x32_bf16 v[80:83], a[52:55], a[240:243], v[80:83]
    v_mfma_f32_16x16x32_bf16 v[84:87], a[52:55], a[244:247], v[84:87]
    v_mfma_f32_16x16x32_bf16 v[88:91], a[52:55], a[248:251], v[88:91]
    v_mfma_f32_16x16x32_bf16 v[92:95], a[52:55], a[252:255], v[92:95]
    buffer_load_dwordx4 a[52:55], v137, s[16:19], s47 offen offset:1024 sc1
    v_mfma_f32_16x16x32_bf16 v[96:99], a[56:59], a[240:243], v[96:99]
    v_mfma_f32_16x16x32_bf16 v[100:103], a[56:59], a[244:247], v[100:103]
    v_mfma_f32_16x16x32_bf16 v[104:107], a[56:59], a[248:251], v[104:107]
    v_mfma_f32_16x16x32_bf16 v[108:111], a[56:59], a[252:255], v[108:111]
    buffer_load_dwordx4 a[56:59], v137, s[16:19], s47 offen offset:2048 sc1
    v_mfma_f32_16x16x32_bf16 v[112:115], a[60:63], a[240:243], v[112:115]
    v_mfma_f32_16x16x32_bf16 v[116:119], a[60:63], a[244:247], v[116:119]
    v_mfma_f32_16x16x32_bf16 v[120:123], a[60:63], a[248:251], v[120:123]
    v_mfma_f32_16x16x32_bf16 v[124:127], a[60:63], a[252:255], v[124:127]
    buffer_load_dwordx4 a[60:63], v137, s[16:19], s47 offen offset:3072 sc1
    buffer_load_dwordx4 a[240:243], v129, s[28:31], s46 offen sc1
    buffer_load_dwordx4 a[244:247], v130, s[28:31], s46 offen sc1
    buffer_load_dwordx4 a[248:251], v131, s[28:31], s46 offen sc1
    buffer_load_dwordx4 a[252:255], v132, s[28:31], s46 offen sc1
    s_addk_i32 s46, 0x400
    s_waitcnt vmcnt(40) lgkmcnt(0)
    s_add_u32 s47, s51, 0xd0000
    v_mfma_f32_16x16x32_bf16 v[64:67], a[64:67], v[168:171], v[64:67]
    v_mfma_f32_16x16x32_bf16 v[68:71], a[64:67], v[172:175], v[68:71]
    v_mfma_f32_16x16x32_bf16 v[72:75], a[64:67], v[176:179], v[72:75]
    v_mfma_f32_16x16x32_bf16 v[76:79], a[64:67], v[180:183], v[76:79]
    buffer_load_dwordx4 a[64:67], v137, s[16:19], s47 offen offset:0 sc1
    v_mfma_f32_16x16x32_bf16 v[80:83], a[68:71], v[168:171], v[80:83]
    v_mfma_f32_16x16x32_bf16 v[84:87], a[68:71], v[172:175], v[84:87]
    v_mfma_f32_16x16x32_bf16 v[88:91], a[68:71], v[176:179], v[88:91]
    v_mfma_f32_16x16x32_bf16 v[92:95], a[68:71], v[180:183], v[92:95]
    buffer_load_dwordx4 a[68:71], v137, s[16:19], s47 offen offset:1024 sc1
    v_mfma_f32_16x16x32_bf16 v[96:99], a[72:75], v[168:171], v[96:99]
    v_mfma_f32_16x16x32_bf16 v[100:103], a[72:75], v[172:175], v[100:103]
    v_mfma_f32_16x16x32_bf16 v[104:107], a[72:75], v[176:179], v[104:107]
    v_mfma_f32_16x16x32_bf16 v[108:111], a[72:75], v[180:183], v[108:111]
    buffer_load_dwordx4 a[72:75], v137, s[16:19], s47 offen offset:2048 sc1
    v_mfma_f32_16x16x32_bf16 v[112:115], a[76:79], v[168:171], v[112:115]
    v_mfma_f32_16x16x32_bf16 v[116:119], a[76:79], v[172:175], v[116:119]
    v_mfma_f32_16x16x32_bf16 v[120:123], a[76:79], v[176:179], v[120:123]
    v_mfma_f32_16x16x32_bf16 v[124:127], a[76:79], v[180:183], v[124:127]
    buffer_load_dwordx4 a[76:79], v137, s[16:19], s47 offen offset:3072 sc1
    buffer_load_dwordx4 v[168:171], v129, s[28:31], s46 offen sc1
    buffer_load_dwordx4 v[172:175], v130, s[28:31], s46 offen sc1
    buffer_load_dwordx4 v[176:179], v131, s[28:31], s46 offen sc1
    buffer_load_dwordx4 v[180:183], v132, s[28:31], s46 offen sc1
    s_addk_i32 s46, 0x400
    s_waitcnt vmcnt(40) lgkmcnt(0)
    s_add_u32 s47, s51, 0xd8000
    v_mfma_f32_16x16x32_bf16 v[64:67], a[80:83], v[184:187], v[64:67]
    v_mfma_f32_16x16x32_bf16 v[68:71], a[80:83], v[188:191], v[68:71]
    v_mfma_f32_16x16x32_bf16 v[72:75], a[80:83], v[192:195], v[72:75]
    v_mfma_f32_16x16x32_bf16 v[76:79], a[80:83], v[196:199], v[76:79]
    buffer_load_dwordx4 a[80:83], v137, s[16:19], s47 offen offset:0 sc1
    v_mfma_f32_16x16x32_bf16 v[80:83], a[84:87], v[184:187], v[80:83]
    v_mfma_f32_16x16x32_bf16 v[84:87], a[84:87], v[188:191], v[84:87]
    v_mfma_f32_16x16x32_bf16 v[88:91], a[84:87], v[192:195], v[88:91]
    v_mfma_f32_16x16x32_bf16 v[92:95], a[84:87], v[196:199], v[92:95]
    buffer_load_dwordx4 a[84:87], v137, s[16:19], s47 offen offset:1024 sc1
    v_mfma_f32_16x16x32_bf16 v[96:99], a[88:91], v[184:187], v[96:99]
    v_mfma_f32_16x16x32_bf16 v[100:103], a[88:91], v[188:191], v[100:103]
    v_mfma_f32_16x16x32_bf16 v[104:107], a[88:91], v[192:195], v[104:107]
    v_mfma_f32_16x16x32_bf16 v[108:111], a[88:91], v[196:199], v[108:111]
    buffer_load_dwordx4 a[88:91], v137, s[16:19], s47 offen offset:2048 sc1
    v_mfma_f32_16x16x32_bf16 v[112:115], a[92:95], v[184:187], v[112:115]
    v_mfma_f32_16x16x32_bf16 v[116:119], a[92:95], v[188:191], v[116:119]
    v_mfma_f32_16x16x32_bf16 v[120:123], a[92:95], v[192:195], v[120:123]
    v_mfma_f32_16x16x32_bf16 v[124:127], a[92:95], v[196:199], v[124:127]
    buffer_load_dwordx4 a[92:95], v137, s[16:19], s47 offen offset:3072 sc1
    buffer_load_dwordx4 v[184:187], v129, s[28:31], s46 offen sc1
    buffer_load_dwordx4 v[188:191], v130, s[28:31], s46 offen sc1
    buffer_load_dwordx4 v[192:195], v131, s[28:31], s46 offen sc1
    buffer_load_dwordx4 v[196:199], v132, s[28:31], s46 offen sc1
    s_addk_i32 s46, 0x400
    s_waitcnt vmcnt(40) lgkmcnt(0)
    s_add_u32 s47, s51, 0xe0000
    v_mfma_f32_16x16x32_bf16 v[64:67], a[96:99], a[192:195], v[64:67]
    v_mfma_f32_16x16x32_bf16 v[68:71], a[96:99], a[196:199], v[68:71]
    v_mfma_f32_16x16x32_bf16 v[72:75], a[96:99], a[200:203], v[72:75]
    v_mfma_f32_16x16x32_bf16 v[76:79], a[96:99], a[204:207], v[76:79]
    buffer_load_dwordx4 a[96:99], v137, s[16:19], s47 offen offset:0 sc1
    v_mfma_f32_16x16x32_bf16 v[80:83], a[100:103], a[192:195], v[80:83]
    v_mfma_f32_16x16x32_bf16 v[84:87], a[100:103], a[196:199], v[84:87]
    v_mfma_f32_16x16x32_bf16 v[88:91], a[100:103], a[200:203], v[88:91]
    v_mfma_f32_16x16x32_bf16 v[92:95], a[100:103], a[204:207], v[92:95]
    buffer_load_dwordx4 a[100:103], v137, s[16:19], s47 offen offset:1024 sc1
    v_mfma_f32_16x16x32_bf16 v[96:99], a[104:107], a[192:195], v[96:99]
    v_mfma_f32_16x16x32_bf16 v[100:103], a[104:107], a[196:199], v[100:103]
    v_mfma_f32_16x16x32_bf16 v[104:107], a[104:107], a[200:203], v[104:107]
    v_mfma_f32_16x16x32_bf16 v[108:111], a[104:107], a[204:207], v[108:111]
    buffer_load_dwordx4 a[104:107], v137, s[16:19], s47 offen offset:2048 sc1
    v_mfma_f32_16x16x32_bf16 v[112:115], a[108:111], a[192:195], v[112:115]
    v_mfma_f32_16x16x32_bf16 v[116:119], a[108:111], a[196:199], v[116:119]
    v_mfma_f32_16x16x32_bf16 v[120:123], a[108:111], a[200:203], v[120:123]
    v_mfma_f32_16x16x32_bf16 v[124:127], a[108:111], a[204:207], v[124:127]
    buffer_load_dwordx4 a[108:111], v137, s[16:19], s47 offen offset:3072 sc1
    buffer_load_dwordx4 a[192:195], v129, s[28:31], s46 offen sc1
    buffer_load_dwordx4 a[196:199], v130, s[28:31], s46 offen sc1
    buffer_load_dwordx4 a[200:203], v131, s[28:31], s46 offen sc1
    buffer_load_dwordx4 a[204:207], v132, s[28:31], s46 offen sc1
    s_addk_i32 s46, 0x400
    s_waitcnt vmcnt(40) lgkmcnt(0)
    s_add_u32 s47, s51, 0xe8000
    v_mfma_f32_16x16x32_bf16 v[64:67], a[112:115], a[208:211], v[64:67]
    v_mfma_f32_16x16x32_bf16 v[68:71], a[112:115], a[212:215], v[68:71]
    v_mfma_f32_16x16x32_bf16 v[72:75], a[112:115], a[216:219], v[72:75]
    v_mfma_f32_16x16x32_bf16 v[76:79], a[112:115], a[220:223], v[76:79]
    buffer_load_dwordx4 a[112:115], v137, s[16:19], s47 offen offset:0 sc1
    v_mfma_f32_16x16x32_bf16 v[80:83], a[116:119], a[208:211], v[80:83]
    v_mfma_f32_16x16x32_bf16 v[84:87], a[116:119], a[212:215], v[84:87]
    v_mfma_f32_16x16x32_bf16 v[88:91], a[116:119], a[216:219], v[88:91]
    v_mfma_f32_16x16x32_bf16 v[92:95], a[116:119], a[220:223], v[92:95]
    buffer_load_dwordx4 a[116:119], v137, s[16:19], s47 offen offset:1024 sc1
    v_mfma_f32_16x16x32_bf16 v[96:99], a[120:123], a[208:211], v[96:99]
    v_mfma_f32_16x16x32_bf16 v[100:103], a[120:123], a[212:215], v[100:103]
    v_mfma_f32_16x16x32_bf16 v[104:107], a[120:123], a[216:219], v[104:107]
    v_mfma_f32_16x16x32_bf16 v[108:111], a[120:123], a[220:223], v[108:111]
    buffer_load_dwordx4 a[120:123], v137, s[16:19], s47 offen offset:2048 sc1
    v_mfma_f32_16x16x32_bf16 v[112:115], a[124:127], a[208:211], v[112:115]
    v_mfma_f32_16x16x32_bf16 v[116:119], a[124:127], a[212:215], v[116:119]
    v_mfma_f32_16x16x32_bf16 v[120:123], a[124:127], a[216:219], v[120:123]
    v_mfma_f32_16x16x32_bf16 v[124:127], a[124:127], a[220:223], v[124:127]
    buffer_load_dwordx4 a[124:127], v137, s[16:19], s47 offen offset:3072 sc1
    buffer_load_dwordx4 a[208:211], v129, s[28:31], s46 offen sc1
    buffer_load_dwordx4 a[212:215], v130, s[28:31], s46 offen sc1
    buffer_load_dwordx4 a[216:219], v131, s[28:31], s46 offen sc1
    buffer_load_dwordx4 a[220:223], v132, s[28:31], s46 offen sc1
    s_addk_i32 s46, 0x400
    s_waitcnt vmcnt(40) lgkmcnt(0)
    s_add_u32 s47, s51, 0xf0000
    v_mfma_f32_16x16x32_bf16 v[64:67], a[160:163], a[224:227], v[64:67]
    v_mfma_f32_16x16x32_bf16 v[68:71], a[160:163], a[228:231], v[68:71]
    v_mfma_f32_16x16x32_bf16 v[72:75], a[160:163], a[232:235], v[72:75]
    v_mfma_f32_16x16x32_bf16 v[76:79], a[160:163], a[236:239], v[76:79]
    buffer_load_dwordx4 a[160:163], v137, s[16:19], s47 offen offset:0 sc1
    v_mfma_f32_16x16x32_bf16 v[80:83], a[164:167], a[224:227], v[80:83]
    v_mfma_f32_16x16x32_bf16 v[84:87], a[164:167], a[228:231], v[84:87]
    v_mfma_f32_16x16x32_bf16 v[88:91], a[164:167], a[232:235], v[88:91]
    v_mfma_f32_16x16x32_bf16 v[92:95], a[164:167], a[236:239], v[92:95]
    buffer_load_dwordx4 a[164:167], v137, s[16:19], s47 offen offset:1024 sc1
    v_mfma_f32_16x16x32_bf16 v[96:99], a[168:171], a[224:227], v[96:99]
    v_mfma_f32_16x16x32_bf16 v[100:103], a[168:171], a[228:231], v[100:103]
    v_mfma_f32_16x16x32_bf16 v[104:107], a[168:171], a[232:235], v[104:107]
    v_mfma_f32_16x16x32_bf16 v[108:111], a[168:171], a[236:239], v[108:111]
    buffer_load_dwordx4 a[168:171], v137, s[16:19], s47 offen offset:2048 sc1
    v_mfma_f32_16x16x32_bf16 v[112:115], a[172:175], a[224:227], v[112:115]
    v_mfma_f32_16x16x32_bf16 v[116:119], a[172:175], a[228:231], v[116:119]
    v_mfma_f32_16x16x32_bf16 v[120:123], a[172:175], a[232:235], v[120:123]
    v_mfma_f32_16x16x32_bf16 v[124:127], a[172:175], a[236:239], v[124:127]
    buffer_load_dwordx4 a[172:175], v137, s[16:19], s47 offen offset:3072 sc1
    buffer_load_dwordx4 a[224:227], v129, s[28:31], s46 offen sc1
    buffer_load_dwordx4 a[228:231], v130, s[28:31], s46 offen sc1
    buffer_load_dwordx4 a[232:235], v131, s[28:31], s46 offen sc1
    buffer_load_dwordx4 a[236:239], v132, s[28:31], s46 offen sc1
    s_addk_i32 s46, 0x400
    s_waitcnt vmcnt(40) lgkmcnt(0)
    s_add_u32 s47, s51, 0xf8000
    v_mfma_f32_16x16x32_bf16 v[64:67], a[176:179], a[240:243], v[64:67]
    v_mfma_f32_16x16x32_bf16 v[68:71], a[176:179], a[244:247], v[68:71]
    v_mfma_f32_16x16x32_bf16 v[72:75], a[176:179], a[248:251], v[72:75]
    v_mfma_f32_16x16x32_bf16 v[76:79], a[176:179], a[252:255], v[76:79]
    buffer_load_dwordx4 a[176:179], v137, s[16:19], s47 offen offset:0 sc1
    v_mfma_f32_16x16x32_bf16 v[80:83], a[180:183], a[240:243], v[80:83]
    v_mfma_f32_16x16x32_bf16 v[84:87], a[180:183], a[244:247], v[84:87]
    v_mfma_f32_16x16x32_bf16 v[88:91], a[180:183], a[248:251], v[88:91]
    v_mfma_f32_16x16x32_bf16 v[92:95], a[180:183], a[252:255], v[92:95]
    buffer_load_dwordx4 a[180:183], v137, s[16:19], s47 offen offset:1024 sc1
    v_mfma_f32_16x16x32_bf16 v[96:99], a[184:187], a[240:243], v[96:99]
    v_mfma_f32_16x16x32_bf16 v[100:103], a[184:187], a[244:247], v[100:103]
    v_mfma_f32_16x16x32_bf16 v[104:107], a[184:187], a[248:251], v[104:107]
    v_mfma_f32_16x16x32_bf16 v[108:111], a[184:187], a[252:255], v[108:111]
    buffer_load_dwordx4 a[184:187], v137, s[16:19], s47 offen offset:2048 sc1
    v_mfma_f32_16x16x32_bf16 v[112:115], a[188:191], a[240:243], v[112:115]
    v_mfma_f32_16x16x32_bf16 v[116:119], a[188:191], a[244:247], v[116:119]
    v_mfma_f32_16x16x32_bf16 v[120:123], a[188:191], a[248:251], v[120:123]
    v_mfma_f32_16x16x32_bf16 v[124:127], a[188:191], a[252:255], v[124:127]
    buffer_load_dwordx4 a[188:191], v137, s[16:19], s47 offen offset:3072 sc1
    buffer_load_dwordx4 a[240:243], v129, s[28:31], s46 offen sc1
    buffer_load_dwordx4 a[244:247], v130, s[28:31], s46 offen sc1
    buffer_load_dwordx4 a[248:251], v131, s[28:31], s46 offen sc1
    buffer_load_dwordx4 a[252:255], v132, s[28:31], s46 offen sc1
    s_addk_i32 s46, 0x400
    s_waitcnt vmcnt(40) lgkmcnt(0)
    v_mfma_f32_16x16x32_bf16 v[64:67], v[0:3], v[168:171], v[64:67]
    v_mfma_f32_16x16x32_bf16 v[68:71], v[0:3], v[172:175], v[68:71]
    v_mfma_f32_16x16x32_bf16 v[72:75], v[0:3], v[176:179], v[72:75]
    v_mfma_f32_16x16x32_bf16 v[76:79], v[0:3], v[180:183], v[76:79]
    v_mfma_f32_16x16x32_bf16 v[80:83], v[4:7], v[168:171], v[80:83]
    v_mfma_f32_16x16x32_bf16 v[84:87], v[4:7], v[172:175], v[84:87]
    v_mfma_f32_16x16x32_bf16 v[88:91], v[4:7], v[176:179], v[88:91]
    v_mfma_f32_16x16x32_bf16 v[92:95], v[4:7], v[180:183], v[92:95]
    v_mfma_f32_16x16x32_bf16 v[96:99], v[8:11], v[168:171], v[96:99]
    v_mfma_f32_16x16x32_bf16 v[100:103], v[8:11], v[172:175], v[100:103]
    v_mfma_f32_16x16x32_bf16 v[104:107], v[8:11], v[176:179], v[104:107]
    v_mfma_f32_16x16x32_bf16 v[108:111], v[8:11], v[180:183], v[108:111]
    v_mfma_f32_16x16x32_bf16 v[112:115], v[12:15], v[168:171], v[112:115]
    v_mfma_f32_16x16x32_bf16 v[116:119], v[12:15], v[172:175], v[116:119]
    v_mfma_f32_16x16x32_bf16 v[120:123], v[12:15], v[176:179], v[120:123]
    v_mfma_f32_16x16x32_bf16 v[124:127], v[12:15], v[180:183], v[124:127]
    buffer_load_dwordx4 v[168:171], v129, s[28:31], s46 offen sc1
    buffer_load_dwordx4 v[172:175], v130, s[28:31], s46 offen sc1
    buffer_load_dwordx4 v[176:179], v131, s[28:31], s46 offen sc1
    buffer_load_dwordx4 v[180:183], v132, s[28:31], s46 offen sc1
    s_addk_i32 s46, 0x400
    s_waitcnt vmcnt(36) lgkmcnt(0)
    v_mfma_f32_16x16x32_bf16 v[64:67], v[16:19], v[184:187], v[64:67]
    v_mfma_f32_16x16x32_bf16 v[68:71], v[16:19], v[188:191], v[68:71]
    v_mfma_f32_16x16x32_bf16 v[72:75], v[16:19], v[192:195], v[72:75]
    v_mfma_f32_16x16x32_bf16 v[76:79], v[16:19], v[196:199], v[76:79]
    v_mfma_f32_16x16x32_bf16 v[80:83], v[20:23], v[184:187], v[80:83]
    v_mfma_f32_16x16x32_bf16 v[84:87], v[20:23], v[188:191], v[84:87]
    v_mfma_f32_16x16x32_bf16 v[88:91], v[20:23], v[192:195], v[88:91]
    v_mfma_f32_16x16x32_bf16 v[92:95], v[20:23], v[196:199], v[92:95]
    v_mfma_f32_16x16x32_bf16 v[96:99], v[24:27], v[184:187], v[96:99]
    v_mfma_f32_16x16x32_bf16 v[100:103], v[24:27], v[188:191], v[100:103]
    v_mfma_f32_16x16x32_bf16 v[104:107], v[24:27], v[192:195], v[104:107]
    v_mfma_f32_16x16x32_bf16 v[108:111], v[24:27], v[196:199], v[108:111]
    v_mfma_f32_16x16x32_bf16 v[112:115], v[28:31], v[184:187], v[112:115]
    v_mfma_f32_16x16x32_bf16 v[116:119], v[28:31], v[188:191], v[116:119]
    v_mfma_f32_16x16x32_bf16 v[120:123], v[28:31], v[192:195], v[120:123]
    v_mfma_f32_16x16x32_bf16 v[124:127], v[28:31], v[196:199], v[124:127]
    buffer_load_dwordx4 v[184:187], v129, s[28:31], s46 offen sc1
    buffer_load_dwordx4 v[188:191], v130, s[28:31], s46 offen sc1
    buffer_load_dwordx4 v[192:195], v131, s[28:31], s46 offen sc1
    buffer_load_dwordx4 v[196:199], v132, s[28:31], s46 offen sc1
    s_addk_i32 s46, 0x400
    s_waitcnt vmcnt(32) lgkmcnt(0)
    v_mfma_f32_16x16x32_bf16 v[64:67], v[32:35], a[192:195], v[64:67]
    v_mfma_f32_16x16x32_bf16 v[68:71], v[32:35], a[196:199], v[68:71]
    v_mfma_f32_16x16x32_bf16 v[72:75], v[32:35], a[200:203], v[72:75]
    v_mfma_f32_16x16x32_bf16 v[76:79], v[32:35], a[204:207], v[76:79]
    v_mfma_f32_16x16x32_bf16 v[80:83], v[36:39], a[192:195], v[80:83]
    v_mfma_f32_16x16x32_bf16 v[84:87], v[36:39], a[196:199], v[84:87]
    v_mfma_f32_16x16x32_bf16 v[88:91], v[36:39], a[200:203], v[88:91]
    v_mfma_f32_16x16x32_bf16 v[92:95], v[36:39], a[204:207], v[92:95]
    v_mfma_f32_16x16x32_bf16 v[96:99], v[40:43], a[192:195], v[96:99]
    v_mfma_f32_16x16x32_bf16 v[100:103], v[40:43], a[196:199], v[100:103]
    v_mfma_f32_16x16x32_bf16 v[104:107], v[40:43], a[200:203], v[104:107]
    v_mfma_f32_16x16x32_bf16 v[108:111], v[40:43], a[204:207], v[108:111]
    v_mfma_f32_16x16x32_bf16 v[112:115], v[44:47], a[192:195], v[112:115]
    v_mfma_f32_16x16x32_bf16 v[116:119], v[44:47], a[196:199], v[116:119]
    v_mfma_f32_16x16x32_bf16 v[120:123], v[44:47], a[200:203], v[120:123]
    v_mfma_f32_16x16x32_bf16 v[124:127], v[44:47], a[204:207], v[124:127]
    buffer_load_dwordx4 a[192:195], v129, s[28:31], s46 offen sc1
    buffer_load_dwordx4 a[196:199], v130, s[28:31], s46 offen sc1
    buffer_load_dwordx4 a[200:203], v131, s[28:31], s46 offen sc1
    buffer_load_dwordx4 a[204:207], v132, s[28:31], s46 offen sc1
    s_addk_i32 s46, 0x400
    s_waitcnt vmcnt(28) lgkmcnt(0)
    v_mfma_f32_16x16x32_bf16 v[64:67], v[48:51], a[208:211], v[64:67]
    v_mfma_f32_16x16x32_bf16 v[68:71], v[48:51], a[212:215], v[68:71]
    v_mfma_f32_16x16x32_bf16 v[72:75], v[48:51], a[216:219], v[72:75]
    v_mfma_f32_16x16x32_bf16 v[76:79], v[48:51], a[220:223], v[76:79]
    v_mfma_f32_16x16x32_bf16 v[80:83], v[52:55], a[208:211], v[80:83]
    v_mfma_f32_16x16x32_bf16 v[84:87], v[52:55], a[212:215], v[84:87]
    v_mfma_f32_16x16x32_bf16 v[88:91], v[52:55], a[216:219], v[88:91]
    v_mfma_f32_16x16x32_bf16 v[92:95], v[52:55], a[220:223], v[92:95]
    v_mfma_f32_16x16x32_bf16 v[96:99], v[56:59], a[208:211], v[96:99]
    v_mfma_f32_16x16x32_bf16 v[100:103], v[56:59], a[212:215], v[100:103]
    v_mfma_f32_16x16x32_bf16 v[104:107], v[56:59], a[216:219], v[104:107]
    v_mfma_f32_16x16x32_bf16 v[108:111], v[56:59], a[220:223], v[108:111]
    v_mfma_f32_16x16x32_bf16 v[112:115], v[60:63], a[208:211], v[112:115]
    v_mfma_f32_16x16x32_bf16 v[116:119], v[60:63], a[212:215], v[116:119]
    v_mfma_f32_16x16x32_bf16 v[120:123], v[60:63], a[216:219], v[120:123]
    v_mfma_f32_16x16x32_bf16 v[124:127], v[60:63], a[220:223], v[124:127]
    buffer_load_dwordx4 a[208:211], v129, s[28:31], s46 offen sc1
    buffer_load_dwordx4 a[212:215], v130, s[28:31], s46 offen sc1
    buffer_load_dwordx4 a[216:219], v131, s[28:31], s46 offen sc1
    buffer_load_dwordx4 a[220:223], v132, s[28:31], s46 offen sc1
    s_addk_i32 s46, 0x400
    s_waitcnt vmcnt(24) lgkmcnt(0)
    v_mfma_f32_16x16x32_bf16 v[64:67], a[128:131], a[224:227], v[64:67]
    v_mfma_f32_16x16x32_bf16 v[68:71], a[128:131], a[228:231], v[68:71]
    v_mfma_f32_16x16x32_bf16 v[72:75], a[128:131], a[232:235], v[72:75]
    v_mfma_f32_16x16x32_bf16 v[76:79], a[128:131], a[236:239], v[76:79]
    v_mfma_f32_16x16x32_bf16 v[80:83], a[132:135], a[224:227], v[80:83]
    v_mfma_f32_16x16x32_bf16 v[84:87], a[132:135], a[228:231], v[84:87]
    v_mfma_f32_16x16x32_bf16 v[88:91], a[132:135], a[232:235], v[88:91]
    v_mfma_f32_16x16x32_bf16 v[92:95], a[132:135], a[236:239], v[92:95]
    v_mfma_f32_16x16x32_bf16 v[96:99], a[136:139], a[224:227], v[96:99]
    v_mfma_f32_16x16x32_bf16 v[100:103], a[136:139], a[228:231], v[100:103]
    v_mfma_f32_16x16x32_bf16 v[104:107], a[136:139], a[232:235], v[104:107]
    v_mfma_f32_16x16x32_bf16 v[108:111], a[136:139], a[236:239], v[108:111]
    v_mfma_f32_16x16x32_bf16 v[112:115], a[140:143], a[224:227], v[112:115]
    v_mfma_f32_16x16x32_bf16 v[116:119], a[140:143], a[228:231], v[116:119]
    v_mfma_f32_16x16x32_bf16 v[120:123], a[140:143], a[232:235], v[120:123]
    v_mfma_f32_16x16x32_bf16 v[124:127], a[140:143], a[236:239], v[124:127]
    buffer_load_dwordx4 a[224:227], v129, s[28:31], s46 offen sc1
    buffer_load_dwordx4 a[228:231], v130, s[28:31], s46 offen sc1
    buffer_load_dwordx4 a[232:235], v131, s[28:31], s46 offen sc1
    buffer_load_dwordx4 a[236:239], v132, s[28:31], s46 offen sc1
    s_addk_i32 s46, 0x400
    s_waitcnt vmcnt(20) lgkmcnt(0)
    v_mfma_f32_16x16x32_bf16 v[64:67], a[144:147], a[240:243], v[64:67]
    v_mfma_f32_16x16x32_bf16 v[68:71], a[144:147], a[244:247], v[68:71]
    v_mfma_f32_16x16x32_bf16 v[72:75], a[144:147], a[248:251], v[72:75]
    v_mfma_f32_16x16x32_bf16 v[76:79], a[144:147], a[252:255], v[76:79]
    v_mfma_f32_16x16x32_bf16 v[80:83], a[148:151], a[240:243], v[80:83]
    v_mfma_f32_16x16x32_bf16 v[84:87], a[148:151], a[244:247], v[84:87]
    v_mfma_f32_16x16x32_bf16 v[88:91], a[148:151], a[248:251], v[88:91]
    v_mfma_f32_16x16x32_bf16 v[92:95], a[148:151], a[252:255], v[92:95]
    v_mfma_f32_16x16x32_bf16 v[96:99], a[152:155], a[240:243], v[96:99]
    v_mfma_f32_16x16x32_bf16 v[100:103], a[152:155], a[244:247], v[100:103]
    v_mfma_f32_16x16x32_bf16 v[104:107], a[152:155], a[248:251], v[104:107]
    v_mfma_f32_16x16x32_bf16 v[108:111], a[152:155], a[252:255], v[108:111]
    v_mfma_f32_16x16x32_bf16 v[112:115], a[156:159], a[240:243], v[112:115]
    v_mfma_f32_16x16x32_bf16 v[116:119], a[156:159], a[244:247], v[116:119]
    v_mfma_f32_16x16x32_bf16 v[120:123], a[156:159], a[248:251], v[120:123]
    v_mfma_f32_16x16x32_bf16 v[124:127], a[156:159], a[252:255], v[124:127]
    buffer_load_dwordx4 a[240:243], v129, s[28:31], s46 offen sc1
    buffer_load_dwordx4 a[244:247], v130, s[28:31], s46 offen sc1
    buffer_load_dwordx4 a[248:251], v131, s[28:31], s46 offen sc1
    buffer_load_dwordx4 a[252:255], v132, s[28:31], s46 offen sc1
    s_addk_i32 s46, 0x400
    s_waitcnt vmcnt(20) lgkmcnt(0)
    v_mfma_f32_16x16x32_bf16 v[64:67], a[0:3], v[168:171], v[64:67]
    v_mfma_f32_16x16x32_bf16 v[68:71], a[0:3], v[172:175], v[68:71]
    v_mfma_f32_16x16x32_bf16 v[72:75], a[0:3], v[176:179], v[72:75]
    v_mfma_f32_16x16x32_bf16 v[76:79], a[0:3], v[180:183], v[76:79]
    v_mfma_f32_16x16x32_bf16 v[80:83], a[4:7], v[168:171], v[80:83]
    v_mfma_f32_16x16x32_bf16 v[84:87], a[4:7], v[172:175], v[84:87]
    v_mfma_f32_16x16x32_bf16 v[88:91], a[4:7], v[176:179], v[88:91]
    v_mfma_f32_16x16x32_bf16 v[92:95], a[4:7], v[180:183], v[92:95]
    v_mfma_f32_16x16x32_bf16 v[96:99], a[8:11], v[168:171], v[96:99]
    v_mfma_f32_16x16x32_bf16 v[100:103], a[8:11], v[172:175], v[100:103]
    v_mfma_f32_16x16x32_bf16 v[104:107], a[8:11], v[176:179], v[104:107]
    v_mfma_f32_16x16x32_bf16 v[108:111], a[8:11], v[180:183], v[108:111]
    v_mfma_f32_16x16x32_bf16 v[112:115], a[12:15], v[168:171], v[112:115]
    v_mfma_f32_16x16x32_bf16 v[116:119], a[12:15], v[172:175], v[116:119]
    v_mfma_f32_16x16x32_bf16 v[120:123], a[12:15], v[176:179], v[120:123]
    v_mfma_f32_16x16x32_bf16 v[124:127], a[12:15], v[180:183], v[124:127]
    buffer_load_dwordx4 v[168:171], v129, s[28:31], s46 offen sc1
    buffer_load_dwordx4 v[172:175], v130, s[28:31], s46 offen sc1
    buffer_load_dwordx4 v[176:179], v131, s[28:31], s46 offen sc1
    buffer_load_dwordx4 v[180:183], v132, s[28:31], s46 offen sc1
    s_addk_i32 s46, 0x400
    s_waitcnt vmcnt(20) lgkmcnt(0)
    v_mfma_f32_16x16x32_bf16 v[64:67], a[16:19], v[184:187], v[64:67]
    v_mfma_f32_16x16x32_bf16 v[68:71], a[16:19], v[188:191], v[68:71]
    v_mfma_f32_16x16x32_bf16 v[72:75], a[16:19], v[192:195], v[72:75]
    v_mfma_f32_16x16x32_bf16 v[76:79], a[16:19], v[196:199], v[76:79]
    v_mfma_f32_16x16x32_bf16 v[80:83], a[20:23], v[184:187], v[80:83]
    v_mfma_f32_16x16x32_bf16 v[84:87], a[20:23], v[188:191], v[84:87]
    v_mfma_f32_16x16x32_bf16 v[88:91], a[20:23], v[192:195], v[88:91]
    v_mfma_f32_16x16x32_bf16 v[92:95], a[20:23], v[196:199], v[92:95]
    v_mfma_f32_16x16x32_bf16 v[96:99], a[24:27], v[184:187], v[96:99]
    v_mfma_f32_16x16x32_bf16 v[100:103], a[24:27], v[188:191], v[100:103]
    v_mfma_f32_16x16x32_bf16 v[104:107], a[24:27], v[192:195], v[104:107]
    v_mfma_f32_16x16x32_bf16 v[108:111], a[24:27], v[196:199], v[108:111]
    v_mfma_f32_16x16x32_bf16 v[112:115], a[28:31], v[184:187], v[112:115]
    v_mfma_f32_16x16x32_bf16 v[116:119], a[28:31], v[188:191], v[116:119]
    v_mfma_f32_16x16x32_bf16 v[120:123], a[28:31], v[192:195], v[120:123]
    v_mfma_f32_16x16x32_bf16 v[124:127], a[28:31], v[196:199], v[124:127]
    buffer_load_dwordx4 v[184:187], v129, s[28:31], s46 offen sc1
    buffer_load_dwordx4 v[188:191], v130, s[28:31], s46 offen sc1
    buffer_load_dwordx4 v[192:195], v131, s[28:31], s46 offen sc1
    buffer_load_dwordx4 v[196:199], v132, s[28:31], s46 offen sc1
    s_addk_i32 s46, 0x400
    s_waitcnt vmcnt(20) lgkmcnt(0)
    v_mfma_f32_16x16x32_bf16 v[64:67], a[32:35], a[192:195], v[64:67]
    v_mfma_f32_16x16x32_bf16 v[68:71], a[32:35], a[196:199], v[68:71]
    v_mfma_f32_16x16x32_bf16 v[72:75], a[32:35], a[200:203], v[72:75]
    v_mfma_f32_16x16x32_bf16 v[76:79], a[32:35], a[204:207], v[76:79]
    v_mfma_f32_16x16x32_bf16 v[80:83], a[36:39], a[192:195], v[80:83]
    v_mfma_f32_16x16x32_bf16 v[84:87], a[36:39], a[196:199], v[84:87]
    v_mfma_f32_16x16x32_bf16 v[88:91], a[36:39], a[200:203], v[88:91]
    v_mfma_f32_16x16x32_bf16 v[92:95], a[36:39], a[204:207], v[92:95]
    v_mfma_f32_16x16x32_bf16 v[96:99], a[40:43], a[192:195], v[96:99]
    v_mfma_f32_16x16x32_bf16 v[100:103], a[40:43], a[196:199], v[100:103]
    v_mfma_f32_16x16x32_bf16 v[104:107], a[40:43], a[200:203], v[104:107]
    v_mfma_f32_16x16x32_bf16 v[108:111], a[40:43], a[204:207], v[108:111]
    v_mfma_f32_16x16x32_bf16 v[112:115], a[44:47], a[192:195], v[112:115]
    v_mfma_f32_16x16x32_bf16 v[116:119], a[44:47], a[196:199], v[116:119]
    v_mfma_f32_16x16x32_bf16 v[120:123], a[44:47], a[200:203], v[120:123]
    v_mfma_f32_16x16x32_bf16 v[124:127], a[44:47], a[204:207], v[124:127]
    buffer_load_dwordx4 a[192:195], v129, s[28:31], s46 offen sc1
    buffer_load_dwordx4 a[196:199], v130, s[28:31], s46 offen sc1
    buffer_load_dwordx4 a[200:203], v131, s[28:31], s46 offen sc1
    buffer_load_dwordx4 a[204:207], v132, s[28:31], s46 offen sc1
    s_addk_i32 s46, 0x400
    s_waitcnt vmcnt(20) lgkmcnt(0)
    v_mfma_f32_16x16x32_bf16 v[64:67], a[48:51], a[208:211], v[64:67]
    v_mfma_f32_16x16x32_bf16 v[68:71], a[48:51], a[212:215], v[68:71]
    v_mfma_f32_16x16x32_bf16 v[72:75], a[48:51], a[216:219], v[72:75]
    v_mfma_f32_16x16x32_bf16 v[76:79], a[48:51], a[220:223], v[76:79]
    v_mfma_f32_16x16x32_bf16 v[80:83], a[52:55], a[208:211], v[80:83]
    v_mfma_f32_16x16x32_bf16 v[84:87], a[52:55], a[212:215], v[84:87]
    v_mfma_f32_16x16x32_bf16 v[88:91], a[52:55], a[216:219], v[88:91]
    v_mfma_f32_16x16x32_bf16 v[92:95], a[52:55], a[220:223], v[92:95]
    v_mfma_f32_16x16x32_bf16 v[96:99], a[56:59], a[208:211], v[96:99]
    v_mfma_f32_16x16x32_bf16 v[100:103], a[56:59], a[212:215], v[100:103]
    v_mfma_f32_16x16x32_bf16 v[104:107], a[56:59], a[216:219], v[104:107]
    v_mfma_f32_16x16x32_bf16 v[108:111], a[56:59], a[220:223], v[108:111]
    v_mfma_f32_16x16x32_bf16 v[112:115], a[60:63], a[208:211], v[112:115]
    v_mfma_f32_16x16x32_bf16 v[116:119], a[60:63], a[212:215], v[116:119]
    v_mfma_f32_16x16x32_bf16 v[120:123], a[60:63], a[216:219], v[120:123]
    v_mfma_f32_16x16x32_bf16 v[124:127], a[60:63], a[220:223], v[124:127]
    buffer_load_dwordx4 a[208:211], v129, s[28:31], s46 offen sc1
    buffer_load_dwordx4 a[212:215], v130, s[28:31], s46 offen sc1
    buffer_load_dwordx4 a[216:219], v131, s[28:31], s46 offen sc1
    buffer_load_dwordx4 a[220:223], v132, s[28:31], s46 offen sc1
    s_addk_i32 s46, 0x400
    s_waitcnt vmcnt(20) lgkmcnt(0)
    v_mfma_f32_16x16x32_bf16 v[64:67], a[64:67], a[224:227], v[64:67]
    v_mfma_f32_16x16x32_bf16 v[68:71], a[64:67], a[228:231], v[68:71]
    v_mfma_f32_16x16x32_bf16 v[72:75], a[64:67], a[232:235], v[72:75]
    v_mfma_f32_16x16x32_bf16 v[76:79], a[64:67], a[236:239], v[76:79]
    v_mfma_f32_16x16x32_bf16 v[80:83], a[68:71], a[224:227], v[80:83]
    v_mfma_f32_16x16x32_bf16 v[84:87], a[68:71], a[228:231], v[84:87]
    v_mfma_f32_16x16x32_bf16 v[88:91], a[68:71], a[232:235], v[88:91]
    v_mfma_f32_16x16x32_bf16 v[92:95], a[68:71], a[236:239], v[92:95]
    v_mfma_f32_16x16x32_bf16 v[96:99], a[72:75], a[224:227], v[96:99]
    v_mfma_f32_16x16x32_bf16 v[100:103], a[72:75], a[228:231], v[100:103]
    v_mfma_f32_16x16x32_bf16 v[104:107], a[72:75], a[232:235], v[104:107]
    v_mfma_f32_16x16x32_bf16 v[108:111], a[72:75], a[236:239], v[108:111]
    v_mfma_f32_16x16x32_bf16 v[112:115], a[76:79], a[224:227], v[112:115]
    v_mfma_f32_16x16x32_bf16 v[116:119], a[76:79], a[228:231], v[116:119]
    v_mfma_f32_16x16x32_bf16 v[120:123], a[76:79], a[232:235], v[120:123]
    v_mfma_f32_16x16x32_bf16 v[124:127], a[76:79], a[236:239], v[124:127]
    s_waitcnt vmcnt(16) lgkmcnt(0)
    s_nop 0
    v_mfma_f32_16x16x32_bf16 v[64:67], a[80:83], a[240:243], v[64:67]
    v_mfma_f32_16x16x32_bf16 v[68:71], a[80:83], a[244:247], v[68:71]
    v_mfma_f32_16x16x32_bf16 v[72:75], a[80:83], a[248:251], v[72:75]
    v_mfma_f32_16x16x32_bf16 v[76:79], a[80:83], a[252:255], v[76:79]
    v_mfma_f32_16x16x32_bf16 v[80:83], a[84:87], a[240:243], v[80:83]
    v_mfma_f32_16x16x32_bf16 v[84:87], a[84:87], a[244:247], v[84:87]
    v_mfma_f32_16x16x32_bf16 v[88:91], a[84:87], a[248:251], v[88:91]
    v_mfma_f32_16x16x32_bf16 v[92:95], a[84:87], a[252:255], v[92:95]
    v_mfma_f32_16x16x32_bf16 v[96:99], a[88:91], a[240:243], v[96:99]
    v_mfma_f32_16x16x32_bf16 v[100:103], a[88:91], a[244:247], v[100:103]
    v_mfma_f32_16x16x32_bf16 v[104:107], a[88:91], a[248:251], v[104:107]
    v_mfma_f32_16x16x32_bf16 v[108:111], a[88:91], a[252:255], v[108:111]
    v_mfma_f32_16x16x32_bf16 v[112:115], a[92:95], a[240:243], v[112:115]
    v_mfma_f32_16x16x32_bf16 v[116:119], a[92:95], a[244:247], v[116:119]
    v_mfma_f32_16x16x32_bf16 v[120:123], a[92:95], a[248:251], v[120:123]
    v_mfma_f32_16x16x32_bf16 v[124:127], a[92:95], a[252:255], v[124:127]
    s_waitcnt vmcnt(12) lgkmcnt(0)
    s_nop 0
    v_mfma_f32_16x16x32_bf16 v[64:67], a[96:99], v[168:171], v[64:67]
    v_mfma_f32_16x16x32_bf16 v[68:71], a[96:99], v[172:175], v[68:71]
    v_mfma_f32_16x16x32_bf16 v[72:75], a[96:99], v[176:179], v[72:75]
    v_mfma_f32_16x16x32_bf16 v[76:79], a[96:99], v[180:183], v[76:79]
    v_mfma_f32_16x16x32_bf16 v[80:83], a[100:103], v[168:171], v[80:83]
    v_mfma_f32_16x16x32_bf16 v[84:87], a[100:103], v[172:175], v[84:87]
    v_mfma_f32_16x16x32_bf16 v[88:91], a[100:103], v[176:179], v[88:91]
    v_mfma_f32_16x16x32_bf16 v[92:95], a[100:103], v[180:183], v[92:95]
    v_mfma_f32_16x16x32_bf16 v[96:99], a[104:107], v[168:171], v[96:99]
    v_mfma_f32_16x16x32_bf16 v[100:103], a[104:107], v[172:175], v[100:103]
    v_mfma_f32_16x16x32_bf16 v[104:107], a[104:107], v[176:179], v[104:107]
    v_mfma_f32_16x16x32_bf16 v[108:111], a[104:107], v[180:183], v[108:111]
    v_mfma_f32_16x16x32_bf16 v[112:115], a[108:111], v[168:171], v[112:115]
    v_mfma_f32_16x16x32_bf16 v[116:119], a[108:111], v[172:175], v[116:119]
    v_mfma_f32_16x16x32_bf16 v[120:123], a[108:111], v[176:179], v[120:123]
    v_mfma_f32_16x16x32_bf16 v[124:127], a[108:111], v[180:183], v[124:127]
    s_waitcnt vmcnt(8) lgkmcnt(0)
    s_nop 0
    v_mfma_f32_16x16x32_bf16 v[64:67], a[112:115], v[184:187], v[64:67]
    v_mfma_f32_16x16x32_bf16 v[68:71], a[112:115], v[188:191], v[68:71]
    v_mfma_f32_16x16x32_bf16 v[72:75], a[112:115], v[192:195], v[72:75]
    v_mfma_f32_16x16x32_bf16 v[76:79], a[112:115], v[196:199], v[76:79]
    v_mfma_f32_16x16x32_bf16 v[80:83], a[116:119], v[184:187], v[80:83]
    v_mfma_f32_16x16x32_bf16 v[84:87], a[116:119], v[188:191], v[84:87]
    v_mfma_f32_16x16x32_bf16 v[88:91], a[116:119], v[192:195], v[88:91]
    v_mfma_f32_16x16x32_bf16 v[92:95], a[116:119], v[196:199], v[92:95]
    v_mfma_f32_16x16x32_bf16 v[96:99], a[120:123], v[184:187], v[96:99]
    v_mfma_f32_16x16x32_bf16 v[100:103], a[120:123], v[188:191], v[100:103]
    v_mfma_f32_16x16x32_bf16 v[104:107], a[120:123], v[192:195], v[104:107]
    v_mfma_f32_16x16x32_bf16 v[108:111], a[120:123], v[196:199], v[108:111]
    v_mfma_f32_16x16x32_bf16 v[112:115], a[124:127], v[184:187], v[112:115]
    v_mfma_f32_16x16x32_bf16 v[116:119], a[124:127], v[188:191], v[116:119]
    v_mfma_f32_16x16x32_bf16 v[120:123], a[124:127], v[192:195], v[120:123]
    v_mfma_f32_16x16x32_bf16 v[124:127], a[124:127], v[196:199], v[124:127]
    s_waitcnt vmcnt(4) lgkmcnt(0)
    s_nop 0
    v_mfma_f32_16x16x32_bf16 v[64:67], a[160:163], a[192:195], v[64:67]
    v_mfma_f32_16x16x32_bf16 v[68:71], a[160:163], a[196:199], v[68:71]
    v_mfma_f32_16x16x32_bf16 v[72:75], a[160:163], a[200:203], v[72:75]
    v_mfma_f32_16x16x32_bf16 v[76:79], a[160:163], a[204:207], v[76:79]
    v_mfma_f32_16x16x32_bf16 v[80:83], a[164:167], a[192:195], v[80:83]
    v_mfma_f32_16x16x32_bf16 v[84:87], a[164:167], a[196:199], v[84:87]
    v_mfma_f32_16x16x32_bf16 v[88:91], a[164:167], a[200:203], v[88:91]
    v_mfma_f32_16x16x32_bf16 v[92:95], a[164:167], a[204:207], v[92:95]
    v_mfma_f32_16x16x32_bf16 v[96:99], a[168:171], a[192:195], v[96:99]
    v_mfma_f32_16x16x32_bf16 v[100:103], a[168:171], a[196:199], v[100:103]
    v_mfma_f32_16x16x32_bf16 v[104:107], a[168:171], a[200:203], v[104:107]
    v_mfma_f32_16x16x32_bf16 v[108:111], a[168:171], a[204:207], v[108:111]
    v_mfma_f32_16x16x32_bf16 v[112:115], a[172:175], a[192:195], v[112:115]
    v_mfma_f32_16x16x32_bf16 v[116:119], a[172:175], a[196:199], v[116:119]
    v_mfma_f32_16x16x32_bf16 v[120:123], a[172:175], a[200:203], v[120:123]
    v_mfma_f32_16x16x32_bf16 v[124:127], a[172:175], a[204:207], v[124:127]
    s_waitcnt vmcnt(0) lgkmcnt(0)
    s_nop 0
    v_mfma_f32_16x16x32_bf16 v[64:67], a[176:179], a[208:211], v[64:67]
    v_mfma_f32_16x16x32_bf16 v[68:71], a[176:179], a[212:215], v[68:71]
    v_mfma_f32_16x16x32_bf16 v[72:75], a[176:179], a[216:219], v[72:75]
    v_mfma_f32_16x16x32_bf16 v[76:79], a[176:179], a[220:223], v[76:79]
    v_mfma_f32_16x16x32_bf16 v[80:83], a[180:183], a[208:211], v[80:83]
    v_mfma_f32_16x16x32_bf16 v[84:87], a[180:183], a[212:215], v[84:87]
    v_mfma_f32_16x16x32_bf16 v[88:91], a[180:183], a[216:219], v[88:91]
    v_mfma_f32_16x16x32_bf16 v[92:95], a[180:183], a[220:223], v[92:95]
    v_mfma_f32_16x16x32_bf16 v[96:99], a[184:187], a[208:211], v[96:99]
    v_mfma_f32_16x16x32_bf16 v[100:103], a[184:187], a[212:215], v[100:103]
    v_mfma_f32_16x16x32_bf16 v[104:107], a[184:187], a[216:219], v[104:107]
    v_mfma_f32_16x16x32_bf16 v[108:111], a[184:187], a[220:223], v[108:111]
    v_mfma_f32_16x16x32_bf16 v[112:115], a[188:191], a[208:211], v[112:115]
    v_mfma_f32_16x16x32_bf16 v[116:119], a[188:191], a[212:215], v[116:119]
    v_mfma_f32_16x16x32_bf16 v[120:123], a[188:191], a[216:219], v[120:123]
    v_mfma_f32_16x16x32_bf16 v[124:127], a[188:191], a[220:223], v[124:127]
    s_nop 7
    s_barrier
    s_lshl_b32 s44, s36, 14
    s_nop 0
    s_add_u32 s44, s44, 0x10000
    v_add_u32_e64 v143, s44, v251
    ds_write_b128 v143, v[64:67] offset:0
    ds_write_b128 v143, v[80:83] offset:1024
    ds_write_b128 v143, v[96:99] offset:2048
    ds_write_b128 v143, v[112:115] offset:3072
    ds_write_b128 v143, v[68:71] offset:4096
    ds_write_b128 v143, v[84:87] offset:5120
    ds_write_b128 v143, v[100:103] offset:6144
    ds_write_b128 v143, v[116:119] offset:7168
    ds_write_b128 v143, v[72:75] offset:8192
    ds_write_b128 v143, v[88:91] offset:9216
    ds_write_b128 v143, v[104:107] offset:10240
    ds_write_b128 v143, v[120:123] offset:11264
    ds_write_b128 v143, v[76:79] offset:12288
    ds_write_b128 v143, v[92:95] offset:13312
    ds_write_b128 v143, v[108:111] offset:14336
    ds_write_b128 v143, v[124:127] offset:15360
    s_waitcnt lgkmcnt(0)
    s_barrier
    s_lshl_b32 s44, s36, 12
    s_nop 0
    s_add_u32 s44, s44, 0x10000
    v_add_u32_e64 v143, s44, v251
    ds_read_b128 v[0:3], v143 offset:0
    ds_read_b128 v[4:7], v143 offset:1024
    ds_read_b128 v[8:11], v143 offset:2048
    ds_read_b128 v[12:15], v143 offset:3072
    ds_read_b128 v[16:19], v143 offset:16384
    ds_read_b128 v[20:23], v143 offset:17408
    ds_read_b128 v[24:27], v143 offset:18432
    ds_read_b128 v[28:31], v143 offset:19456
    ds_read_b128 v[32:35], v143 offset:32768
    ds_read_b128 v[36:39], v143 offset:33792
    ds_read_b128 v[40:43], v143 offset:34816
    ds_read_b128 v[44:47], v143 offset:35840
    ds_read_b128 v[48:51], v143 offset:49152
    ds_read_b128 v[52:55], v143 offset:50176
    ds_read_b128 v[56:59], v143 offset:51200
    ds_read_b128 v[60:63], v143 offset:52224
    s_waitcnt lgkmcnt(0)
    s_nop 0
    v_pk_add_f32 v[0:1], v[0:1], v[16:17]
    v_pk_add_f32 v[32:33], v[32:33], v[48:49]
    v_pk_add_f32 v[2:3], v[2:3], v[18:19]
    v_pk_add_f32 v[34:35], v[34:35], v[50:51]
    v_pk_add_f32 v[4:5], v[4:5], v[20:21]
    v_pk_add_f32 v[36:37], v[36:37], v[52:53]
    v_pk_add_f32 v[6:7], v[6:7], v[22:23]
    v_pk_add_f32 v[38:39], v[38:39], v[54:55]
    v_pk_add_f32 v[8:9], v[8:9], v[24:25]
    v_pk_add_f32 v[40:41], v[40:41], v[56:57]
    v_pk_add_f32 v[10:11], v[10:11], v[26:27]
    v_pk_add_f32 v[42:43], v[42:43], v[58:59]
    v_pk_add_f32 v[12:13], v[12:13], v[28:29]
    v_pk_add_f32 v[44:45], v[44:45], v[60:61]
    v_pk_add_f32 v[14:15], v[14:15], v[30:31]
    v_pk_add_f32 v[46:47], v[46:47], v[62:63]
    v_pk_add_f32 v[0:1], v[0:1], v[32:33]
    v_pk_add_f32 v[2:3], v[2:3], v[34:35]
    v_pk_add_f32 v[4:5], v[4:5], v[36:37]
    v_pk_add_f32 v[6:7], v[6:7], v[38:39]
    v_pk_add_f32 v[8:9], v[8:9], v[40:41]
    v_pk_add_f32 v[10:11], v[10:11], v[42:43]
    v_pk_add_f32 v[12:13], v[12:13], v[44:45]
    v_pk_add_f32 v[14:15], v[14:15], v[46:47]
    v_lshlrev_b32 v48, 16, v144
    v_fmac_f32 v48, v0, v152
    v_and_b32 v49, 0xffff0000, v144
    v_fmac_f32 v49, v1, v153
    v_lshlrev_b32_e64 v50, 16, v145
    v_fmac_f32 v50, v2, v154
    v_and_b32 v51, 0xffff0000, v145
    v_fmac_f32 v51, v3, v155
    v_lshlrev_b32_e64 v52, 16, v146
    v_fmac_f32 v52, v4, v156
    v_and_b32 v53, 0xffff0000, v146
    v_fmac_f32 v53, v5, v157
    v_lshlrev_b32_e64 v54, 16, v147
    v_fmac_f32 v54, v6, v158
    v_and_b32 v55, 0xffff0000, v147
    v_fmac_f32 v55, v7, v159
    s_nop 0
    v_cvt_pk_bf16_f32 v64, v48, v49
    v_cvt_pk_bf16_f32 v65, v50, v51
    v_cvt_pk_bf16_f32 v66, v52, v53
    v_cvt_pk_bf16_f32 v67, v54, v55
    v_lshlrev_b32 v56, 16, v148
    v_fmac_f32 v56, v8, v160
    v_and_b32 v57, 0xffff0000, v148
    v_fmac_f32 v57, v9, v161
    v_lshlrev_b32_e64 v58, 16, v149
    v_fmac_f32 v58, v10, v162
    v_and_b32 v59, 0xffff0000, v149
    v_fmac_f32 v59, v11, v163
    v_lshlrev_b32_e64 v60, 16, v150
    v_fmac_f32 v60, v12, v164
    v_and_b32 v61, 0xffff0000, v150
    v_fmac_f32 v61, v13, v165
    v_lshlrev_b32_e64 v62, 16, v151
    v_fmac_f32 v62, v14, v166
    v_and_b32 v63, 0xffff0000, v151
    v_fmac_f32 v63, v15, v167
    s_nop 0
    v_cvt_pk_bf16_f32 v68, v56, v57
    v_cvt_pk_bf16_f32 v69, v58, v59
    v_cvt_pk_bf16_f32 v70, v60, v61
    v_cvt_pk_bf16_f32 v71, v62, v63
    buffer_store_dwordx4 v[64:67], v142, s[24:27], 0 offen
    buffer_store_dwordx4 v[68:71], v142, s[24:27], 0 offen offset:64
K1_END:
    s_endpgm
SPIN_19:
    s_nop 0
    s_mov_b32 s45, 0x8000
SPINL_35:
    s_sleep 8
    s_nop 0
    buffer_load_dword v225, off, s[88:91], 0 sc1
    s_waitcnt vmcnt(0)
    v_readfirstlane_b32 s44, v225
    s_sub_u32 s45, s45, 1
    s_cmp_eq_u32 s45, 0
    s_cbranch_scc1 SPINBK_20
    s_nop 0
    s_cmp_ge_u32 s44, 256
    s_cbranch_scc0 SPINL_35
    s_branch SPINBK_20
RARE_1:
    s_call_b64 s[40:41], RAREFN_0
    s_branch BACK_2
RARE_3:
    s_call_b64 s[40:41], RAREFN_1
    s_branch BACK_4
RARE_5:
    s_call_b64 s[40:41], RAREFN_0
    s_branch BACK_6
RARE_7:
    s_call_b64 s[40:41], RAREFN_1
    s_branch BACK_8
RARE_9:
    s_call_b64 s[40:41], RAREFN_0
    s_branch BACK_10
RARE_11:
    s_call_b64 s[40:41], RAREFN_1
    s_branch BACK_12
RARE_13:
    s_call_b64 s[40:41], RAREFN_0
    s_branch BACK_14
RARE_15:
    s_call_b64 s[40:41], RAREFN_1
    s_branch BACK_16
RARE_17:
    s_call_b64 s[40:41], RAREFN_0
    s_branch BACK_18
RARE_21:
    s_call_b64 s[40:41], RAREFN_1
    s_branch BACK_22
RARE_23:
    s_call_b64 s[40:41], RAREFN_0
    s_branch BACK_24
RARE_25:
    s_call_b64 s[40:41], RAREFN_1
    s_branch BACK_26
RARE_27:
    s_call_b64 s[40:41], RAREFN_0
    s_branch BACK_28
RARE_29:
    s_call_b64 s[40:41], RAREFN_1
    s_branch BACK_30
RARE_31:
    s_call_b64 s[40:41], RAREFN_0
    s_branch BACK_32
RARE_33:
    s_call_b64 s[40:41], RAREFN_1
    s_branch BACK_34
RAREFN_0:
    s_nop 15
    s_nop 15
    v_max3_f32 v217, v64, v65, v66
    v_max3_f32 v217, v217, v67, v80
    v_max3_f32 v217, v217, v81, v82
    v_max_f32 v217, v217, v83
    v_mov_b32 v218, v217
    s_nop 1
    v_permlane32_swap_b32 v217, v218
    s_nop 1
    v_max_f32 v217, v217, v218
    v_mov_b32 v218, v217
    s_nop 1
    v_permlane16_swap_b32 v217, v218
    s_nop 1
    v_max_f32 v217, v217, v218
    v_max_f32 v217, 0, v217
    v_exp_f32_e64 v219, -v217
    v_sub_f32 v128, v128, v217
    v_sub_f32 v129, v129, v217
    v_sub_f32 v130, v130, v217
    v_sub_f32 v131, v131, v217
    v_sub_f32 v64, v64, v217
    v_sub_f32 v65, v65, v217
    v_sub_f32 v66, v66, v217
    v_sub_f32 v67, v67, v217
    v_sub_f32 v80, v80, v217
    v_sub_f32 v81, v81, v217
    v_sub_f32 v82, v82, v217
    v_sub_f32 v83, v83, v217
    v_sub_f32 v96, v96, v217
    v_sub_f32 v97, v97, v217
    v_sub_f32 v98, v98, v217
    v_sub_f32 v99, v99, v217
    v_sub_f32 v112, v112, v217
    v_sub_f32 v113, v113, v217
    v_sub_f32 v114, v114, v217
    v_sub_f32 v115, v115, v217
    v_mul_f32_e64 v192, v192, v219
    v_accvgpr_read_b32 v218, a0
    s_nop 0
    v_mul_f32_e64 v218, v218, v219
    s_nop 0
    v_accvgpr_write_b32 a0, v218
    v_accvgpr_read_b32 v218, a1
    s_nop 0
    v_mul_f32_e64 v218, v218, v219
    s_nop 0
    v_accvgpr_write_b32 a1, v218
    v_accvgpr_read_b32 v218, a2
    s_nop 0
    v_mul_f32_e64 v218, v218, v219
    s_nop 0
    v_accvgpr_write_b32 a2, v218
    v_accvgpr_read_b32 v218, a3
    s_nop 0
    v_mul_f32_e64 v218, v218, v219
    s_nop 0
    v_accvgpr_write_b32 a3, v218
    v_accvgpr_read_b32 v218, a16
    s_nop 0
    v_mul_f32_e64 v218, v218, v219
    s_nop 0
    v_accvgpr_write_b32 a16, v218
    v_accvgpr_read_b32 v218, a17
    s_nop 0
    v_mul_f32_e64 v218, v218, v219
    s_nop 0
    v_accvgpr_write_b32 a17, v218
    v_accvgpr_read_b32 v218, a18
    s_nop 0
    v_mul_f32_e64 v218, v218, v219
    s_nop 0
    v_accvgpr_write_b32 a18, v218
    v_accvgpr_read_b32 v218, a19
    s_nop 0
    v_mul_f32_e64 v218, v218, v219
    s_nop 0
    v_accvgpr_write_b32 a19, v218
    v_accvgpr_read_b32 v218, a32
    s_nop 0
    v_mul_f32_e64 v218, v218, v219
    s_nop 0
    v_accvgpr_write_b32 a32, v218
    v_accvgpr_read_b32 v218, a33
    s_nop 0
    v_mul_f32_e64 v218, v218, v219
    s_nop 0
    v_accvgpr_write_b32 a33, v218
    v_accvgpr_read_b32 v218, a34
    s_nop 0
    v_mul_f32_e64 v218, v218, v219
    s_nop 0
    v_accvgpr_write_b32 a34, v218
    v_accvgpr_read_b32 v218, a35
    s_nop 0
    v_mul_f32_e64 v218, v218, v219
    s_nop 0
    v_accvgpr_write_b32 a35, v218
    v_accvgpr_read_b32 v218, a48
    s_nop 0
    v_mul_f32_e64 v218, v218, v219
    s_nop 0
    v_accvgpr_write_b32 a48, v218
    v_accvgpr_read_b32 v218, a49
    s_nop 0
    v_mul_f32_e64 v218, v218, v219
    s_nop 0
    v_accvgpr_write_b32 a49, v218
    v_accvgpr_read_b32 v218, a50
    s_nop 0
    v_mul_f32_e64 v218, v218, v219
    s_nop 0
    v_accvgpr_write_b32 a50, v218
    v_accvgpr_read_b32 v218, a51
    s_nop 0
    v_mul_f32_e64 v218, v218, v219
    s_nop 0
    v_accvgpr_write_b32 a51, v218
    v_accvgpr_read_b32 v218, a64
    s_nop 0
    v_mul_f32_e64 v218, v218, v219
    s_nop 0
    v_accvgpr_write_b32 a64, v218
    v_accvgpr_read_b32 v218, a65
    s_nop 0
    v_mul_f32_e64 v218, v218, v219
    s_nop 0
    v_accvgpr_write_b32 a65, v218
    v_accvgpr_read_b32 v218, a66
    s_nop 0
    v_mul_f32_e64 v218, v218, v219
    s_nop 0
    v_accvgpr_write_b32 a66, v218
    v_accvgpr_read_b32 v218, a67
    s_nop 0
    v_mul_f32_e64 v218, v218, v219
    s_nop 0
    v_accvgpr_write_b32 a67, v218
    v_accvgpr_read_b32 v218, a80
    s_nop 0
    v_mul_f32_e64 v218, v218, v219
    s_nop 0
    v_accvgpr_write_b32 a80, v218
    v_accvgpr_read_b32 v218, a81
    s_nop 0
    v_mul_f32_e64 v218, v218, v219
    s_nop 0
    v_accvgpr_write_b32 a81, v218
    v_accvgpr_read_b32 v218, a82
    s_nop 0
    v_mul_f32_e64 v218, v218, v219
    s_nop 0
    v_accvgpr_write_b32 a82, v218
    v_accvgpr_read_b32 v218, a83
    s_nop 0
    v_mul_f32_e64 v218, v218, v219
    s_nop 0
    v_accvgpr_write_b32 a83, v218
    v_accvgpr_read_b32 v218, a96
    s_nop 0
    v_mul_f32_e64 v218, v218, v219
    s_nop 0
    v_accvgpr_write_b32 a96, v218
    v_accvgpr_read_b32 v218, a97
    s_nop 0
    v_mul_f32_e64 v218, v218, v219
    s_nop 0
    v_accvgpr_write_b32 a97, v218
    v_accvgpr_read_b32 v218, a98
    s_nop 0
    v_mul_f32_e64 v218, v218, v219
    s_nop 0
    v_accvgpr_write_b32 a98, v218
    v_accvgpr_read_b32 v218, a99
    s_nop 0
    v_mul_f32_e64 v218, v218, v219
    s_nop 0
    v_accvgpr_write_b32 a99, v218
    v_accvgpr_read_b32 v218, a112
    s_nop 0
    v_mul_f32_e64 v218, v218, v219
    s_nop 0
    v_accvgpr_write_b32 a112, v218
    v_accvgpr_read_b32 v218, a113
    s_nop 0
    v_mul_f32_e64 v218, v218, v219
    s_nop 0
    v_accvgpr_write_b32 a113, v218
    v_accvgpr_read_b32 v218, a114
    s_nop 0
    v_mul_f32_e64 v218, v218, v219
    s_nop 0
    v_accvgpr_write_b32 a114, v218
    v_accvgpr_read_b32 v218, a115
    s_nop 0
    v_mul_f32_e64 v218, v218, v219
    s_nop 0
    v_accvgpr_write_b32 a115, v218
    v_max3_f32 v217, v68, v69, v70
    v_max3_f32 v217, v217, v71, v84
    v_max3_f32 v217, v217, v85, v86
    v_max_f32 v217, v217, v87
    v_mov_b32 v218, v217
    s_nop 1
    v_permlane32_swap_b32 v217, v218
    s_nop 1
    v_max_f32 v217, v217, v218
    v_mov_b32 v218, v217
    s_nop 1
    v_permlane16_swap_b32 v217, v218
    s_nop 1
    v_max_f32 v217, v217, v218
    v_max_f32 v217, 0, v217
    v_exp_f32_e64 v219, -v217
    v_sub_f32 v132, v132, v217
    v_sub_f32 v133, v133, v217
    v_sub_f32 v134, v134, v217
    v_sub_f32 v135, v135, v217
    v_sub_f32 v68, v68, v217
    v_sub_f32 v69, v69, v217
    v_sub_f32 v70, v70, v217
    v_sub_f32 v71, v71, v217
    v_sub_f32 v84, v84, v217
    v_sub_f32 v85, v85, v217
    v_sub_f32 v86, v86, v217
    v_sub_f32 v87, v87, v217
    v_sub_f32 v100, v100, v217
    v_sub_f32 v101, v101, v217
    v_sub_f32 v102, v102, v217
    v_sub_f32 v103, v103, v217
    v_sub_f32 v116, v116, v217
    v_sub_f32 v117, v117, v217
    v_sub_f32 v118, v118, v217
    v_sub_f32 v119, v119, v217
    v_mul_f32_e64 v193, v193, v219
    v_accvgpr_read_b32 v218, a4
    s_nop 0
    v_mul_f32_e64 v218, v218, v219
    s_nop 0
    v_accvgpr_write_b32 a4, v218
    v_accvgpr_read_b32 v218, a5
    s_nop 0
    v_mul_f32_e64 v218, v218, v219
    s_nop 0
    v_accvgpr_write_b32 a5, v218
    v_accvgpr_read_b32 v218, a6
    s_nop 0
    v_mul_f32_e64 v218, v218, v219
    s_nop 0
    v_accvgpr_write_b32 a6, v218
    v_accvgpr_read_b32 v218, a7
    s_nop 0
    v_mul_f32_e64 v218, v218, v219
    s_nop 0
    v_accvgpr_write_b32 a7, v218
    v_accvgpr_read_b32 v218, a20
    s_nop 0
    v_mul_f32_e64 v218, v218, v219
    s_nop 0
    v_accvgpr_write_b32 a20, v218
    v_accvgpr_read_b32 v218, a21
    s_nop 0
    v_mul_f32_e64 v218, v218, v219
    s_nop 0
    v_accvgpr_write_b32 a21, v218
    v_accvgpr_read_b32 v218, a22
    s_nop 0
    v_mul_f32_e64 v218, v218, v219
    s_nop 0
    v_accvgpr_write_b32 a22, v218
    v_accvgpr_read_b32 v218, a23
    s_nop 0
    v_mul_f32_e64 v218, v218, v219
    s_nop 0
    v_accvgpr_write_b32 a23, v218
    v_accvgpr_read_b32 v218, a36
    s_nop 0
    v_mul_f32_e64 v218, v218, v219
    s_nop 0
    v_accvgpr_write_b32 a36, v218
    v_accvgpr_read_b32 v218, a37
    s_nop 0
    v_mul_f32_e64 v218, v218, v219
    s_nop 0
    v_accvgpr_write_b32 a37, v218
    v_accvgpr_read_b32 v218, a38
    s_nop 0
    v_mul_f32_e64 v218, v218, v219
    s_nop 0
    v_accvgpr_write_b32 a38, v218
    v_accvgpr_read_b32 v218, a39
    s_nop 0
    v_mul_f32_e64 v218, v218, v219
    s_nop 0
    v_accvgpr_write_b32 a39, v218
    v_accvgpr_read_b32 v218, a52
    s_nop 0
    v_mul_f32_e64 v218, v218, v219
    s_nop 0
    v_accvgpr_write_b32 a52, v218
    v_accvgpr_read_b32 v218, a53
    s_nop 0
    v_mul_f32_e64 v218, v218, v219
    s_nop 0
    v_accvgpr_write_b32 a53, v218
    v_accvgpr_read_b32 v218, a54
    s_nop 0
    v_mul_f32_e64 v218, v218, v219
    s_nop 0
    v_accvgpr_write_b32 a54, v218
    v_accvgpr_read_b32 v218, a55
    s_nop 0
    v_mul_f32_e64 v218, v218, v219
    s_nop 0
    v_accvgpr_write_b32 a55, v218
    v_accvgpr_read_b32 v218, a68
    s_nop 0
    v_mul_f32_e64 v218, v218, v219
    s_nop 0
    v_accvgpr_write_b32 a68, v218
    v_accvgpr_read_b32 v218, a69
    s_nop 0
    v_mul_f32_e64 v218, v218, v219
    s_nop 0
    v_accvgpr_write_b32 a69, v218
    v_accvgpr_read_b32 v218, a70
    s_nop 0
    v_mul_f32_e64 v218, v218, v219
    s_nop 0
    v_accvgpr_write_b32 a70, v218
    v_accvgpr_read_b32 v218, a71
    s_nop 0
    v_mul_f32_e64 v218, v218, v219
    s_nop 0
    v_accvgpr_write_b32 a71, v218
    v_accvgpr_read_b32 v218, a84
    s_nop 0
    v_mul_f32_e64 v218, v218, v219
    s_nop 0
    v_accvgpr_write_b32 a84, v218
    v_accvgpr_read_b32 v218, a85
    s_nop 0
    v_mul_f32_e64 v218, v218, v219
    s_nop 0
    v_accvgpr_write_b32 a85, v218
    v_accvgpr_read_b32 v218, a86
    s_nop 0
    v_mul_f32_e64 v218, v218, v219
    s_nop 0
    v_accvgpr_write_b32 a86, v218
    v_accvgpr_read_b32 v218, a87
    s_nop 0
    v_mul_f32_e64 v218, v218, v219
    s_nop 0
    v_accvgpr_write_b32 a87, v218
    v_accvgpr_read_b32 v218, a100
    s_nop 0
    v_mul_f32_e64 v218, v218, v219
    s_nop 0
    v_accvgpr_write_b32 a100, v218
    v_accvgpr_read_b32 v218, a101
    s_nop 0
    v_mul_f32_e64 v218, v218, v219
    s_nop 0
    v_accvgpr_write_b32 a101, v218
    v_accvgpr_read_b32 v218, a102
    s_nop 0
    v_mul_f32_e64 v218, v218, v219
    s_nop 0
    v_accvgpr_write_b32 a102, v218
    v_accvgpr_read_b32 v218, a103
    s_nop 0
    v_mul_f32_e64 v218, v218, v219
    s_nop 0
    v_accvgpr_write_b32 a103, v218
    v_accvgpr_read_b32 v218, a116
    s_nop 0
    v_mul_f32_e64 v218, v218, v219
    s_nop 0
    v_accvgpr_write_b32 a116, v218
    v_accvgpr_read_b32 v218, a117
    s_nop 0
    v_mul_f32_e64 v218, v218, v219
    s_nop 0
    v_accvgpr_write_b32 a117, v218
    v_accvgpr_read_b32 v218, a118
    s_nop 0
    v_mul_f32_e64 v218, v218, v219
    s_nop 0
    v_accvgpr_write_b32 a118, v218
    v_accvgpr_read_b32 v218, a119
    s_nop 0
    v_mul_f32_e64 v218, v218, v219
    s_nop 0
    v_accvgpr_write_b32 a119, v218
    v_max3_f32 v217, v72, v73, v74
    v_max3_f32 v217, v217, v75, v88
    v_max3_f32 v217, v217, v89, v90
    v_max_f32 v217, v217, v91
    v_mov_b32 v218, v217
    s_nop 1
    v_permlane32_swap_b32 v217, v218
    s_nop 1
    v_max_f32 v217, v217, v218
    v_mov_b32 v218, v217
    s_nop 1
    v_permlane16_swap_b32 v217, v218
    s_nop 1
    v_max_f32 v217, v217, v218
    v_max_f32 v217, 0, v217
    v_exp_f32_e64 v219, -v217
    v_sub_f32 v136, v136, v217
    v_sub_f32 v137, v137, v217
    v_sub_f32 v138, v138, v217
    v_sub_f32 v139, v139, v217
    v_sub_f32 v72, v72, v217
    v_sub_f32 v73, v73, v217
    v_sub_f32 v74, v74, v217
    v_sub_f32 v75, v75, v217
    v_sub_f32 v88, v88, v217
    v_sub_f32 v89, v89, v217
    v_sub_f32 v90, v90, v217
    v_sub_f32 v91, v91, v217
    v_sub_f32 v104, v104, v217
    v_sub_f32 v105, v105, v217
    v_sub_f32 v106, v106, v217
    v_sub_f32 v107, v107, v217
    v_sub_f32 v120, v120, v217
    v_sub_f32 v121, v121, v217
    v_sub_f32 v122, v122, v217
    v_sub_f32 v123, v123, v217
    v_mul_f32_e64 v194, v194, v219
    v_accvgpr_read_b32 v218, a8
    s_nop 0
    v_mul_f32_e64 v218, v218, v219
    s_nop 0
    v_accvgpr_write_b32 a8, v218
    v_accvgpr_read_b32 v218, a9
    s_nop 0
    v_mul_f32_e64 v218, v218, v219
    s_nop 0
    v_accvgpr_write_b32 a9, v218
    v_accvgpr_read_b32 v218, a10
    s_nop 0
    v_mul_f32_e64 v218, v218, v219
    s_nop 0
    v_accvgpr_write_b32 a10, v218
    v_accvgpr_read_b32 v218, a11
    s_nop 0
    v_mul_f32_e64 v218, v218, v219
    s_nop 0
    v_accvgpr_write_b32 a11, v218
    v_accvgpr_read_b32 v218, a24
    s_nop 0
    v_mul_f32_e64 v218, v218, v219
    s_nop 0
    v_accvgpr_write_b32 a24, v218
    v_accvgpr_read_b32 v218, a25
    s_nop 0
    v_mul_f32_e64 v218, v218, v219
    s_nop 0
    v_accvgpr_write_b32 a25, v218
    v_accvgpr_read_b32 v218, a26
    s_nop 0
    v_mul_f32_e64 v218, v218, v219
    s_nop 0
    v_accvgpr_write_b32 a26, v218
    v_accvgpr_read_b32 v218, a27
    s_nop 0
    v_mul_f32_e64 v218, v218, v219
    s_nop 0
    v_accvgpr_write_b32 a27, v218
    v_accvgpr_read_b32 v218, a40
    s_nop 0
    v_mul_f32_e64 v218, v218, v219
    s_nop 0
    v_accvgpr_write_b32 a40, v218
    v_accvgpr_read_b32 v218, a41
    s_nop 0
    v_mul_f32_e64 v218, v218, v219
    s_nop 0
    v_accvgpr_write_b32 a41, v218
    v_accvgpr_read_b32 v218, a42
    s_nop 0
    v_mul_f32_e64 v218, v218, v219
    s_nop 0
    v_accvgpr_write_b32 a42, v218
    v_accvgpr_read_b32 v218, a43
    s_nop 0
    v_mul_f32_e64 v218, v218, v219
    s_nop 0
    v_accvgpr_write_b32 a43, v218
    v_accvgpr_read_b32 v218, a56
    s_nop 0
    v_mul_f32_e64 v218, v218, v219
    s_nop 0
    v_accvgpr_write_b32 a56, v218
    v_accvgpr_read_b32 v218, a57
    s_nop 0
    v_mul_f32_e64 v218, v218, v219
    s_nop 0
    v_accvgpr_write_b32 a57, v218
    v_accvgpr_read_b32 v218, a58
    s_nop 0
    v_mul_f32_e64 v218, v218, v219
    s_nop 0
    v_accvgpr_write_b32 a58, v218
    v_accvgpr_read_b32 v218, a59
    s_nop 0
    v_mul_f32_e64 v218, v218, v219
    s_nop 0
    v_accvgpr_write_b32 a59, v218
    v_accvgpr_read_b32 v218, a72
    s_nop 0
    v_mul_f32_e64 v218, v218, v219
    s_nop 0
    v_accvgpr_write_b32 a72, v218
    v_accvgpr_read_b32 v218, a73
    s_nop 0
    v_mul_f32_e64 v218, v218, v219
    s_nop 0
    v_accvgpr_write_b32 a73, v218
    v_accvgpr_read_b32 v218, a74
    s_nop 0
    v_mul_f32_e64 v218, v218, v219
    s_nop 0
    v_accvgpr_write_b32 a74, v218
    v_accvgpr_read_b32 v218, a75
    s_nop 0
    v_mul_f32_e64 v218, v218, v219
    s_nop 0
    v_accvgpr_write_b32 a75, v218
    v_accvgpr_read_b32 v218, a88
    s_nop 0
    v_mul_f32_e64 v218, v218, v219
    s_nop 0
    v_accvgpr_write_b32 a88, v218
    v_accvgpr_read_b32 v218, a89
    s_nop 0
    v_mul_f32_e64 v218, v218, v219
    s_nop 0
    v_accvgpr_write_b32 a89, v218
    v_accvgpr_read_b32 v218, a90
    s_nop 0
    v_mul_f32_e64 v218, v218, v219
    s_nop 0
    v_accvgpr_write_b32 a90, v218
    v_accvgpr_read_b32 v218, a91
    s_nop 0
    v_mul_f32_e64 v218, v218, v219
    s_nop 0
    v_accvgpr_write_b32 a91, v218
    v_accvgpr_read_b32 v218, a104
    s_nop 0
    v_mul_f32_e64 v218, v218, v219
    s_nop 0
    v_accvgpr_write_b32 a104, v218
    v_accvgpr_read_b32 v218, a105
    s_nop 0
    v_mul_f32_e64 v218, v218, v219
    s_nop 0
    v_accvgpr_write_b32 a105, v218
    v_accvgpr_read_b32 v218, a106
    s_nop 0
    v_mul_f32_e64 v218, v218, v219
    s_nop 0
    v_accvgpr_write_b32 a106, v218
    v_accvgpr_read_b32 v218, a107
    s_nop 0
    v_mul_f32_e64 v218, v218, v219
    s_nop 0
    v_accvgpr_write_b32 a107, v218
    v_accvgpr_read_b32 v218, a120
    s_nop 0
    v_mul_f32_e64 v218, v218, v219
    s_nop 0
    v_accvgpr_write_b32 a120, v218
    v_accvgpr_read_b32 v218, a121
    s_nop 0
    v_mul_f32_e64 v218, v218, v219
    s_nop 0
    v_accvgpr_write_b32 a121, v218
    v_accvgpr_read_b32 v218, a122
    s_nop 0
    v_mul_f32_e64 v218, v218, v219
    s_nop 0
    v_accvgpr_write_b32 a122, v218
    v_accvgpr_read_b32 v218, a123
    s_nop 0
    v_mul_f32_e64 v218, v218, v219
    s_nop 0
    v_accvgpr_write_b32 a123, v218
    v_max3_f32 v217, v76, v77, v78
    v_max3_f32 v217, v217, v79, v92
    v_max3_f32 v217, v217, v93, v94
    v_max_f32 v217, v217, v95
    v_mov_b32 v218, v217
    s_nop 1
    v_permlane32_swap_b32 v217, v218
    s_nop 1
    v_max_f32 v217, v217, v218
    v_mov_b32 v218, v217
    s_nop 1
    v_permlane16_swap_b32 v217, v218
    s_nop 1
    v_max_f32 v217, v217, v218
    v_max_f32 v217, 0, v217
    v_exp_f32_e64 v219, -v217
    v_sub_f32 v140, v140, v217
    v_sub_f32 v141, v141, v217
    v_sub_f32 v142, v142, v217
    v_sub_f32 v143, v143, v217
    v_sub_f32 v76, v76, v217
    v_sub_f32 v77, v77, v217
    v_sub_f32 v78, v78, v217
    v_sub_f32 v79, v79, v217
    v_sub_f32 v92, v92, v217
    v_sub_f32 v93, v93, v217
    v_sub_f32 v94, v94, v217
    v_sub_f32 v95, v95, v217
    v_sub_f32 v108, v108, v217
    v_sub_f32 v109, v109, v217
    v_sub_f32 v110, v110, v217
    v_sub_f32 v111, v111, v217
    v_sub_f32 v124, v124, v217
    v_sub_f32 v125, v125, v217
    v_sub_f32 v126, v126, v217
    v_sub_f32 v127, v127, v217
    v_mul_f32_e64 v195, v195, v219
    v_accvgpr_read_b32 v218, a12
    s_nop 0
    v_mul_f32_e64 v218, v218, v219
    s_nop 0
    v_accvgpr_write_b32 a12, v218
    v_accvgpr_read_b32 v218, a13
    s_nop 0
    v_mul_f32_e64 v218, v218, v219
    s_nop 0
    v_accvgpr_write_b32 a13, v218
    v_accvgpr_read_b32 v218, a14
    s_nop 0
    v_mul_f32_e64 v218, v218, v219
    s_nop 0
    v_accvgpr_write_b32 a14, v218
    v_accvgpr_read_b32 v218, a15
    s_nop 0
    v_mul_f32_e64 v218, v218, v219
    s_nop 0
    v_accvgpr_write_b32 a15, v218
    v_accvgpr_read_b32 v218, a28
    s_nop 0
    v_mul_f32_e64 v218, v218, v219
    s_nop 0
    v_accvgpr_write_b32 a28, v218
    v_accvgpr_read_b32 v218, a29
    s_nop 0
    v_mul_f32_e64 v218, v218, v219
    s_nop 0
    v_accvgpr_write_b32 a29, v218
    v_accvgpr_read_b32 v218, a30
    s_nop 0
    v_mul_f32_e64 v218, v218, v219
    s_nop 0
    v_accvgpr_write_b32 a30, v218
    v_accvgpr_read_b32 v218, a31
    s_nop 0
    v_mul_f32_e64 v218, v218, v219
    s_nop 0
    v_accvgpr_write_b32 a31, v218
    v_accvgpr_read_b32 v218, a44
    s_nop 0
    v_mul_f32_e64 v218, v218, v219
    s_nop 0
    v_accvgpr_write_b32 a44, v218
    v_accvgpr_read_b32 v218, a45
    s_nop 0
    v_mul_f32_e64 v218, v218, v219
    s_nop 0
    v_accvgpr_write_b32 a45, v218
    v_accvgpr_read_b32 v218, a46
    s_nop 0
    v_mul_f32_e64 v218, v218, v219
    s_nop 0
    v_accvgpr_write_b32 a46, v218
    v_accvgpr_read_b32 v218, a47
    s_nop 0
    v_mul_f32_e64 v218, v218, v219
    s_nop 0
    v_accvgpr_write_b32 a47, v218
    v_accvgpr_read_b32 v218, a60
    s_nop 0
    v_mul_f32_e64 v218, v218, v219
    s_nop 0
    v_accvgpr_write_b32 a60, v218
    v_accvgpr_read_b32 v218, a61
    s_nop 0
    v_mul_f32_e64 v218, v218, v219
    s_nop 0
    v_accvgpr_write_b32 a61, v218
    v_accvgpr_read_b32 v218, a62
    s_nop 0
    v_mul_f32_e64 v218, v218, v219
    s_nop 0
    v_accvgpr_write_b32 a62, v218
    v_accvgpr_read_b32 v218, a63
    s_nop 0
    v_mul_f32_e64 v218, v218, v219
    s_nop 0
    v_accvgpr_write_b32 a63, v218
    v_accvgpr_read_b32 v218, a76
    s_nop 0
    v_mul_f32_e64 v218, v218, v219
    s_nop 0
    v_accvgpr_write_b32 a76, v218
    v_accvgpr_read_b32 v218, a77
    s_nop 0
    v_mul_f32_e64 v218, v218, v219
    s_nop 0
    v_accvgpr_write_b32 a77, v218
    v_accvgpr_read_b32 v218, a78
    s_nop 0
    v_mul_f32_e64 v218, v218, v219
    s_nop 0
    v_accvgpr_write_b32 a78, v218
    v_accvgpr_read_b32 v218, a79
    s_nop 0
    v_mul_f32_e64 v218, v218, v219
    s_nop 0
    v_accvgpr_write_b32 a79, v218
    v_accvgpr_read_b32 v218, a92
    s_nop 0
    v_mul_f32_e64 v218, v218, v219
    s_nop 0
    v_accvgpr_write_b32 a92, v218
    v_accvgpr_read_b32 v218, a93
    s_nop 0
    v_mul_f32_e64 v218, v218, v219
    s_nop 0
    v_accvgpr_write_b32 a93, v218
    v_accvgpr_read_b32 v218, a94
    s_nop 0
    v_mul_f32_e64 v218, v218, v219
    s_nop 0
    v_accvgpr_write_b32 a94, v218
    v_accvgpr_read_b32 v218, a95
    s_nop 0
    v_mul_f32_e64 v218, v218, v219
    s_nop 0
    v_accvgpr_write_b32 a95, v218
    v_accvgpr_read_b32 v218, a108
    s_nop 0
    v_mul_f32_e64 v218, v218, v219
    s_nop 0
    v_accvgpr_write_b32 a108, v218
    v_accvgpr_read_b32 v218, a109
    s_nop 0
    v_mul_f32_e64 v218, v218, v219
    s_nop 0
    v_accvgpr_write_b32 a109, v218
    v_accvgpr_read_b32 v218, a110
    s_nop 0
    v_mul_f32_e64 v218, v218, v219
    s_nop 0
    v_accvgpr_write_b32 a110, v218
    v_accvgpr_read_b32 v218, a111
    s_nop 0
    v_mul_f32_e64 v218, v218, v219
    s_nop 0
    v_accvgpr_write_b32 a111, v218
    v_accvgpr_read_b32 v218, a124
    s_nop 0
    v_mul_f32_e64 v218, v218, v219
    s_nop 0
    v_accvgpr_write_b32 a124, v218
    v_accvgpr_read_b32 v218, a125
    s_nop 0
    v_mul_f32_e64 v218, v218, v219
    s_nop 0
    v_accvgpr_write_b32 a125, v218
    v_accvgpr_read_b32 v218, a126
    s_nop 0
    v_mul_f32_e64 v218, v218, v219
    s_nop 0
    v_accvgpr_write_b32 a126, v218
    v_accvgpr_read_b32 v218, a127
    s_nop 0
    v_mul_f32_e64 v218, v218, v219
    s_nop 0
    v_accvgpr_write_b32 a127, v218
    v_exp_f32 v176, v64
    s_nop 1
    v_exp_f32 v177, v65
    s_nop 1
    v_add_f32_e64 v196, v176, v177
    v_cvt_pk_bf16_f32 v144, v176, v177
    v_exp_f32 v178, v66
    s_nop 1
    v_add_f32 v196, v196, v178
    v_exp_f32 v179, v67
    s_nop 1
    v_add_f32 v196, v196, v179
    v_cvt_pk_bf16_f32 v145, v178, v179
    v_exp_f32 v180, v80
    s_nop 1
    v_add_f32 v196, v196, v180
    v_exp_f32 v181, v81
    s_nop 1
    v_add_f32 v196, v196, v181
    v_cvt_pk_bf16_f32 v146, v180, v181
    v_exp_f32 v182, v82
    s_nop 1
    v_add_f32 v196, v196, v182
    v_exp_f32 v183, v83
    s_nop 1
    v_add_f32 v196, v196, v183
    v_cvt_pk_bf16_f32 v147, v182, v183
    v_exp_f32 v176, v68
    s_nop 1
    v_exp_f32 v177, v69
    s_nop 1
    v_add_f32_e64 v197, v176, v177
    v_cvt_pk_bf16_f32 v148, v176, v177
    v_exp_f32 v178, v70
    s_nop 1
    v_add_f32 v197, v197, v178
    v_exp_f32 v179, v71
    s_nop 1
    v_add_f32 v197, v197, v179
    v_cvt_pk_bf16_f32 v149, v178, v179
    v_exp_f32 v180, v84
    s_nop 1
    v_add_f32 v197, v197, v180
    v_exp_f32 v181, v85
    s_nop 1
    v_add_f32 v197, v197, v181
    v_cvt_pk_bf16_f32 v150, v180, v181
    v_exp_f32 v182, v86
    s_nop 1
    v_add_f32 v197, v197, v182
    v_exp_f32 v183, v87
    s_nop 1
    v_add_f32 v197, v197, v183
    v_cvt_pk_bf16_f32 v151, v182, v183
    v_exp_f32 v176, v72
    s_nop 1
    v_exp_f32 v177, v73
    s_nop 1
    v_add_f32_e64 v198, v176, v177
    v_cvt_pk_bf16_f32 v152, v176, v177
    v_exp_f32 v178, v74
    s_nop 1
    v_add_f32 v198, v198, v178
    v_exp_f32 v179, v75
    s_nop 1
    v_add_f32 v198, v198, v179
    v_cvt_pk_bf16_f32 v153, v178, v179
    v_exp_f32 v180, v88
    s_nop 1
    v_add_f32 v198, v198, v180
    v_exp_f32 v181, v89
    s_nop 1
    v_add_f32 v198, v198, v181
    v_cvt_pk_bf16_f32 v154, v180, v181
    v_exp_f32 v182, v90
    s_nop 1
    v_add_f32 v198, v198, v182
    v_exp_f32 v183, v91
    s_nop 1
    v_add_f32 v198, v198, v183
    v_cvt_pk_bf16_f32 v155, v182, v183
    v_exp_f32 v176, v76
    s_nop 1
    v_exp_f32 v177, v77
    s_nop 1
    v_add_f32_e64 v199, v176, v177
    v_cvt_pk_bf16_f32 v156, v176, v177
    v_exp_f32 v178, v78
    s_nop 1
    v_add_f32 v199, v199, v178
    v_exp_f32 v179, v79
    s_nop 1
    v_add_f32 v199, v199, v179
    v_cvt_pk_bf16_f32 v157, v178, v179
    v_exp_f32 v180, v92
    s_nop 1
    v_add_f32 v199, v199, v180
    v_exp_f32 v181, v93
    s_nop 1
    v_add_f32 v199, v199, v181
    v_cvt_pk_bf16_f32 v158, v180, v181
    v_exp_f32 v182, v94
    s_nop 1
    v_add_f32 v199, v199, v182
    v_exp_f32 v183, v95
    s_nop 1
    v_add_f32 v199, v199, v183
    v_cvt_pk_bf16_f32 v159, v182, v183
    s_nop 4
    s_setpc_b64 s[40:41]
RAREFN_1:
    s_nop 15
    s_nop 15
    v_max3_f32 v217, v96, v97, v98
    v_max3_f32 v217, v217, v99, v112
    v_max3_f32 v217, v217, v113, v114
    v_max_f32 v217, v217, v115
    v_mov_b32 v218, v217
    s_nop 1
    v_permlane32_swap_b32 v217, v218
    s_nop 1
    v_max_f32 v217, v217, v218
    v_mov_b32 v218, v217
    s_nop 1
    v_permlane16_swap_b32 v217, v218
    s_nop 1
    v_max_f32 v217, v217, v218
    v_max_f32 v217, 0, v217
    v_exp_f32_e64 v219, -v217
    v_sub_f32 v128, v128, v217
    v_sub_f32 v129, v129, v217
    v_sub_f32 v130, v130, v217
    v_sub_f32 v131, v131, v217
    v_sub_f32 v96, v96, v217
    v_sub_f32 v97, v97, v217
    v_sub_f32 v98, v98, v217
    v_sub_f32 v99, v99, v217
    v_sub_f32 v112, v112, v217
    v_sub_f32 v113, v113, v217
    v_sub_f32 v114, v114, v217
    v_sub_f32 v115, v115, v217
    v_sub_f32 v64, v64, v217
    v_sub_f32 v65, v65, v217
    v_sub_f32 v66, v66, v217
    v_sub_f32 v67, v67, v217
    v_sub_f32 v80, v80, v217
    v_sub_f32 v81, v81, v217
    v_sub_f32 v82, v82, v217
    v_sub_f32 v83, v83, v217
    v_mul_f32_e64 v192, v192, v219
    v_accvgpr_read_b32 v218, a0
    s_nop 0
    v_mul_f32_e64 v218, v218, v219
    s_nop 0
    v_accvgpr_write_b32 a0, v218
    v_accvgpr_read_b32 v218, a1
    s_nop 0
    v_mul_f32_e64 v218, v218, v219
    s_nop 0
    v_accvgpr_write_b32 a1, v218
    v_accvgpr_read_b32 v218, a2
    s_nop 0
    v_mul_f32_e64 v218, v218, v219
    s_nop 0
    v_accvgpr_write_b32 a2, v218
    v_accvgpr_read_b32 v218, a3
    s_nop 0
    v_mul_f32_e64 v218, v218, v219
    s_nop 0
    v_accvgpr_write_b32 a3, v218
    v_accvgpr_read_b32 v218, a16
    s_nop 0
    v_mul_f32_e64 v218, v218, v219
    s_nop 0
    v_accvgpr_write_b32 a16, v218
    v_accvgpr_read_b32 v218, a17
    s_nop 0
    v_mul_f32_e64 v218, v218, v219
    s_nop 0
    v_accvgpr_write_b32 a17, v218
    v_accvgpr_read_b32 v218, a18
    s_nop 0
    v_mul_f32_e64 v218, v218, v219
    s_nop 0
    v_accvgpr_write_b32 a18, v218
    v_accvgpr_read_b32 v218, a19
    s_nop 0
    v_mul_f32_e64 v218, v218, v219
    s_nop 0
    v_accvgpr_write_b32 a19, v218
    v_accvgpr_read_b32 v218, a32
    s_nop 0
    v_mul_f32_e64 v218, v218, v219
    s_nop 0
    v_accvgpr_write_b32 a32, v218
    v_accvgpr_read_b32 v218, a33
    s_nop 0
    v_mul_f32_e64 v218, v218, v219
    s_nop 0
    v_accvgpr_write_b32 a33, v218
    v_accvgpr_read_b32 v218, a34
    s_nop 0
    v_mul_f32_e64 v218, v218, v219
    s_nop 0
    v_accvgpr_write_b32 a34, v218
    v_accvgpr_read_b32 v218, a35
    s_nop 0
    v_mul_f32_e64 v218, v218, v219
    s_nop 0
    v_accvgpr_write_b32 a35, v218
    v_accvgpr_read_b32 v218, a48
    s_nop 0
    v_mul_f32_e64 v218, v218, v219
    s_nop 0
    v_accvgpr_write_b32 a48, v218
    v_accvgpr_read_b32 v218, a49
    s_nop 0
    v_mul_f32_e64 v218, v218, v219
    s_nop 0
    v_accvgpr_write_b32 a49, v218
    v_accvgpr_read_b32 v218, a50
    s_nop 0
    v_mul_f32_e64 v218, v218, v219
    s_nop 0
    v_accvgpr_write_b32 a50, v218
    v_accvgpr_read_b32 v218, a51
    s_nop 0
    v_mul_f32_e64 v218, v218, v219
    s_nop 0
    v_accvgpr_write_b32 a51, v218
    v_accvgpr_read_b32 v218, a64
    s_nop 0
    v_mul_f32_e64 v218, v218, v219
    s_nop 0
    v_accvgpr_write_b32 a64, v218
    v_accvgpr_read_b32 v218, a65
    s_nop 0
    v_mul_f32_e64 v218, v218, v219
    s_nop 0
    v_accvgpr_write_b32 a65, v218
    v_accvgpr_read_b32 v218, a66
    s_nop 0
    v_mul_f32_e64 v218, v218, v219
    s_nop 0
    v_accvgpr_write_b32 a66, v218
    v_accvgpr_read_b32 v218, a67
    s_nop 0
    v_mul_f32_e64 v218, v218, v219
    s_nop 0
    v_accvgpr_write_b32 a67, v218
    v_accvgpr_read_b32 v218, a80
    s_nop 0
    v_mul_f32_e64 v218, v218, v219
    s_nop 0
    v_accvgpr_write_b32 a80, v218
    v_accvgpr_read_b32 v218, a81
    s_nop 0
    v_mul_f32_e64 v218, v218, v219
    s_nop 0
    v_accvgpr_write_b32 a81, v218
    v_accvgpr_read_b32 v218, a82
    s_nop 0
    v_mul_f32_e64 v218, v218, v219
    s_nop 0
    v_accvgpr_write_b32 a82, v218
    v_accvgpr_read_b32 v218, a83
    s_nop 0
    v_mul_f32_e64 v218, v218, v219
    s_nop 0
    v_accvgpr_write_b32 a83, v218
    v_accvgpr_read_b32 v218, a96
    s_nop 0
    v_mul_f32_e64 v218, v218, v219
    s_nop 0
    v_accvgpr_write_b32 a96, v218
    v_accvgpr_read_b32 v218, a97
    s_nop 0
    v_mul_f32_e64 v218, v218, v219
    s_nop 0
    v_accvgpr_write_b32 a97, v218
    v_accvgpr_read_b32 v218, a98
    s_nop 0
    v_mul_f32_e64 v218, v218, v219
    s_nop 0
    v_accvgpr_write_b32 a98, v218
    v_accvgpr_read_b32 v218, a99
    s_nop 0
    v_mul_f32_e64 v218, v218, v219
    s_nop 0
    v_accvgpr_write_b32 a99, v218
    v_accvgpr_read_b32 v218, a112
    s_nop 0
    v_mul_f32_e64 v218, v218, v219
    s_nop 0
    v_accvgpr_write_b32 a112, v218
    v_accvgpr_read_b32 v218, a113
    s_nop 0
    v_mul_f32_e64 v218, v218, v219
    s_nop 0
    v_accvgpr_write_b32 a113, v218
    v_accvgpr_read_b32 v218, a114
    s_nop 0
    v_mul_f32_e64 v218, v218, v219
    s_nop 0
    v_accvgpr_write_b32 a114, v218
    v_accvgpr_read_b32 v218, a115
    s_nop 0
    v_mul_f32_e64 v218, v218, v219
    s_nop 0
    v_accvgpr_write_b32 a115, v218
    v_max3_f32 v217, v100, v101, v102
    v_max3_f32 v217, v217, v103, v116
    v_max3_f32 v217, v217, v117, v118
    v_max_f32 v217, v217, v119
    v_mov_b32 v218, v217
    s_nop 1
    v_permlane32_swap_b32 v217, v218
    s_nop 1
    v_max_f32 v217, v217, v218
    v_mov_b32 v218, v217
    s_nop 1
    v_permlane16_swap_b32 v217, v218
    s_nop 1
    v_max_f32 v217, v217, v218
    v_max_f32 v217, 0, v217
    v_exp_f32_e64 v219, -v217
    v_sub_f32 v132, v132, v217
    v_sub_f32 v133, v133, v217
    v_sub_f32 v134, v134, v217
    v_sub_f32 v135, v135, v217
    v_sub_f32 v100, v100, v217
    v_sub_f32 v101, v101, v217
    v_sub_f32 v102, v102, v217
    v_sub_f32 v103, v103, v217
    v_sub_f32 v116, v116, v217
    v_sub_f32 v117, v117, v217
    v_sub_f32 v118, v118, v217
    v_sub_f32 v119, v119, v217
    v_sub_f32 v68, v68, v217
    v_sub_f32 v69, v69, v217
    v_sub_f32 v70, v70, v217
    v_sub_f32 v71, v71, v217
    v_sub_f32 v84, v84, v217
    v_sub_f32 v85, v85, v217
    v_sub_f32 v86, v86, v217
    v_sub_f32 v87, v87, v217
    v_mul_f32_e64 v193, v193, v219
    v_accvgpr_read_b32 v218, a4
    s_nop 0
    v_mul_f32_e64 v218, v218, v219
    s_nop 0
    v_accvgpr_write_b32 a4, v218
    v_accvgpr_read_b32 v218, a5
    s_nop 0
    v_mul_f32_e64 v218, v218, v219
    s_nop 0
    v_accvgpr_write_b32 a5, v218
    v_accvgpr_read_b32 v218, a6
    s_nop 0
    v_mul_f32_e64 v218, v218, v219
    s_nop 0
    v_accvgpr_write_b32 a6, v218
    v_accvgpr_read_b32 v218, a7
    s_nop 0
    v_mul_f32_e64 v218, v218, v219
    s_nop 0
    v_accvgpr_write_b32 a7, v218
    v_accvgpr_read_b32 v218, a20
    s_nop 0
    v_mul_f32_e64 v218, v218, v219
    s_nop 0
    v_accvgpr_write_b32 a20, v218
    v_accvgpr_read_b32 v218, a21
    s_nop 0
    v_mul_f32_e64 v218, v218, v219
    s_nop 0
    v_accvgpr_write_b32 a21, v218
    v_accvgpr_read_b32 v218, a22
    s_nop 0
    v_mul_f32_e64 v218, v218, v219
    s_nop 0
    v_accvgpr_write_b32 a22, v218
    v_accvgpr_read_b32 v218, a23
    s_nop 0
    v_mul_f32_e64 v218, v218, v219
    s_nop 0
    v_accvgpr_write_b32 a23, v218
    v_accvgpr_read_b32 v218, a36
    s_nop 0
    v_mul_f32_e64 v218, v218, v219
    s_nop 0
    v_accvgpr_write_b32 a36, v218
    v_accvgpr_read_b32 v218, a37
    s_nop 0
    v_mul_f32_e64 v218, v218, v219
    s_nop 0
    v_accvgpr_write_b32 a37, v218
    v_accvgpr_read_b32 v218, a38
    s_nop 0
    v_mul_f32_e64 v218, v218, v219
    s_nop 0
    v_accvgpr_write_b32 a38, v218
    v_accvgpr_read_b32 v218, a39
    s_nop 0
    v_mul_f32_e64 v218, v218, v219
    s_nop 0
    v_accvgpr_write_b32 a39, v218
    v_accvgpr_read_b32 v218, a52
    s_nop 0
    v_mul_f32_e64 v218, v218, v219
    s_nop 0
    v_accvgpr_write_b32 a52, v218
    v_accvgpr_read_b32 v218, a53
    s_nop 0
    v_mul_f32_e64 v218, v218, v219
    s_nop 0
    v_accvgpr_write_b32 a53, v218
    v_accvgpr_read_b32 v218, a54
    s_nop 0
    v_mul_f32_e64 v218, v218, v219
    s_nop 0
    v_accvgpr_write_b32 a54, v218
    v_accvgpr_read_b32 v218, a55
    s_nop 0
    v_mul_f32_e64 v218, v218, v219
    s_nop 0
    v_accvgpr_write_b32 a55, v218
    v_accvgpr_read_b32 v218, a68
    s_nop 0
    v_mul_f32_e64 v218, v218, v219
    s_nop 0
    v_accvgpr_write_b32 a68, v218
    v_accvgpr_read_b32 v218, a69
    s_nop 0
    v_mul_f32_e64 v218, v218, v219
    s_nop 0
    v_accvgpr_write_b32 a69, v218
    v_accvgpr_read_b32 v218, a70
    s_nop 0
    v_mul_f32_e64 v218, v218, v219
    s_nop 0
    v_accvgpr_write_b32 a70, v218
    v_accvgpr_read_b32 v218, a71
    s_nop 0
    v_mul_f32_e64 v218, v218, v219
    s_nop 0
    v_accvgpr_write_b32 a71, v218
    v_accvgpr_read_b32 v218, a84
    s_nop 0
    v_mul_f32_e64 v218, v218, v219
    s_nop 0
    v_accvgpr_write_b32 a84, v218
    v_accvgpr_read_b32 v218, a85
    s_nop 0
    v_mul_f32_e64 v218, v218, v219
    s_nop 0
    v_accvgpr_write_b32 a85, v218
    v_accvgpr_read_b32 v218, a86
    s_nop 0
    v_mul_f32_e64 v218, v218, v219
    s_nop 0
    v_accvgpr_write_b32 a86, v218
    v_accvgpr_read_b32 v218, a87
    s_nop 0
    v_mul_f32_e64 v218, v218, v219
    s_nop 0
    v_accvgpr_write_b32 a87, v218
    v_accvgpr_read_b32 v218, a100
    s_nop 0
    v_mul_f32_e64 v218, v218, v219
    s_nop 0
    v_accvgpr_write_b32 a100, v218
    v_accvgpr_read_b32 v218, a101
    s_nop 0
    v_mul_f32_e64 v218, v218, v219
    s_nop 0
    v_accvgpr_write_b32 a101, v218
    v_accvgpr_read_b32 v218, a102
    s_nop 0
    v_mul_f32_e64 v218, v218, v219
    s_nop 0
    v_accvgpr_write_b32 a102, v218
    v_accvgpr_read_b32 v218, a103
    s_nop 0
    v_mul_f32_e64 v218, v218, v219
    s_nop 0
    v_accvgpr_write_b32 a103, v218
    v_accvgpr_read_b32 v218, a116
    s_nop 0
    v_mul_f32_e64 v218, v218, v219
    s_nop 0
    v_accvgpr_write_b32 a116, v218
    v_accvgpr_read_b32 v218, a117
    s_nop 0
    v_mul_f32_e64 v218, v218, v219
    s_nop 0
    v_accvgpr_write_b32 a117, v218
    v_accvgpr_read_b32 v218, a118
    s_nop 0
    v_mul_f32_e64 v218, v218, v219
    s_nop 0
    v_accvgpr_write_b32 a118, v218
    v_accvgpr_read_b32 v218, a119
    s_nop 0
    v_mul_f32_e64 v218, v218, v219
    s_nop 0
    v_accvgpr_write_b32 a119, v218
    v_max3_f32 v217, v104, v105, v106
    v_max3_f32 v217, v217, v107, v120
    v_max3_f32 v217, v217, v121, v122
    v_max_f32 v217, v217, v123
    v_mov_b32 v218, v217
    s_nop 1
    v_permlane32_swap_b32 v217, v218
    s_nop 1
    v_max_f32 v217, v217, v218
    v_mov_b32 v218, v217
    s_nop 1
    v_permlane16_swap_b32 v217, v218
    s_nop 1
    v_max_f32 v217, v217, v218
    v_max_f32 v217, 0, v217
    v_exp_f32_e64 v219, -v217
    v_sub_f32 v136, v136, v217
    v_sub_f32 v137, v137, v217
    v_sub_f32 v138, v138, v217
    v_sub_f32 v139, v139, v217
    v_sub_f32 v104, v104, v217
    v_sub_f32 v105, v105, v217
    v_sub_f32 v106, v106, v217
    v_sub_f32 v107, v107, v217
    v_sub_f32 v120, v120, v217
    v_sub_f32 v121, v121, v217
    v_sub_f32 v122, v122, v217
    v_sub_f32 v123, v123, v217
    v_sub_f32 v72, v72, v217
    v_sub_f32 v73, v73, v217
    v_sub_f32 v74, v74, v217
    v_sub_f32 v75, v75, v217
    v_sub_f32 v88, v88, v217
    v_sub_f32 v89, v89, v217
    v_sub_f32 v90, v90, v217
    v_sub_f32 v91, v91, v217
    v_mul_f32_e64 v194, v194, v219
    v_accvgpr_read_b32 v218, a8
    s_nop 0
    v_mul_f32_e64 v218, v218, v219
    s_nop 0
    v_accvgpr_write_b32 a8, v218
    v_accvgpr_read_b32 v218, a9
    s_nop 0
    v_mul_f32_e64 v218, v218, v219
    s_nop 0
    v_accvgpr_write_b32 a9, v218
    v_accvgpr_read_b32 v218, a10
    s_nop 0
    v_mul_f32_e64 v218, v218, v219
    s_nop 0
    v_accvgpr_write_b32 a10, v218
    v_accvgpr_read_b32 v218, a11
    s_nop 0
    v_mul_f32_e64 v218, v218, v219
    s_nop 0
    v_accvgpr_write_b32 a11, v218
    v_accvgpr_read_b32 v218, a24
    s_nop 0
    v_mul_f32_e64 v218, v218, v219
    s_nop 0
    v_accvgpr_write_b32 a24, v218
    v_accvgpr_read_b32 v218, a25
    s_nop 0
    v_mul_f32_e64 v218, v218, v219
    s_nop 0
    v_accvgpr_write_b32 a25, v218
    v_accvgpr_read_b32 v218, a26
    s_nop 0
    v_mul_f32_e64 v218, v218, v219
    s_nop 0
    v_accvgpr_write_b32 a26, v218
    v_accvgpr_read_b32 v218, a27
    s_nop 0
    v_mul_f32_e64 v218, v218, v219
    s_nop 0
    v_accvgpr_write_b32 a27, v218
    v_accvgpr_read_b32 v218, a40
    s_nop 0
    v_mul_f32_e64 v218, v218, v219
    s_nop 0
    v_accvgpr_write_b32 a40, v218
    v_accvgpr_read_b32 v218, a41
    s_nop 0
    v_mul_f32_e64 v218, v218, v219
    s_nop 0
    v_accvgpr_write_b32 a41, v218
    v_accvgpr_read_b32 v218, a42
    s_nop 0
    v_mul_f32_e64 v218, v218, v219
    s_nop 0
    v_accvgpr_write_b32 a42, v218
    v_accvgpr_read_b32 v218, a43
    s_nop 0
    v_mul_f32_e64 v218, v218, v219
    s_nop 0
    v_accvgpr_write_b32 a43, v218
    v_accvgpr_read_b32 v218, a56
    s_nop 0
    v_mul_f32_e64 v218, v218, v219
    s_nop 0
    v_accvgpr_write_b32 a56, v218
    v_accvgpr_read_b32 v218, a57
    s_nop 0
    v_mul_f32_e64 v218, v218, v219
    s_nop 0
    v_accvgpr_write_b32 a57, v218
    v_accvgpr_read_b32 v218, a58
    s_nop 0
    v_mul_f32_e64 v218, v218, v219
    s_nop 0
    v_accvgpr_write_b32 a58, v218
    v_accvgpr_read_b32 v218, a59
    s_nop 0
    v_mul_f32_e64 v218, v218, v219
    s_nop 0
    v_accvgpr_write_b32 a59, v218
    v_accvgpr_read_b32 v218, a72
    s_nop 0
    v_mul_f32_e64 v218, v218, v219
    s_nop 0
    v_accvgpr_write_b32 a72, v218
    v_accvgpr_read_b32 v218, a73
    s_nop 0
    v_mul_f32_e64 v218, v218, v219
    s_nop 0
    v_accvgpr_write_b32 a73, v218
    v_accvgpr_read_b32 v218, a74
    s_nop 0
    v_mul_f32_e64 v218, v218, v219
    s_nop 0
    v_accvgpr_write_b32 a74, v218
    v_accvgpr_read_b32 v218, a75
    s_nop 0
    v_mul_f32_e64 v218, v218, v219
    s_nop 0
    v_accvgpr_write_b32 a75, v218
    v_accvgpr_read_b32 v218, a88
    s_nop 0
    v_mul_f32_e64 v218, v218, v219
    s_nop 0
    v_accvgpr_write_b32 a88, v218
    v_accvgpr_read_b32 v218, a89
    s_nop 0
    v_mul_f32_e64 v218, v218, v219
    s_nop 0
    v_accvgpr_write_b32 a89, v218
    v_accvgpr_read_b32 v218, a90
    s_nop 0
    v_mul_f32_e64 v218, v218, v219
    s_nop 0
    v_accvgpr_write_b32 a90, v218
    v_accvgpr_read_b32 v218, a91
    s_nop 0
    v_mul_f32_e64 v218, v218, v219
    s_nop 0
    v_accvgpr_write_b32 a91, v218
    v_accvgpr_read_b32 v218, a104
    s_nop 0
    v_mul_f32_e64 v218, v218, v219
    s_nop 0
    v_accvgpr_write_b32 a104, v218
    v_accvgpr_read_b32 v218, a105
    s_nop 0
    v_mul_f32_e64 v218, v218, v219
    s_nop 0
    v_accvgpr_write_b32 a105, v218
    v_accvgpr_read_b32 v218, a106
    s_nop 0
    v_mul_f32_e64 v218, v218, v219
    s_nop 0
    v_accvgpr_write_b32 a106, v218
    v_accvgpr_read_b32 v218, a107
    s_nop 0
    v_mul_f32_e64 v218, v218, v219
    s_nop 0
    v_accvgpr_write_b32 a107, v218
    v_accvgpr_read_b32 v218, a120
    s_nop 0
    v_mul_f32_e64 v218, v218, v219
    s_nop 0
    v_accvgpr_write_b32 a120, v218
    v_accvgpr_read_b32 v218, a121
    s_nop 0
    v_mul_f32_e64 v218, v218, v219
    s_nop 0
    v_accvgpr_write_b32 a121, v218
    v_accvgpr_read_b32 v218, a122
    s_nop 0
    v_mul_f32_e64 v218, v218, v219
    s_nop 0
    v_accvgpr_write_b32 a122, v218
    v_accvgpr_read_b32 v218, a123
    s_nop 0
    v_mul_f32_e64 v218, v218, v219
    s_nop 0
    v_accvgpr_write_b32 a123, v218
    v_max3_f32 v217, v108, v109, v110
    v_max3_f32 v217, v217, v111, v124
    v_max3_f32 v217, v217, v125, v126
    v_max_f32 v217, v217, v127
    v_mov_b32 v218, v217
    s_nop 1
    v_permlane32_swap_b32 v217, v218
    s_nop 1
    v_max_f32 v217, v217, v218
    v_mov_b32 v218, v217
    s_nop 1
    v_permlane16_swap_b32 v217, v218
    s_nop 1
    v_max_f32 v217, v217, v218
    v_max_f32 v217, 0, v217
    v_exp_f32_e64 v219, -v217
    v_sub_f32 v140, v140, v217
    v_sub_f32 v141, v141, v217
    v_sub_f32 v142, v142, v217
    v_sub_f32 v143, v143, v217
    v_sub_f32 v108, v108, v217
    v_sub_f32 v109, v109, v217
    v_sub_f32 v110, v110, v217
    v_sub_f32 v111, v111, v217
    v_sub_f32 v124, v124, v217
    v_sub_f32 v125, v125, v217
    v_sub_f32 v126, v126, v217
    v_sub_f32 v127, v127, v217
    v_sub_f32 v76, v76, v217
    v_sub_f32 v77, v77, v217
    v_sub_f32 v78, v78, v217
    v_sub_f32 v79, v79, v217
    v_sub_f32 v92, v92, v217
    v_sub_f32 v93, v93, v217
    v_sub_f32 v94, v94, v217
    v_sub_f32 v95, v95, v217
    v_mul_f32_e64 v195, v195, v219
    v_accvgpr_read_b32 v218, a12
    s_nop 0
    v_mul_f32_e64 v218, v218, v219
    s_nop 0
    v_accvgpr_write_b32 a12, v218
    v_accvgpr_read_b32 v218, a13
    s_nop 0
    v_mul_f32_e64 v218, v218, v219
    s_nop 0
    v_accvgpr_write_b32 a13, v218
    v_accvgpr_read_b32 v218, a14
    s_nop 0
    v_mul_f32_e64 v218, v218, v219
    s_nop 0
    v_accvgpr_write_b32 a14, v218
    v_accvgpr_read_b32 v218, a15
    s_nop 0
    v_mul_f32_e64 v218, v218, v219
    s_nop 0
    v_accvgpr_write_b32 a15, v218
    v_accvgpr_read_b32 v218, a28
    s_nop 0
    v_mul_f32_e64 v218, v218, v219
    s_nop 0
    v_accvgpr_write_b32 a28, v218
    v_accvgpr_read_b32 v218, a29
    s_nop 0
    v_mul_f32_e64 v218, v218, v219
    s_nop 0
    v_accvgpr_write_b32 a29, v218
    v_accvgpr_read_b32 v218, a30
    s_nop 0
    v_mul_f32_e64 v218, v218, v219
    s_nop 0
    v_accvgpr_write_b32 a30, v218
    v_accvgpr_read_b32 v218, a31
    s_nop 0
    v_mul_f32_e64 v218, v218, v219
    s_nop 0
    v_accvgpr_write_b32 a31, v218
    v_accvgpr_read_b32 v218, a44
    s_nop 0
    v_mul_f32_e64 v218, v218, v219
    s_nop 0
    v_accvgpr_write_b32 a44, v218
    v_accvgpr_read_b32 v218, a45
    s_nop 0
    v_mul_f32_e64 v218, v218, v219
    s_nop 0
    v_accvgpr_write_b32 a45, v218
    v_accvgpr_read_b32 v218, a46
    s_nop 0
    v_mul_f32_e64 v218, v218, v219
    s_nop 0
    v_accvgpr_write_b32 a46, v218
    v_accvgpr_read_b32 v218, a47
    s_nop 0
    v_mul_f32_e64 v218, v218, v219
    s_nop 0
    v_accvgpr_write_b32 a47, v218
    v_accvgpr_read_b32 v218, a60
    s_nop 0
    v_mul_f32_e64 v218, v218, v219
    s_nop 0
    v_accvgpr_write_b32 a60, v218
    v_accvgpr_read_b32 v218, a61
    s_nop 0
    v_mul_f32_e64 v218, v218, v219
    s_nop 0
    v_accvgpr_write_b32 a61, v218
    v_accvgpr_read_b32 v218, a62
    s_nop 0
    v_mul_f32_e64 v218, v218, v219
    s_nop 0
    v_accvgpr_write_b32 a62, v218
    v_accvgpr_read_b32 v218, a63
    s_nop 0
    v_mul_f32_e64 v218, v218, v219
    s_nop 0
    v_accvgpr_write_b32 a63, v218
    v_accvgpr_read_b32 v218, a76
    s_nop 0
    v_mul_f32_e64 v218, v218, v219
    s_nop 0
    v_accvgpr_write_b32 a76, v218
    v_accvgpr_read_b32 v218, a77
    s_nop 0
    v_mul_f32_e64 v218, v218, v219
    s_nop 0
    v_accvgpr_write_b32 a77, v218
    v_accvgpr_read_b32 v218, a78
    s_nop 0
    v_mul_f32_e64 v218, v218, v219
    s_nop 0
    v_accvgpr_write_b32 a78, v218
    v_accvgpr_read_b32 v218, a79
    s_nop 0
    v_mul_f32_e64 v218, v218, v219
    s_nop 0
    v_accvgpr_write_b32 a79, v218
    v_accvgpr_read_b32 v218, a92
    s_nop 0
    v_mul_f32_e64 v218, v218, v219
    s_nop 0
    v_accvgpr_write_b32 a92, v218
    v_accvgpr_read_b32 v218, a93
    s_nop 0
    v_mul_f32_e64 v218, v218, v219
    s_nop 0
    v_accvgpr_write_b32 a93, v218
    v_accvgpr_read_b32 v218, a94
    s_nop 0
    v_mul_f32_e64 v218, v218, v219
    s_nop 0
    v_accvgpr_write_b32 a94, v218
    v_accvgpr_read_b32 v218, a95
    s_nop 0
    v_mul_f32_e64 v218, v218, v219
    s_nop 0
    v_accvgpr_write_b32 a95, v218
    v_accvgpr_read_b32 v218, a108
    s_nop 0
    v_mul_f32_e64 v218, v218, v219
    s_nop 0
    v_accvgpr_write_b32 a108, v218
    v_accvgpr_read_b32 v218, a109
    s_nop 0
    v_mul_f32_e64 v218, v218, v219
    s_nop 0
    v_accvgpr_write_b32 a109, v218
    v_accvgpr_read_b32 v218, a110
    s_nop 0
    v_mul_f32_e64 v218, v218, v219
    s_nop 0
    v_accvgpr_write_b32 a110, v218
    v_accvgpr_read_b32 v218, a111
    s_nop 0
    v_mul_f32_e64 v218, v218, v219
    s_nop 0
    v_accvgpr_write_b32 a111, v218
    v_accvgpr_read_b32 v218, a124
    s_nop 0
    v_mul_f32_e64 v218, v218, v219
    s_nop 0
    v_accvgpr_write_b32 a124, v218
    v_accvgpr_read_b32 v218, a125
    s_nop 0
    v_mul_f32_e64 v218, v218, v219
    s_nop 0
    v_accvgpr_write_b32 a125, v218
    v_accvgpr_read_b32 v218, a126
    s_nop 0
    v_mul_f32_e64 v218, v218, v219
    s_nop 0
    v_accvgpr_write_b32 a126, v218
    v_accvgpr_read_b32 v218, a127
    s_nop 0
    v_mul_f32_e64 v218, v218, v219
    s_nop 0
    v_accvgpr_write_b32 a127, v218
    v_exp_f32 v176, v96
    s_nop 1
    v_exp_f32 v177, v97
    s_nop 1
    v_add_f32_e64 v200, v176, v177
    v_cvt_pk_bf16_f32 v160, v176, v177
    v_exp_f32 v178, v98
    s_nop 1
    v_add_f32 v200, v200, v178
    v_exp_f32 v179, v99
    s_nop 1
    v_add_f32 v200, v200, v179
    v_cvt_pk_bf16_f32 v161, v178, v179
    v_exp_f32 v180, v112
    s_nop 1
    v_add_f32 v200, v200, v180
    v_exp_f32 v181, v113
    s_nop 1
    v_add_f32 v200, v200, v181
    v_cvt_pk_bf16_f32 v162, v180, v181
    v_exp_f32 v182, v114
    s_nop 1
    v_add_f32 v200, v200, v182
    v_exp_f32 v183, v115
    s_nop 1
    v_add_f32 v200, v200, v183
    v_cvt_pk_bf16_f32 v163, v182, v183
    v_exp_f32 v176, v100
    s_nop 1
    v_exp_f32 v177, v101
    s_nop 1
    v_add_f32_e64 v201, v176, v177
    v_cvt_pk_bf16_f32 v164, v176, v177
    v_exp_f32 v178, v102
    s_nop 1
    v_add_f32 v201, v201, v178
    v_exp_f32 v179, v103
    s_nop 1
    v_add_f32 v201, v201, v179
    v_cvt_pk_bf16_f32 v165, v178, v179
    v_exp_f32 v180, v116
    s_nop 1
    v_add_f32 v201, v201, v180
    v_exp_f32 v181, v117
    s_nop 1
    v_add_f32 v201, v201, v181
    v_cvt_pk_bf16_f32 v166, v180, v181
    v_exp_f32 v182, v118
    s_nop 1
    v_add_f32 v201, v201, v182
    v_exp_f32 v183, v119
    s_nop 1
    v_add_f32 v201, v201, v183
    v_cvt_pk_bf16_f32 v167, v182, v183
    v_exp_f32 v176, v104
    s_nop 1
    v_exp_f32 v177, v105
    s_nop 1
    v_add_f32_e64 v202, v176, v177
    v_cvt_pk_bf16_f32 v168, v176, v177
    v_exp_f32 v178, v106
    s_nop 1
    v_add_f32 v202, v202, v178
    v_exp_f32 v179, v107
    s_nop 1
    v_add_f32 v202, v202, v179
    v_cvt_pk_bf16_f32 v169, v178, v179
    v_exp_f32 v180, v120
    s_nop 1
    v_add_f32 v202, v202, v180
    v_exp_f32 v181, v121
    s_nop 1
    v_add_f32 v202, v202, v181
    v_cvt_pk_bf16_f32 v170, v180, v181
    v_exp_f32 v182, v122
    s_nop 1
    v_add_f32 v202, v202, v182
    v_exp_f32 v183, v123
    s_nop 1
    v_add_f32 v202, v202, v183
    v_cvt_pk_bf16_f32 v171, v182, v183
    v_exp_f32 v176, v108
    s_nop 1
    v_exp_f32 v177, v109
    s_nop 1
    v_add_f32_e64 v203, v176, v177
    v_cvt_pk_bf16_f32 v172, v176, v177
    v_exp_f32 v178, v110
    s_nop 1
    v_add_f32 v203, v203, v178
    v_exp_f32 v179, v111
    s_nop 1
    v_add_f32 v203, v203, v179
    v_cvt_pk_bf16_f32 v173, v178, v179
    v_exp_f32 v180, v124
    s_nop 1
    v_add_f32 v203, v203, v180
    v_exp_f32 v181, v125
    s_nop 1
    v_add_f32 v203, v203, v181
    v_cvt_pk_bf16_f32 v174, v180, v181
    v_exp_f32 v182, v126
    s_nop 1
    v_add_f32 v203, v203, v182
    v_exp_f32 v183, v127
    s_nop 1
    v_add_f32 v203, v203, v183
    v_cvt_pk_bf16_f32 v175, v182, v183
    s_nop 4
    s_setpc_b64 s[40:41]
.section .rodata,"a"
.p2align 6
.amdhsa_kernel recurrent_scan__mha_block_cached__dense_activation_relu__prompt_kernel
  .amdhsa_next_free_vgpr 512
  .amdhsa_next_free_sgpr 102
  .amdhsa_accum_offset 256
  .amdhsa_group_segment_fixed_size 0
  .amdhsa_kernarg_size 88
  .amdhsa_user_sgpr_count 2
  .amdhsa_user_sgpr_kernarg_segment_ptr 1
  .amdhsa_system_sgpr_workgroup_id_x 1
  .amdhsa_float_denorm_mode_32 3
.end_amdhsa_kernel
```
